```python
import torch

def _softmax(x, axis=-1):
    return torch.softmax(x, dim=axis)
def _gelu(x):
    return torch.nn.functional.gelu(x, approximate="tanh")
def _silu(x):
    return torch.nn.functional.silu(x)
def _sigmoid(x):
    return torch.sigmoid(x)
def _layernorm(x, axis=-1, eps=1e-5):
    m = x.mean(dim=axis, keepdim=True)
    v = x.var(dim=axis, keepdim=True, unbiased=False)
    return (x - m) / torch.sqrt(v + eps)
def _scatter_add(tgt, idx, src, axis=0):
    return tgt.clone().index_add_(axis, idx, src)
def _segment_sum(src, seg, n):
    out = torch.zeros((n,) + src.shape[1:], dtype=src.dtype)
    return out.index_add_(0, seg, src)
def _pad(x, pw):
    flat = tuple(v for pair in reversed(pw) for v in pair)
    return torch.nn.functional.pad(x, flat)

kernel_name = 'interleave_layers__spectral_gfnet__linear_attn_block__prompt'

def setup_inputs():

    _w = (lambda a: (lambda t: t.to(torch.bfloat16) if t.is_floating_point() else t)(torch.as_tensor(a)))
    def _A_setup():
        B, S, D = 1, 2048, 576
        Df = D // 2 + 1
        return {
            "x": _w((lambda *s: torch.randn(*s, dtype=torch.bfloat16) * 0.05)(B, S, D)),
            "w_r": _w((lambda *s: torch.randn(*s, dtype=torch.bfloat16) * 0.4)(S, Df) * 0.02),
            "w_i": _w((lambda *s: torch.randn(*s, dtype=torch.bfloat16) * 0.4)(S, Df) * 0.02),
        }
    _A_in = _A_setup()

    def _B_setup():
        B, S, D = 1, 2048, 576
        return {
            "x": _w((lambda *s: torch.randn(*s, dtype=torch.bfloat16) * 0.05)(B, S, D)),
            "wqkv": _w((lambda *s: torch.randn(*s, dtype=torch.bfloat16) * 0.05)(D, 3 * D)),
            "wo": _w((lambda *s: torch.randn(*s, dtype=torch.bfloat16) * 0.05)(D, D)),
        }
    _B_in = _B_setup()

    return {
        "A_x": _A_in["x"],
        "A_w_r": _A_in["w_r"],
        "A_w_i": _A_in["w_i"],
        "B_x": _B_in["x"],
        "B_wqkv": _B_in["wqkv"],
        "B_wo": _B_in["wo"],
    }

def reference(A_x, A_w_r, A_w_i, B_x, B_wqkv, B_wo):
    def _A_ref(x, w_r, w_i):
        B, S, D = x.shape
        X = (lambda x, axes=(-2,-1): torch.fft.rfft2(x.float(), dim=axes))(x, axes=(-2, -1))
        W = w_r + 1j * w_i
        X = X * W
        y = (lambda x, s, axes=(-2,-1): torch.fft.irfft2(x, s=s, dim=axes).to(torch.bfloat16))(X, (S, D), axes=(-2, -1))
        return y

    def _B_ref(x, wqkv, wo):
        B, S, D = x.shape
        H = 32; Dh = D // H
        qkv = (lambda x, *d: x.permute(*d))((x @ wqkv).reshape(B, S, 3, H, Dh), 2, 0, 3, 1, 4)
        q, k, v = qkv[0], qkv[1], qkv[2]
        phi = lambda t: torch.where(t > 0, t + 1, torch.exp(t)) + 1e-6
        pq, pk = phi(q), phi(k)
        kv = torch.einsum("bhsd,bhse->bhde", pk, v)
        z = torch.einsum("bhsd->bhd", pk)
        num = torch.einsum("bhqd,bhde->bhqe", pq, kv)
        den = torch.einsum("bhqd,bhd->bhq", pq, z)[..., None] + 1e-6
        o = num / den
        return (lambda x, *d: x.permute(*d))(o, 0, 2, 1, 3).reshape(B, S, D) @ wo

    x = A_x
    x = x + _A_ref(_layernorm(x, axis=-1), A_w_r, A_w_i)
    x = x + _B_ref(_layernorm(x, axis=-1), B_wqkv, B_wo)
    x = x + _A_ref(_layernorm(x, axis=-1), A_w_r, A_w_i)
    x = x + _B_ref(_layernorm(x, axis=-1), B_wqkv, B_wo)
    return x
```

```asm
; @launch kernel=k1_kernel grid=(256,1,1) block=(512,1,1) lds=160768
; @launch kernel=kp_kernel grid=(256,1,1) block=(256,1,1) lds=163840
.amdgcn_target "amdgcn-amd-amdhsa--gfx950"
.text
.globl k1_kernel
.p2align 8
.type k1_kernel,@function
k1_kernel:
 s_cmp_ge_u32 s2, 256
 s_cbranch_scc1 L_k1_exit
 s_load_dwordx2 s[4:5], s[0:1], 64
 s_load_dwordx2 s[6:7], s[0:1], 0
 s_load_dwordx4 s[48:51], s[0:1], 8
 s_load_dwordx2 s[52:53], s[0:1], 32
 s_getpc_b64 s[54:55]
L_k1_pc:
 s_sub_u32 s54, s54, L_k1_pc-k1_kernel
 s_subb_u32 s55, s55, 0
 s_bfe_u32 s3, s2, 0x30003
 s_lshl_b32 s3, s3, 13
 v_lshl_add_u32 v8, v0, 7, s3
 v_min_u32 v8, L_code_end-k1_kernel-4, v8
 v_mov_b32 v9, s55
 v_add_co_u32 v8, vcc, s54, v8
 s_nop 1
 v_addc_co_u32 v9, vcc, 0, v9, vcc
 v_cmp_gt_u32 vcc, 64, v0
 s_cbranch_vccz L_k1_nopf
 global_load_dword v127, v[8:9], off
L_k1_nopf:
 v_lshrrev_b32 v1, 6, v0
 s_nop 0
 v_readfirstlane_b32 s20, v1
 v_and_b32 v1, 63, v0
 v_and_b32 v2, 15, v0
 v_bfe_u32 v3, v0, 4, 2
 v_lshlrev_b32 v4, 4, v1
 s_and_b32 s23, s2, 7
 s_lshl_b32 s23, s23, 2
 s_lshr_b32 s3, s2, 3
 s_and_b32 s24, s3, 3
 s_add_u32 s23, s23, s24
 s_lshr_b32 s24, s3, 2
 s_lshl2_add_u32 s25, s23, s20
 s_and_b32 s21, s24, 1
 s_xor_b32 s21, s21, 1
 s_lshl_b32 s22, s24, 2
 s_lshr_b32 s27, s24, 1
 s_add_u32 s27, s27, 32
 s_and_b32 s3, s2, 7
 s_and_b32 s47, s23, 3
 s_mul_i32 s46, s3, 3
 s_add_u32 s46, s46, s47
 s_add_u32 s61, s3, 24
 s_cmp_lt_u32 s47, 3
 s_cselect_b32 s47, s46, s61
 s_sub_u32 s61, s47, 27
 s_lshl3_add_u32 s61, s61, s24
 s_cmp_lt_u32 s61, 32
 s_cselect_b32 s46, 1, 2
 s_cmp_lt_u32 s47, 27
 s_cselect_b32 s46, 0, s46
 s_cselect_b32 s47, s47, s61
 s_cmp_lt_u32 s20, 4
 s_cbranch_scc1 L_k1_compute
 s_sub_u32 s20, s20, 4
 s_sub_u32 s25, s25, 4
 v_lshrrev_b32 v5, 3, v1
 v_mul_u32_u24 v5, 1152, v5
 v_add_u32 v6, 9216, v5
 v_and_b32 v8, 7, v1
 v_xor_b32 v9, v8, v3
 v_lshl_add_u32 v5, v9, 4, v5
 v_xor_b32 v9, 4, v9
 v_lshl_add_u32 v6, v9, 4, v6
 s_and_b32 s26, s25, 64
 s_bfe_u32 s3, s25, 0x10004
 s_lshl_b32 s3, s3, 5
 s_or_b32 s26, s26, s3
 s_bfe_u32 s3, s25, 0x20001
 s_lshl_b32 s3, s3, 3
 s_or_b32 s26, s26, s3
 s_bfe_u32 s3, s25, 0x10003
 s_lshl_b32 s3, s3, 2
 s_or_b32 s26, s26, s3
 s_and_b32 s3, s25, 1
 s_lshl_b32 s3, s3, 1
 s_or_b32 s26, s26, s3
 s_bfe_u32 s3, s25, 0x10005
 s_or_b32 s26, s26, s3
 s_mul_i32 s32, s26, 18432
 s_mul_i32 s33, s20, 18432
 s_add_u32 s33, s33, 46080
 s_cmp_lg_u32 s46, 0
 s_cbranch_scc1 L_k1_lt1
 s_lshl_b32 s56, s47, 7
 s_lshl2_add_u32 s62, s24, s20
 s_mul_i32 s62, s62, 62208
 s_add_u32 s62, s62, s56
 s_mul_i32 s3, s20, 27648
 s_add_u32 s56, s56, s3
 s_lshl_b32 s60, s20, 10
 s_and_b32 s3, s20, 1
 s_lshl_b32 s3, s3, 2
 v_lshrrev_b32 v7, 3, v1
 v_and_b32 v13, 2, v7
 v_or_b32 v13, s3, v13
 v_and_b32 v14, 7, v1
 v_xor_b32 v13, v13, v14
 v_mul_u32_u24 v7, 3456, v7
 v_lshl_add_u32 v16, v13, 4, v7
 v_min_u32 v15, 17, v1
 v_mul_u32_u24 v15, 3456, v15
 s_waitcnt lgkmcnt(0)
 s_mov_b32 s12, s6
 s_mov_b32 s13, s7
 s_mov_b32 s14, 0x240000
 s_mov_b32 s15, 0x20000
 s_mov_b32 s16, s52
 s_mov_b32 s17, s53
 s_mov_b32 s18, 0x1e6000
 s_mov_b32 s19, 0x20000
 s_mov_b32 s37, s24
 s_mov_b32 s40, 9
L_k1a_x:
 s_lshl_b32 s3, s37, 11
 s_add_u32 m0, s3, s33
 s_lshl_b32 s3, s37, 7
 s_add_u32 s3, s3, s32
 buffer_load_dwordx4 v5, s[12:15], s3 offen lds
 s_add_u32 m0, m0, 1024
 s_add_u32 s37, s37, 1
 buffer_load_dwordx4 v6, s[12:15], s3 offen lds
 s_cmp_lg_u32 s40, 8
 s_cbranch_scc1 L_k1a_np
 s_nop 0
L_k1a_np:
 s_cmp_eq_u32 s37, 9
 s_cselect_b32 s37, 0, s37
 s_sub_u32 s40, s40, 1
 s_cmp_lg_u32 s40, 0
 s_cbranch_scc1 L_k1a_x
 s_add_u32 m0, s60, 119808
 s_nop 0
 buffer_load_dwordx4 v16, s[16:19], s56 offen lds
 s_add_u32 m0, m0, 4096
 s_add_u32 s56, s56, 110592
 buffer_load_dwordx4 v16, s[16:19], s56 offen lds
 s_add_u32 m0, m0, 4096
 s_add_u32 s56, s56, 110592
 buffer_load_dwordx4 v16, s[16:19], s56 offen lds
 s_add_u32 m0, m0, 4096
 s_add_u32 s56, s56, 110592
 buffer_load_dwordx4 v16, s[16:19], s56 offen lds
 s_add_u32 m0, m0, 4096
 s_add_u32 s56, s56, 110592
 buffer_load_dwordx4 v16, s[16:19], s56 offen lds
 s_add_u32 m0, m0, 4096
 s_add_u32 s56, s56, 110592
 buffer_load_dwordx4 v16, s[16:19], s56 offen lds
 s_add_u32 m0, m0, 4096
 s_add_u32 s56, s56, 110592
 s_waitcnt vmcnt(6)
 s_barrier
 buffer_load_dwordx4 v16, s[16:19], s56 offen lds
 s_add_u32 m0, m0, 4096
 s_add_u32 s56, s56, 110592
 buffer_load_dwordx4 v16, s[16:19], s56 offen lds
 s_add_u32 m0, m0, 4096
 s_add_u32 s56, s56, 110592
 buffer_load_dwordx4 v16, s[16:19], s56 offen lds
 s_add_u32 m0, m0, 4096
 s_add_u32 s56, s56, 110592
 buffer_load_dwordx4 v16, s[16:19], s56 offen lds
 s_add_u32 m0, m0, 4096
 s_add_u32 s56, s56, 110592
 s_barrier
 s_add_u32 m0, s60, 46080
 s_nop 0
 buffer_load_dwordx4 v16, s[16:19], s56 offen lds
 s_add_u32 m0, m0, 4096
 s_add_u32 s56, s56, 110592
 buffer_load_dwordx4 v16, s[16:19], s56 offen lds
 s_add_u32 m0, m0, 4096
 s_add_u32 s56, s56, 110592
 buffer_load_dwordx4 v16, s[16:19], s56 offen lds
 s_add_u32 m0, m0, 4096
 s_add_u32 s56, s56, 110592
 buffer_load_dwordx4 v16, s[16:19], s56 offen lds
 s_add_u32 m0, m0, 4096
 s_add_u32 s56, s56, 110592
 buffer_load_dwordx4 v16, s[16:19], s56 offen lds
 s_add_u32 m0, m0, 4096
 s_add_u32 s56, s56, 110592
 buffer_load_dwordx4 v16, s[16:19], s56 offen lds
 s_add_u32 m0, m0, 4096
 s_add_u32 s56, s56, 110592
 buffer_load_dwordx4 v16, s[16:19], s56 offen lds
 s_add_u32 m0, m0, 4096
 s_add_u32 s56, s56, 110592
 buffer_load_dwordx4 v16, s[16:19], s56 offen lds
 s_add_u32 m0, m0, 4096
 s_add_u32 s56, s56, 110592
 s_mov_b32 s8, s4
 s_mov_b32 s9, s5
 s_mov_b32 s10, 0xbf0000
 s_mov_b32 s11, 0x20000
 v_mov_b32 v28, -1
 v_mov_b32 v29, -1
 v_mov_b32 v30, -1
 v_mov_b32 v31, -1
 s_lshl2_add_u32 s3, s2, s20
 s_mul_i32 s3, s3, 3072
 s_add_u32 s3, s3, 0x940000
 buffer_store_dwordx4 v[28:31], v4, s[8:11], s3 offen offset:0 sc1
 buffer_store_dwordx4 v[28:31], v4, s[8:11], s3 offen offset:1024 sc1
 buffer_store_dwordx4 v[28:31], v4, s[8:11], s3 offen offset:2048 sc1
 s_barrier
 s_waitcnt vmcnt(3)
 s_barrier
 s_endpgm
L_k1_lt1:
 s_cmp_eq_u32 s46, 1
 s_cselect_b32 s18, 1183744, 0
 s_mov_b32 s30, s18
 s_and_b32 s3, s47, 3
 s_lshl_b32 s3, s3, 4
 s_and_b32 s56, s47, 28
 s_add_u32 s56, s56, s20
 s_lshl_b32 s56, s56, 6
 s_add_u32 s56, s56, s3
 s_mul_i32 s56, s56, 578
 s_mov_b32 s62, s56
 s_mul_i32 s60, s20, 9216
 v_lshlrev_b32 v15, 7, v1
 s_mov_b32 s3, 0x71c71c8
 v_add_u32 v13, 0, v1
 v_mul_hi_u32 v14, v13, s3
 v_lshl_add_u32 v14, v14, 1, 2
 v_lshl_add_u32 v16, v13, 4, v14
 v_add_u32 v13, 64, v1
 v_mul_hi_u32 v14, v13, s3
 v_lshl_add_u32 v14, v14, 1, 2
 v_lshl_add_u32 v17, v13, 4, v14
 v_add_u32 v13, 128, v1
 v_mul_hi_u32 v14, v13, s3
 v_lshl_add_u32 v14, v14, 1, 2
 v_lshl_add_u32 v18, v13, 4, v14
 v_add_u32 v13, 192, v1
 v_mul_hi_u32 v14, v13, s3
 v_lshl_add_u32 v14, v14, 1, 2
 v_lshl_add_u32 v19, v13, 4, v14
 v_add_u32 v13, 256, v1
 v_mul_hi_u32 v14, v13, s3
 v_lshl_add_u32 v14, v14, 1, 2
 v_lshl_add_u32 v20, v13, 4, v14
 v_add_u32 v13, 320, v1
 v_mul_hi_u32 v14, v13, s3
 v_lshl_add_u32 v14, v14, 1, 2
 v_lshl_add_u32 v21, v13, 4, v14
 v_add_u32 v13, 384, v1
 v_mul_hi_u32 v14, v13, s3
 v_lshl_add_u32 v14, v14, 1, 2
 v_lshl_add_u32 v22, v13, 4, v14
 v_add_u32 v13, 448, v1
 v_mul_hi_u32 v14, v13, s3
 v_lshl_add_u32 v14, v14, 1, 2
 v_lshl_add_u32 v23, v13, 4, v14
 v_add_u32 v13, 512, v1
 v_mul_hi_u32 v14, v13, s3
 v_lshl_add_u32 v14, v14, 1, 2
 v_lshl_add_u32 v24, v13, 4, v14
 s_waitcnt lgkmcnt(0)
 s_mov_b32 s16, s48
 s_mov_b32 s17, s49
 s_mov_b32 s19, 0x20000
 s_mov_b32 s28, s50
 s_mov_b32 s29, s51
 s_mov_b32 s31, 0x20000
 s_mov_b32 s12, s6
 s_mov_b32 s13, s7
 s_mov_b32 s14, 0x240000
 s_mov_b32 s15, 0x20000
 s_mov_b32 s37, s24
 s_mov_b32 s40, 9
L_k1b_x:
 s_lshl_b32 s3, s37, 11
 s_add_u32 m0, s3, s33
 s_lshl_b32 s3, s37, 7
 s_add_u32 s3, s3, s32
 buffer_load_dwordx4 v5, s[12:15], s3 offen lds
 s_add_u32 m0, m0, 1024
 s_add_u32 s37, s37, 1
 buffer_load_dwordx4 v6, s[12:15], s3 offen lds
 s_cmp_lg_u32 s40, 8
 s_cbranch_scc1 L_k1b_np
 s_nop 0
L_k1b_np:
 s_cmp_eq_u32 s37, 9
 s_cselect_b32 s37, 0, s37
 s_sub_u32 s40, s40, 1
 s_cmp_lg_u32 s40, 0
 s_cbranch_scc1 L_k1b_x
 s_add_u32 m0, s60, 119808
 s_nop 0
 buffer_load_dwordx4 v16, s[16:19], s56 offen lds
 s_add_u32 m0, m0, 1024
 s_nop 0
 buffer_load_dwordx4 v17, s[16:19], s56 offen lds
 s_add_u32 m0, m0, 1024
 s_nop 0
 buffer_load_dwordx4 v18, s[16:19], s56 offen lds
 s_add_u32 m0, m0, 1024
 s_nop 0
 buffer_load_dwordx4 v19, s[16:19], s56 offen lds
 s_add_u32 m0, m0, 1024
 s_nop 0
 buffer_load_dwordx4 v20, s[16:19], s56 offen lds
 s_add_u32 m0, m0, 1024
 s_nop 0
 buffer_load_dwordx4 v21, s[16:19], s56 offen lds
 s_add_u32 m0, m0, 1024
 s_waitcnt vmcnt(6)
 s_barrier
 buffer_load_dwordx4 v22, s[16:19], s56 offen lds
 s_add_u32 m0, m0, 1024
 s_nop 0
 buffer_load_dwordx4 v23, s[16:19], s56 offen lds
 s_add_u32 m0, m0, 1024
 s_nop 0
 buffer_load_dwordx4 v24, s[16:19], s56 offen lds
 s_add_u32 m0, m0, 1024
 s_barrier
 s_add_u32 m0, s60, 46080
 s_nop 0
 buffer_load_dwordx4 v16, s[28:31], s56 offen lds
 s_add_u32 m0, m0, 1024
 s_nop 0
 buffer_load_dwordx4 v17, s[28:31], s56 offen lds
 s_add_u32 m0, m0, 1024
 s_nop 0
 buffer_load_dwordx4 v18, s[28:31], s56 offen lds
 s_add_u32 m0, m0, 1024
 s_nop 0
 buffer_load_dwordx4 v19, s[28:31], s56 offen lds
 s_add_u32 m0, m0, 1024
 s_nop 0
 buffer_load_dwordx4 v20, s[28:31], s56 offen lds
 s_add_u32 m0, m0, 1024
 s_nop 0
 buffer_load_dwordx4 v21, s[28:31], s56 offen lds
 s_add_u32 m0, m0, 1024
 s_nop 0
 buffer_load_dwordx4 v22, s[28:31], s56 offen lds
 s_add_u32 m0, m0, 1024
 s_nop 0
 buffer_load_dwordx4 v23, s[28:31], s56 offen lds
 s_add_u32 m0, m0, 1024
 s_nop 0
 buffer_load_dwordx4 v24, s[28:31], s56 offen lds
 s_add_u32 m0, m0, 1024
 s_mov_b32 s8, s4
 s_mov_b32 s9, s5
 s_mov_b32 s10, 0xbf0000
 s_mov_b32 s11, 0x20000
 v_mov_b32 v28, -1
 v_mov_b32 v29, -1
 v_mov_b32 v30, -1
 v_mov_b32 v31, -1
 s_lshl2_add_u32 s3, s2, s20
 s_mul_i32 s3, s3, 3072
 s_add_u32 s3, s3, 0x940000
 buffer_store_dwordx4 v[28:31], v4, s[8:11], s3 offen offset:0 sc1
 buffer_store_dwordx4 v[28:31], v4, s[8:11], s3 offen offset:1024 sc1
 buffer_store_dwordx4 v[28:31], v4, s[8:11], s3 offen offset:2048 sc1
 s_barrier
 s_waitcnt vmcnt(3)
 s_barrier
 s_endpgm
L_k1_compute:
 s_add_u32 s38, s22, s20
 v_lshrrev_b32 v8, 2, v2
 v_lshlrev_b32 v8, 3, v8
 v_and_b32 v9, 3, v2
 v_add_u32 v8, v8, v9
 v_lshlrev_b32 v9, 3, v3
 v_cvt_f32_u32 v9, v9
 s_lshr_b32 s3, s38, 1
 s_lshl_b32 s3, s3, 5
 s_and_b32 s39, s38, 1
 s_lshl2_add_u32 s3, s39, s3
 v_add_u32 v10, s3, v8
 v_lshrrev_b32 v11, 1, v10
 v_and_b32 v12, 1, v10
 v_cvt_f32_u32 v12, v12
 v_mul_f32 v12, 0x3e800000, v12
 v_cvt_f32_u32 v11, v11
 v_mul_f32 v11, 0x3ae38e39, v11
 v_cmp_eq_u32 vcc, 0, v10
 s_nop 1
 v_cndmask_b32 v11, v11, 0.5, vcc
 v_cmp_eq_u32 vcc, 1, v10
 s_nop 1
 v_cndmask_b32 v12, v12, 0, vcc
 v_cos_f32 v15, v11
 s_nop 0
 v_add_f32 v15, v15, v15
 v_mul_f32 v13, 0x42000000, v11
 v_fma_f32 v88, v9, v11, v12
 v_add_f32 v96, v88, v13
 v_add_f32 v89, v88, v11
 v_add_f32 v97, v96, v11
 v_cos_f32 v13, v13
 v_cos_f32 v88, v88
 v_cos_f32 v96, v96
 v_cos_f32 v89, v89
 v_cos_f32 v97, v97
 s_lshl_b32 s3, s20, 10
 v_add_u32 v14, s3, v4
 v_add_f32 v13, v13, v13
 v_fma_f32 v90, v15, v89, -v88
 v_fma_f32 v98, v15, v97, -v96
 v_fma_f32 v91, v15, v90, -v89
 v_fma_f32 v99, v15, v98, -v97
 v_fma_f32 v92, v15, v91, -v90
 v_fma_f32 v100, v15, v99, -v98
 v_fma_f32 v93, v15, v92, -v91
 v_fma_f32 v101, v15, v100, -v99
 v_fma_f32 v94, v15, v93, -v92
 v_fma_f32 v102, v15, v101, -v100
 v_fma_f32 v95, v15, v94, -v93
 v_fma_f32 v103, v15, v102, -v101
 v_cvt_pk_bf16_f32 v104, v88, v89
 v_cvt_pk_bf16_f32 v105, v90, v91
 v_cvt_pk_bf16_f32 v106, v92, v93
 v_cvt_pk_bf16_f32 v107, v94, v95
 ds_write_b128 v14, v[104:107] offset:0
 v_cvt_pk_bf16_f32 v108, v96, v97
 v_cvt_pk_bf16_f32 v109, v98, v99
 v_cvt_pk_bf16_f32 v110, v100, v101
 v_cvt_pk_bf16_f32 v111, v102, v103
 ds_write_b128 v14, v[108:111] offset:5120
 v_fma_f32 v88, v13, v96, -v88
 v_fma_f32 v89, v13, v97, -v89
 v_fma_f32 v90, v13, v98, -v90
 v_fma_f32 v91, v13, v99, -v91
 v_fma_f32 v92, v13, v100, -v92
 v_fma_f32 v93, v13, v101, -v93
 v_fma_f32 v94, v13, v102, -v94
 v_fma_f32 v95, v13, v103, -v95
 v_cvt_pk_bf16_f32 v104, v88, v89
 v_cvt_pk_bf16_f32 v105, v90, v91
 v_cvt_pk_bf16_f32 v106, v92, v93
 v_cvt_pk_bf16_f32 v107, v94, v95
 ds_write_b128 v14, v[104:107] offset:10240
 v_fma_f32 v96, v13, v88, -v96
 v_fma_f32 v97, v13, v89, -v97
 v_fma_f32 v98, v13, v90, -v98
 v_fma_f32 v99, v13, v91, -v99
 v_fma_f32 v100, v13, v92, -v100
 v_fma_f32 v101, v13, v93, -v101
 v_fma_f32 v102, v13, v94, -v102
 v_fma_f32 v103, v13, v95, -v103
 v_cvt_pk_bf16_f32 v108, v96, v97
 v_cvt_pk_bf16_f32 v109, v98, v99
 v_cvt_pk_bf16_f32 v110, v100, v101
 v_cvt_pk_bf16_f32 v111, v102, v103
 ds_write_b128 v14, v[108:111] offset:15360
 v_fma_f32 v88, v13, v96, -v88
 v_fma_f32 v89, v13, v97, -v89
 v_fma_f32 v90, v13, v98, -v90
 v_fma_f32 v91, v13, v99, -v91
 v_fma_f32 v92, v13, v100, -v92
 v_fma_f32 v93, v13, v101, -v93
 v_fma_f32 v94, v13, v102, -v94
 v_fma_f32 v95, v13, v103, -v95
 v_cvt_pk_bf16_f32 v104, v88, v89
 v_cvt_pk_bf16_f32 v105, v90, v91
 v_cvt_pk_bf16_f32 v106, v92, v93
 v_cvt_pk_bf16_f32 v107, v94, v95
 ds_write_b128 v14, v[104:107] offset:20480
 v_fma_f32 v96, v13, v88, -v96
 v_fma_f32 v97, v13, v89, -v97
 v_fma_f32 v98, v13, v90, -v98
 v_fma_f32 v99, v13, v91, -v99
 v_fma_f32 v100, v13, v92, -v100
 v_fma_f32 v101, v13, v93, -v101
 v_fma_f32 v102, v13, v94, -v102
 v_fma_f32 v103, v13, v95, -v103
 v_cvt_pk_bf16_f32 v108, v96, v97
 v_cvt_pk_bf16_f32 v109, v98, v99
 v_cvt_pk_bf16_f32 v110, v100, v101
 v_cvt_pk_bf16_f32 v111, v102, v103
 ds_write_b128 v14, v[108:111] offset:25600
 v_fma_f32 v88, v13, v96, -v88
 v_fma_f32 v89, v13, v97, -v89
 v_fma_f32 v90, v13, v98, -v90
 v_fma_f32 v91, v13, v99, -v91
 v_fma_f32 v92, v13, v100, -v92
 v_fma_f32 v93, v13, v101, -v93
 v_fma_f32 v94, v13, v102, -v94
 v_fma_f32 v95, v13, v103, -v95
 v_cvt_pk_bf16_f32 v104, v88, v89
 v_cvt_pk_bf16_f32 v105, v90, v91
 v_cvt_pk_bf16_f32 v106, v92, v93
 v_cvt_pk_bf16_f32 v107, v94, v95
 ds_write_b128 v14, v[104:107] offset:30720
 v_fma_f32 v96, v13, v88, -v96
 v_fma_f32 v97, v13, v89, -v97
 v_fma_f32 v98, v13, v90, -v98
 v_fma_f32 v99, v13, v91, -v99
 v_fma_f32 v100, v13, v92, -v100
 v_fma_f32 v101, v13, v93, -v101
 v_fma_f32 v102, v13, v94, -v102
 v_fma_f32 v103, v13, v95, -v103
 v_cvt_pk_bf16_f32 v108, v96, v97
 v_cvt_pk_bf16_f32 v109, v98, v99
 v_cvt_pk_bf16_f32 v110, v100, v101
 v_cvt_pk_bf16_f32 v111, v102, v103
 ds_write_b128 v14, v[108:111] offset:35840
 v_fma_f32 v88, v13, v96, -v88
 v_fma_f32 v89, v13, v97, -v89
 v_fma_f32 v90, v13, v98, -v90
 v_fma_f32 v91, v13, v99, -v91
 v_fma_f32 v92, v13, v100, -v92
 v_fma_f32 v93, v13, v101, -v93
 v_fma_f32 v94, v13, v102, -v94
 v_fma_f32 v95, v13, v103, -v95
 v_cvt_pk_bf16_f32 v104, v88, v89
 v_cvt_pk_bf16_f32 v105, v90, v91
 v_cvt_pk_bf16_f32 v106, v92, v93
 v_cvt_pk_bf16_f32 v107, v94, v95
 ds_write_b128 v14, v[104:107] offset:40960
 s_cmp_eq_u32 s21, 0
 s_cbranch_scc1 L_p1_trig_done
 s_mov_b32 s38, s27
 s_mov_b32 s33, s20
 s_lshr_b32 s3, s38, 1
 s_lshl_b32 s3, s3, 5
 s_and_b32 s39, s38, 1
 s_lshl2_add_u32 s3, s39, s3
 v_add_u32 v10, s3, v8
 v_lshrrev_b32 v11, 1, v10
 v_and_b32 v12, 1, v10
 v_cvt_f32_u32 v12, v12
 v_mul_f32 v12, 0x3e800000, v12
 v_cvt_f32_u32 v11, v11
 v_mul_f32 v11, 0x3ae38e39, v11
 v_cmp_eq_u32 vcc, 0, v10
 s_nop 1
 v_cndmask_b32 v11, v11, 0.5, vcc
 v_cmp_eq_u32 vcc, 1, v10
 s_nop 1
 v_cndmask_b32 v12, v12, 0, vcc
 v_cos_f32 v15, v11
 s_nop 0
 v_add_f32 v15, v15, v15
L_p1_tr:
 s_lshl_b32 s3, s33, 5
 v_cvt_f32_u32 v13, s3
 v_add_f32 v13, v13, v9
 v_fma_f32 v13, v13, v11, v12
 v_fract_f32 v13, v13
 v_add_f32 v89, v13, v11
 v_cos_f32 v88, v13
 v_cos_f32 v89, v89
 s_mul_i32 s3, s33, 5120
 v_add_u32 v14, s3, v4
 v_fma_f32 v90, v15, v89, -v88
 v_fma_f32 v91, v15, v90, -v89
 v_fma_f32 v92, v15, v91, -v90
 v_fma_f32 v93, v15, v92, -v91
 v_fma_f32 v94, v15, v93, -v92
 v_fma_f32 v95, v15, v94, -v93
 v_cvt_pk_bf16_f32 v96, v88, v89
 v_cvt_pk_bf16_f32 v97, v90, v91
 v_cvt_pk_bf16_f32 v98, v92, v93
 v_cvt_pk_bf16_f32 v99, v94, v95
 s_add_u32 s33, s33, 4
 s_cmp_lt_u32 s33, 9
 ds_write_b128 v14, v[96:99] offset:4096
 s_cbranch_scc1 L_p1_tr
L_p1_trig_done:
 v_lshrrev_b32 v8, 1, v2
 v_xor_b32 v8, v8, v3
 v_lshlrev_b32 v9, 7, v2
 s_mul_i32 s3, s20, 18432
 s_add_u32 s3, s3, 46080
 v_add_u32 v9, s3, v9
 v_lshl_add_u32 v10, v8, 4, v9
 v_xor_b32 v8, 4, v8
 v_lshl_add_u32 v11, v8, 4, v9
 s_waitcnt vmcnt(0) lgkmcnt(0)
 s_mov_b32 s8, s4
 s_mov_b32 s9, s5
 s_mov_b32 s10, 0x2000000
 s_mov_b32 s11, 0x20000
 v_mov_b32 v88, 0
 v_lshlrev_b32 v89, 2, v0
 s_and_b32 s3, s2, 3
 s_lshl_b32 s3, s3, 10
 s_add_u32 s3, s3, 0x18d0000
 s_cmp_ge_u32 s2, 4
 s_cbranch_scc1 L_k1_nocnt
 buffer_store_dword v88, v89, s[8:11], s3 offen
L_k1_nocnt:
 s_barrier
 ds_read_b128 v[16:19], v10 offset:0
 ds_read_b128 v[52:55], v11 offset:8192
 ds_read_b128 v[20:23], v11 offset:0
 ds_read_b128 v[56:59], v10 offset:10240
 ds_read_b128 v[24:27], v10 offset:2048
 ds_read_b128 v[60:63], v11 offset:10240
 ds_read_b128 v[28:31], v11 offset:2048
 ds_read_b128 v[64:67], v10 offset:12288
 ds_read_b128 v[32:35], v10 offset:4096
 ds_read_b128 v[68:71], v11 offset:12288
 ds_read_b128 v[36:39], v11 offset:4096
 ds_read_b128 v[72:75], v10 offset:14336
 ds_read_b128 v[40:43], v10 offset:6144
 ds_read_b128 v[76:79], v11 offset:14336
 ds_read_b128 v[44:47], v11 offset:6144
 ds_read_b128 v[80:83], v10 offset:16384
 ds_read_b128 v[48:51], v10 offset:8192
 ds_read_b128 v[84:87], v11 offset:16384
 s_cmp_eq_u32 s24, 0
 s_mov_b32 s36, 0x3d715bef
 s_cselect_b32 s3, 0x3d2aaaab, s36
 s_cselect_b32 s37, 0, s36
 v_mov_b32 v8, s36
 v_mov_b32 v9, s3
 v_mov_b32 v10, s37
 v_cmp_eq_u32 vcc, 0, v3
 s_nop 1
 v_cndmask_b32 v9, v8, v9, vcc
 v_cndmask_b32 v10, v8, v10, vcc
 s_mov_b32 s37, 0x0
 s_waitcnt lgkmcnt(0)
 s_barrier
 ds_read_b128 a[0:3], v4 offset:0
 ds_read_b128 a[4:7], v4 offset:1024
 ds_read_b128 a[8:11], v4 offset:2048
 ds_read_b128 a[12:15], v4 offset:3072
 ds_read_b128 a[16:19], v4 offset:4096
 s_waitcnt lgkmcnt(4)
 v_mfma_f32_16x16x32_bf16 v[88:91], a[0:3], v[16:19], 0
 v_mfma_f32_16x16x32_bf16 v[92:95], a[0:3], v[52:55], 0
 ds_read_b128 a[20:23], v4 offset:5120
 s_waitcnt lgkmcnt(4)
 v_mfma_f32_16x16x32_bf16 v[96:99], a[4:7], v[16:19], 0
 v_mfma_f32_16x16x32_bf16 v[100:103], a[4:7], v[52:55], 0
 ds_read_b128 a[24:27], v4 offset:6144
 s_waitcnt lgkmcnt(4)
 v_mfma_f32_16x16x32_bf16 v[104:107], a[8:11], v[16:19], 0
 v_mfma_f32_16x16x32_bf16 v[108:111], a[8:11], v[52:55], 0
 ds_read_b128 a[28:31], v4 offset:7168
 s_waitcnt lgkmcnt(4)
 v_mfma_f32_16x16x32_bf16 v[112:115], a[12:15], v[16:19], 0
 v_mfma_f32_16x16x32_bf16 v[116:119], a[12:15], v[52:55], 0
 ds_read_b128 a[32:35], v4 offset:8192
 s_waitcnt lgkmcnt(4)
 v_mfma_f32_16x16x32_bf16 v[120:123], a[16:19], v[16:19], 0
 v_mfma_f32_16x16x32_bf16 v[124:127], a[16:19], v[52:55], 0
 ds_read_b128 a[36:39], v4 offset:9216
 s_waitcnt lgkmcnt(4)
 v_mfma_f32_16x16x32_bf16 v[88:91], a[20:23], v[20:23], v[88:91]
 v_mfma_f32_16x16x32_bf16 v[92:95], a[20:23], v[56:59], v[92:95]
 ds_read_b128 a[0:3], v4 offset:10240
 s_waitcnt lgkmcnt(4)
 v_mfma_f32_16x16x32_bf16 v[96:99], a[24:27], v[20:23], v[96:99]
 v_mfma_f32_16x16x32_bf16 v[100:103], a[24:27], v[56:59], v[100:103]
 ds_read_b128 a[4:7], v4 offset:11264
 s_waitcnt lgkmcnt(4)
 v_mfma_f32_16x16x32_bf16 v[104:107], a[28:31], v[20:23], v[104:107]
 v_mfma_f32_16x16x32_bf16 v[108:111], a[28:31], v[56:59], v[108:111]
 ds_read_b128 a[8:11], v4 offset:12288
 s_waitcnt lgkmcnt(4)
 v_mfma_f32_16x16x32_bf16 v[112:115], a[32:35], v[20:23], v[112:115]
 v_mfma_f32_16x16x32_bf16 v[116:119], a[32:35], v[56:59], v[116:119]
 ds_read_b128 a[12:15], v4 offset:13312
 s_waitcnt lgkmcnt(4)
 v_mfma_f32_16x16x32_bf16 v[120:123], a[36:39], v[20:23], v[120:123]
 v_mfma_f32_16x16x32_bf16 v[124:127], a[36:39], v[56:59], v[124:127]
 ds_read_b128 a[16:19], v4 offset:14336
 s_waitcnt lgkmcnt(4)
 v_mfma_f32_16x16x32_bf16 v[88:91], a[0:3], v[24:27], v[88:91]
 v_mfma_f32_16x16x32_bf16 v[92:95], a[0:3], v[60:63], v[92:95]
 ds_read_b128 a[20:23], v4 offset:15360
 s_waitcnt lgkmcnt(4)
 v_mfma_f32_16x16x32_bf16 v[96:99], a[4:7], v[24:27], v[96:99]
 v_mfma_f32_16x16x32_bf16 v[100:103], a[4:7], v[60:63], v[100:103]
 ds_read_b128 a[24:27], v4 offset:16384
 s_waitcnt lgkmcnt(4)
 v_mfma_f32_16x16x32_bf16 v[104:107], a[8:11], v[24:27], v[104:107]
 v_mfma_f32_16x16x32_bf16 v[108:111], a[8:11], v[60:63], v[108:111]
 ds_read_b128 a[28:31], v4 offset:17408
 s_waitcnt lgkmcnt(4)
 v_mfma_f32_16x16x32_bf16 v[112:115], a[12:15], v[24:27], v[112:115]
 v_mfma_f32_16x16x32_bf16 v[116:119], a[12:15], v[60:63], v[116:119]
 ds_read_b128 a[32:35], v4 offset:18432
 s_waitcnt lgkmcnt(4)
 v_mfma_f32_16x16x32_bf16 v[120:123], a[16:19], v[24:27], v[120:123]
 v_mfma_f32_16x16x32_bf16 v[124:127], a[16:19], v[60:63], v[124:127]
 ds_read_b128 a[36:39], v4 offset:19456
 s_waitcnt lgkmcnt(4)
 v_mfma_f32_16x16x32_bf16 v[88:91], a[20:23], v[28:31], v[88:91]
 v_mfma_f32_16x16x32_bf16 v[92:95], a[20:23], v[64:67], v[92:95]
 ds_read_b128 a[0:3], v4 offset:20480
 s_waitcnt lgkmcnt(4)
 v_mfma_f32_16x16x32_bf16 v[96:99], a[24:27], v[28:31], v[96:99]
 v_mfma_f32_16x16x32_bf16 v[100:103], a[24:27], v[64:67], v[100:103]
 ds_read_b128 a[4:7], v4 offset:21504
 s_waitcnt lgkmcnt(4)
 v_mfma_f32_16x16x32_bf16 v[104:107], a[28:31], v[28:31], v[104:107]
 v_mfma_f32_16x16x32_bf16 v[108:111], a[28:31], v[64:67], v[108:111]
 ds_read_b128 a[8:11], v4 offset:22528
 s_waitcnt lgkmcnt(4)
 v_mfma_f32_16x16x32_bf16 v[112:115], a[32:35], v[28:31], v[112:115]
 v_mfma_f32_16x16x32_bf16 v[116:119], a[32:35], v[64:67], v[116:119]
 ds_read_b128 a[12:15], v4 offset:23552
 s_waitcnt lgkmcnt(4)
 v_mfma_f32_16x16x32_bf16 v[120:123], a[36:39], v[28:31], v[120:123]
 v_mfma_f32_16x16x32_bf16 v[124:127], a[36:39], v[64:67], v[124:127]
 ds_read_b128 a[16:19], v4 offset:24576
 s_waitcnt lgkmcnt(4)
 v_mfma_f32_16x16x32_bf16 v[88:91], a[0:3], v[32:35], v[88:91]
 v_mfma_f32_16x16x32_bf16 v[92:95], a[0:3], v[68:71], v[92:95]
 ds_read_b128 a[20:23], v4 offset:25600
 s_waitcnt lgkmcnt(4)
 v_mfma_f32_16x16x32_bf16 v[96:99], a[4:7], v[32:35], v[96:99]
 v_mfma_f32_16x16x32_bf16 v[100:103], a[4:7], v[68:71], v[100:103]
 ds_read_b128 a[24:27], v4 offset:26624
 s_waitcnt lgkmcnt(4)
 v_mfma_f32_16x16x32_bf16 v[104:107], a[8:11], v[32:35], v[104:107]
 v_mfma_f32_16x16x32_bf16 v[108:111], a[8:11], v[68:71], v[108:111]
 ds_read_b128 a[28:31], v4 offset:27648
 s_waitcnt lgkmcnt(4)
 v_mfma_f32_16x16x32_bf16 v[112:115], a[12:15], v[32:35], v[112:115]
 v_mfma_f32_16x16x32_bf16 v[116:119], a[12:15], v[68:71], v[116:119]
 ds_read_b128 a[32:35], v4 offset:28672
 s_waitcnt lgkmcnt(4)
 v_mfma_f32_16x16x32_bf16 v[120:123], a[16:19], v[32:35], v[120:123]
 v_mfma_f32_16x16x32_bf16 v[124:127], a[16:19], v[68:71], v[124:127]
 ds_read_b128 a[36:39], v4 offset:29696
 s_waitcnt lgkmcnt(4)
 v_mfma_f32_16x16x32_bf16 v[88:91], a[20:23], v[36:39], v[88:91]
 v_mfma_f32_16x16x32_bf16 v[92:95], a[20:23], v[72:75], v[92:95]
 ds_read_b128 a[0:3], v4 offset:30720
 s_waitcnt lgkmcnt(4)
 v_mfma_f32_16x16x32_bf16 v[96:99], a[24:27], v[36:39], v[96:99]
 v_mfma_f32_16x16x32_bf16 v[100:103], a[24:27], v[72:75], v[100:103]
 ds_read_b128 a[4:7], v4 offset:31744
 s_waitcnt lgkmcnt(4)
 v_mfma_f32_16x16x32_bf16 v[104:107], a[28:31], v[36:39], v[104:107]
 v_mfma_f32_16x16x32_bf16 v[108:111], a[28:31], v[72:75], v[108:111]
 ds_read_b128 a[8:11], v4 offset:32768
 s_waitcnt lgkmcnt(4)
 v_mfma_f32_16x16x32_bf16 v[112:115], a[32:35], v[36:39], v[112:115]
 v_mfma_f32_16x16x32_bf16 v[116:119], a[32:35], v[72:75], v[116:119]
 ds_read_b128 a[12:15], v4 offset:33792
 s_waitcnt lgkmcnt(4)
 v_mfma_f32_16x16x32_bf16 v[120:123], a[36:39], v[36:39], v[120:123]
 v_mfma_f32_16x16x32_bf16 v[124:127], a[36:39], v[72:75], v[124:127]
 ds_read_b128 a[16:19], v4 offset:34816
 s_waitcnt lgkmcnt(4)
 v_mfma_f32_16x16x32_bf16 v[88:91], a[0:3], v[40:43], v[88:91]
 v_mfma_f32_16x16x32_bf16 v[92:95], a[0:3], v[76:79], v[92:95]
 ds_read_b128 a[20:23], v4 offset:35840
 s_waitcnt lgkmcnt(4)
 v_mfma_f32_16x16x32_bf16 v[96:99], a[4:7], v[40:43], v[96:99]
 v_mfma_f32_16x16x32_bf16 v[100:103], a[4:7], v[76:79], v[100:103]
 ds_read_b128 a[24:27], v4 offset:36864
 s_waitcnt lgkmcnt(4)
 v_mfma_f32_16x16x32_bf16 v[104:107], a[8:11], v[40:43], v[104:107]
 v_mfma_f32_16x16x32_bf16 v[108:111], a[8:11], v[76:79], v[108:111]
 ds_read_b128 a[28:31], v4 offset:37888
 s_waitcnt lgkmcnt(4)
 v_mfma_f32_16x16x32_bf16 v[112:115], a[12:15], v[40:43], v[112:115]
 v_mfma_f32_16x16x32_bf16 v[116:119], a[12:15], v[76:79], v[116:119]
 ds_read_b128 a[32:35], v4 offset:38912
 s_waitcnt lgkmcnt(4)
 v_mfma_f32_16x16x32_bf16 v[120:123], a[16:19], v[40:43], v[120:123]
 v_mfma_f32_16x16x32_bf16 v[124:127], a[16:19], v[76:79], v[124:127]
 ds_read_b128 a[36:39], v4 offset:39936
 s_waitcnt lgkmcnt(4)
 v_mfma_f32_16x16x32_bf16 v[88:91], a[20:23], v[44:47], v[88:91]
 v_mfma_f32_16x16x32_bf16 v[92:95], a[20:23], v[80:83], v[92:95]
 ds_read_b128 a[0:3], v4 offset:40960
 s_waitcnt lgkmcnt(4)
 v_mfma_f32_16x16x32_bf16 v[96:99], a[24:27], v[44:47], v[96:99]
 v_mfma_f32_16x16x32_bf16 v[100:103], a[24:27], v[80:83], v[100:103]
 ds_read_b128 a[4:7], v4 offset:41984
 s_waitcnt lgkmcnt(4)
 v_mfma_f32_16x16x32_bf16 v[104:107], a[28:31], v[44:47], v[104:107]
 v_mfma_f32_16x16x32_bf16 v[108:111], a[28:31], v[80:83], v[108:111]
 ds_read_b128 a[8:11], v4 offset:43008
 s_waitcnt lgkmcnt(4)
 v_mfma_f32_16x16x32_bf16 v[112:115], a[32:35], v[44:47], v[112:115]
 v_mfma_f32_16x16x32_bf16 v[116:119], a[32:35], v[80:83], v[116:119]
 ds_read_b128 a[12:15], v4 offset:44032
 s_waitcnt lgkmcnt(4)
 v_mfma_f32_16x16x32_bf16 v[120:123], a[36:39], v[44:47], v[120:123]
 v_mfma_f32_16x16x32_bf16 v[124:127], a[36:39], v[80:83], v[124:127]
 ds_read_b128 a[16:19], v4 offset:45056
 s_waitcnt lgkmcnt(4)
 v_mfma_f32_16x16x32_bf16 v[88:91], a[0:3], v[48:51], v[88:91]
 v_mfma_f32_16x16x32_bf16 v[92:95], a[0:3], v[84:87], v[92:95]
 s_waitcnt lgkmcnt(3)
 v_mfma_f32_16x16x32_bf16 v[96:99], a[4:7], v[48:51], v[96:99]
 v_mfma_f32_16x16x32_bf16 v[100:103], a[4:7], v[84:87], v[100:103]
 s_waitcnt lgkmcnt(2)
 v_mfma_f32_16x16x32_bf16 v[104:107], a[8:11], v[48:51], v[104:107]
 v_mfma_f32_16x16x32_bf16 v[108:111], a[8:11], v[84:87], v[108:111]
 s_waitcnt lgkmcnt(1)
 v_mfma_f32_16x16x32_bf16 v[112:115], a[12:15], v[48:51], v[112:115]
 v_mfma_f32_16x16x32_bf16 v[116:119], a[12:15], v[84:87], v[116:119]
 s_waitcnt lgkmcnt(0)
 v_mfma_f32_16x16x32_bf16 v[120:123], a[16:19], v[48:51], v[120:123]
 v_mfma_f32_16x16x32_bf16 v[124:127], a[16:19], v[84:87], v[124:127]
 v_add_f32 v88, v88, v92
 v_add_f32 v89, v89, v93
 v_sub_f32 v90, v90, v94
 v_sub_f32 v91, v91, v95
 v_mul_f32 v88, v9, v88
 v_mul_f32 v89, v9, v89
 v_mul_f32 v90, s36, v90
 v_mul_f32 v91, s36, v91
 v_cvt_pk_bf16_f32 v92, v88, v89
 v_cvt_pk_bf16_f32 v93, v90, v91
 v_add_f32 v96, v96, v100
 v_add_f32 v97, v97, v101
 v_sub_f32 v98, v98, v102
 v_sub_f32 v99, v99, v103
 v_mul_f32 v96, s36, v96
 v_mul_f32 v97, s36, v97
 v_mul_f32 v98, s36, v98
 v_mul_f32 v99, s36, v99
 v_cvt_pk_bf16_f32 v100, v96, v97
 v_cvt_pk_bf16_f32 v101, v98, v99
 v_add_f32 v104, v104, v108
 v_add_f32 v105, v105, v109
 v_sub_f32 v106, v106, v110
 v_sub_f32 v107, v107, v111
 v_mul_f32 v104, s36, v104
 v_mul_f32 v105, s36, v105
 v_mul_f32 v106, s36, v106
 v_mul_f32 v107, s36, v107
 v_cvt_pk_bf16_f32 v108, v104, v105
 v_cvt_pk_bf16_f32 v109, v106, v107
 v_add_f32 v112, v112, v116
 v_add_f32 v113, v113, v117
 v_sub_f32 v114, v114, v118
 v_sub_f32 v115, v115, v119
 v_mul_f32 v112, s36, v112
 v_mul_f32 v113, s36, v113
 v_mul_f32 v114, s36, v114
 v_mul_f32 v115, s36, v115
 v_cvt_pk_bf16_f32 v116, v112, v113
 v_cvt_pk_bf16_f32 v117, v114, v115
 v_add_f32 v120, v120, v124
 v_add_f32 v121, v121, v125
 v_sub_f32 v122, v122, v126
 v_sub_f32 v123, v123, v127
 v_mul_f32 v120, s36, v120
 v_mul_f32 v121, s36, v121
 v_mul_f32 v122, s36, v122
 v_mul_f32 v123, s36, v123
 v_cvt_pk_bf16_f32 v124, v120, v121
 v_cvt_pk_bf16_f32 v125, v122, v123
 v_cmp_eq_f32 vcc, 0, v10
 s_nop 1
 v_cndmask_b32 v13, 1.0, 0, vcc
 v_mul_f32 v8, v88, v88
 v_mul_f32 v12, v89, v13
 v_fmac_f32 v8, v12, v12
 v_fmac_f32 v8, v90, v90
 v_fmac_f32 v8, v91, v91
 v_fmac_f32 v8, v96, v96
 v_fmac_f32 v8, v97, v97
 v_fmac_f32 v8, v98, v98
 v_fmac_f32 v8, v99, v99
 v_fmac_f32 v8, v104, v104
 v_fmac_f32 v8, v105, v105
 v_fmac_f32 v8, v106, v106
 v_fmac_f32 v8, v107, v107
 v_fmac_f32 v8, v112, v112
 v_fmac_f32 v8, v113, v113
 v_fmac_f32 v8, v114, v114
 v_fmac_f32 v8, v115, v115
 s_cmp_eq_u32 s21, 0
 s_cbranch_scc1 L_p1_ss4
 v_fmac_f32 v8, v120, v120
 v_fmac_f32 v8, v121, v121
 v_fmac_f32 v8, v122, v122
 v_fmac_f32 v8, v123, v123
L_p1_ss4:
 v_mov_b32 v11, 1.0
 s_and_b32 s38, s20, 1
 s_lshl_b32 s3, s20, 10
 s_add_u32 s3, s3, 108544
 v_mfma_f32_16x16x4_f32 v[128:131], v11, v8, 0
 v_lshl_add_u32 v5, v1, 3, s3
 v_xor_b32 v6, 0x400, v5
 s_cmp_eq_u32 s38, 0
 s_cselect_b64 vcc, -1, 0
 v_cndmask_b32 v132, v92, v108, vcc
 v_cndmask_b32 v92, v108, v92, vcc
 v_cndmask_b32 v133, v93, v109, vcc
 v_cndmask_b32 v93, v109, v93, vcc
 ds_write_b64 v5, v[132:133] offset:0
 v_cndmask_b32 v134, v100, v116, vcc
 v_cndmask_b32 v100, v116, v100, vcc
 v_cndmask_b32 v135, v101, v117, vcc
 v_cndmask_b32 v101, v117, v101, vcc
 ds_write_b64 v5, v[134:135] offset:512
 ds_write_b32 v5, v128 offset:4096
 ds_write_b64 v5, v[124:125] offset:4608
 s_lshr_b32 s3, s25, 1
 s_lshl_b32 s3, s3, 8
 s_add_u32 s39, s3, s37
 v_mul_u32_u24 v7, 33280, v3
 v_lshl_add_u32 v7, v2, 4, v7
 s_lshr_b32 s3, s27, 1
 s_lshl_b32 s3, s3, 3
 s_and_b32 s35, s27, 1
 s_add_u32 s3, s3, s35
 s_mul_i32 s3, s3, 16640
 s_add_u32 s34, s3, s39
 s_lshl_b32 s3, s24, 1
 s_add_u32 s3, s3, s38
 s_mul_i32 s3, s3, 133120
 s_add_u32 s39, s39, s3
 s_add_u32 s35, s39, 16640
 s_lshr_b32 s36, s25, 3
 s_lshl_b32 s36, s36, 1
 s_lshr_b32 s3, s24, 2
 s_add_u32 s36, s36, s3
 s_lshl_b32 s36, s36, 10
 s_bfe_u32 s3, s25, 0x20001
 s_lshl_b32 s3, s3, 8
 s_add_u32 s36, s36, s3
 s_and_b32 s3, s24, 3
 s_lshl2_add_u32 s36, s3, s36
 s_add_u32 s36, s36, 0x18c0000
 s_waitcnt lgkmcnt(0)
 s_barrier
 ds_read_b64 v[132:133], v6
 ds_read_b64 v[134:135], v6 offset:512
 ds_read_b32 v129, v6 offset:4096
 ds_read_b64 v[144:145], v6 offset:4608
 v_mov_b32 v146, v124
 v_mov_b32 v147, v125
 s_waitcnt lgkmcnt(3)
 v_cndmask_b32 v136, v132, v92, vcc
 v_cndmask_b32 v138, v92, v132, vcc
 v_cndmask_b32 v137, v133, v93, vcc
 v_cndmask_b32 v139, v93, v133, vcc
 buffer_store_dwordx4 v[136:139], v7, s[8:11], s39 offen
 s_waitcnt lgkmcnt(2)
 v_cndmask_b32 v140, v134, v100, vcc
 v_cndmask_b32 v142, v100, v134, vcc
 v_cndmask_b32 v141, v135, v101, vcc
 v_cndmask_b32 v143, v101, v135, vcc
 buffer_store_dwordx4 v[140:143], v7, s[8:11], s35 offen
 s_waitcnt lgkmcnt(1)
 v_cvt_pk_bf16_f32 v128, v128, v129
 s_and_b64 exec, vcc, 0xffff
 s_cbranch_execz L_p1_noss
 buffer_store_dword v128, v4, s[8:11], s36 offen
L_p1_noss:
 s_mov_b64 exec, -1
 s_and_b32 s3, s38, s21
 s_cbranch_scc0 L_p1_nx5
 s_waitcnt lgkmcnt(0)
 buffer_store_dwordx4 v[144:147], v7, s[8:11], s34 offen
L_p1_nx5:
 s_mov_b32 s36, 0x3d715bef
 s_barrier
 s_cmp_eq_u32 s46, 1
 s_cbranch_scc1 L_k1_t1
 s_cmp_eq_u32 s46, 2
 s_cbranch_scc1 L_k1_end
 v_lshrrev_b32 v11, 2, v2
 v_and_b32 v12, 2, v11
 v_and_b32 v13, 1, v3
 v_lshl_or_b32 v12, v13, 2, v12
 s_lshl_b32 s3, s20, 1
 v_xor_b32 v12, s3, v12
 v_lshlrev_b32 v12, 4, v12
 v_lshl_add_u32 v12, v11, 7, v12
 v_and_b32 v13, 3, v2
 v_lshl_add_u32 v12, v13, 3, v12
 v_lshl_add_u32 v12, v3, 10, v12
 v_add_u32 v11, 119808, v12
 v_add_u32 v12, 46080, v12
 ds_read_b64_tr_b16 v[16:17], v11 offset:0
 ds_read_b64_tr_b16 v[18:19], v11 offset:512
 ds_read_b64_tr_b16 v[52:53], v11 offset:36864
 ds_read_b64_tr_b16 v[54:55], v11 offset:37376
 ds_read_b128 a[0:3], v4 offset:0
 ds_read_b128 a[4:7], v4 offset:1024
 ds_read_b128 a[8:11], v4 offset:2048
 ds_read_b128 a[12:15], v4 offset:3072
 ds_read_b128 a[16:19], v4 offset:4096
 s_waitcnt lgkmcnt(4)
 v_mfma_f32_16x16x32_bf16 v[88:91], a[0:3], v[16:19], 0
 ds_read_b64_tr_b16 v[20:21], v11 offset:4096
 v_mfma_f32_16x16x32_bf16 v[92:95], a[0:3], v[52:55], 0
 ds_read_b64_tr_b16 v[22:23], v11 offset:4608
 s_waitcnt lgkmcnt(5)
 v_mfma_f32_16x16x32_bf16 v[96:99], a[4:7], v[16:19], 0
 ds_read_b64_tr_b16 v[56:57], v12 offset:0
 v_mfma_f32_16x16x32_bf16 v[100:103], a[4:7], v[52:55], 0
 ds_read_b64_tr_b16 v[58:59], v12 offset:512
 ds_read_b128 a[20:23], v4 offset:5120
 s_waitcnt lgkmcnt(7)
 v_mfma_f32_16x16x32_bf16 v[104:107], a[8:11], v[16:19], 0
 ds_read_b128 a[24:27], v4 offset:6144
 v_mfma_f32_16x16x32_bf16 v[108:111], a[8:11], v[52:55], 0
 ds_read_b128 a[28:31], v4 offset:7168
 s_waitcnt lgkmcnt(8)
 v_mfma_f32_16x16x32_bf16 v[112:115], a[12:15], v[16:19], 0
 ds_read_b128 a[32:35], v4 offset:8192
 ds_read_b128 a[36:39], v4 offset:9216
 v_mfma_f32_16x16x32_bf16 v[116:119], a[12:15], v[52:55], 0
 s_lshl2_add_u32 s3, s47, s20
 s_waitcnt lgkmcnt(9)
 v_mfma_f32_16x16x32_bf16 v[120:123], a[16:19], v[16:19], 0
 s_lshl_b32 s3, s3, 4
 v_mfma_f32_16x16x32_bf16 v[124:127], a[16:19], v[52:55], 0
 v_add_u32 v5, s3, v2
 s_mov_b32 s3, 0xe38e38f
 s_waitcnt lgkmcnt(4)
 v_mfma_f32_16x16x32_bf16 v[88:91], a[20:23], v[20:23], v[88:91]
 ds_read_b64_tr_b16 v[24:25], v11 offset:8192
 v_mfma_f32_16x16x32_bf16 v[92:95], a[20:23], v[56:59], v[92:95]
 ds_read_b64_tr_b16 v[26:27], v11 offset:8704
 s_waitcnt lgkmcnt(5)
 v_mfma_f32_16x16x32_bf16 v[96:99], a[24:27], v[20:23], v[96:99]
 ds_read_b64_tr_b16 v[60:61], v12 offset:4096
 ds_read_b64_tr_b16 v[62:63], v12 offset:4608
 v_mfma_f32_16x16x32_bf16 v[100:103], a[24:27], v[56:59], v[100:103]
 ds_read_b128 a[0:3], v4 offset:10240
 s_waitcnt lgkmcnt(7)
 v_mfma_f32_16x16x32_bf16 v[104:107], a[28:31], v[20:23], v[104:107]
 ds_read_b128 a[4:7], v4 offset:11264
 ds_read_b128 a[8:11], v4 offset:12288
 v_mfma_f32_16x16x32_bf16 v[108:111], a[28:31], v[56:59], v[108:111]
 ds_read_b128 a[12:15], v4 offset:13312
 s_waitcnt lgkmcnt(9)
 v_mfma_f32_16x16x32_bf16 v[112:115], a[32:35], v[20:23], v[112:115]
 ds_read_b128 a[16:19], v4 offset:14336
 v_mfma_f32_16x16x32_bf16 v[116:119], a[32:35], v[56:59], v[116:119]
 v_mul_hi_u32 v6, v5, s3
 v_mul_u32_u24 v7, 18, v6
 s_waitcnt lgkmcnt(9)
 v_mfma_f32_16x16x32_bf16 v[120:123], a[36:39], v[20:23], v[120:123]
 v_sub_u32 v7, v5, v7
 v_mfma_f32_16x16x32_bf16 v[124:127], a[36:39], v[56:59], v[124:127]
 v_lshrrev_b32 v5, 5, v6
 v_and_b32 v8, 1, v6
 s_waitcnt lgkmcnt(4)
 v_mfma_f32_16x16x32_bf16 v[88:91], a[0:3], v[24:27], v[88:91]
 ds_read_b64_tr_b16 v[28:29], v11 offset:12288
 v_mfma_f32_16x16x32_bf16 v[92:95], a[0:3], v[60:63], v[92:95]
 ds_read_b64_tr_b16 v[30:31], v11 offset:12800
 s_waitcnt lgkmcnt(5)
 v_mfma_f32_16x16x32_bf16 v[96:99], a[4:7], v[24:27], v[96:99]
 ds_read_b64_tr_b16 v[64:65], v12 offset:8192
 ds_read_b64_tr_b16 v[66:67], v12 offset:8704
 v_mfma_f32_16x16x32_bf16 v[100:103], a[4:7], v[60:63], v[100:103]
 ds_read_b128 a[20:23], v4 offset:15360
 s_waitcnt lgkmcnt(7)
 v_mfma_f32_16x16x32_bf16 v[104:107], a[8:11], v[24:27], v[104:107]
 ds_read_b128 a[24:27], v4 offset:16384
 ds_read_b128 a[28:31], v4 offset:17408
 v_mfma_f32_16x16x32_bf16 v[108:111], a[8:11], v[60:63], v[108:111]
 ds_read_b128 a[32:35], v4 offset:18432
 s_waitcnt lgkmcnt(9)
 v_mfma_f32_16x16x32_bf16 v[112:115], a[12:15], v[24:27], v[112:115]
 ds_read_b128 a[36:39], v4 offset:19456
 v_mfma_f32_16x16x32_bf16 v[116:119], a[12:15], v[60:63], v[116:119]
 v_bfe_u32 v13, v6, 1, 4
 v_mul_u32_u24 v13, 8064, v13
 s_waitcnt lgkmcnt(9)
 v_mfma_f32_16x16x32_bf16 v[120:123], a[16:19], v[24:27], v[120:123]
 v_lshlrev_b32 v14, 1, v5
 v_mfma_f32_16x16x32_bf16 v[124:127], a[16:19], v[60:63], v[124:127]
 v_add_u32 v14, -2, v14
 v_cmp_eq_u32 vcc, 0, v5
 s_waitcnt lgkmcnt(4)
 v_mfma_f32_16x16x32_bf16 v[88:91], a[20:23], v[28:31], v[88:91]
 ds_read_b64_tr_b16 v[32:33], v11 offset:16384
 v_mfma_f32_16x16x32_bf16 v[92:95], a[20:23], v[64:67], v[92:95]
 ds_read_b64_tr_b16 v[34:35], v11 offset:16896
 s_waitcnt lgkmcnt(5)
 v_mfma_f32_16x16x32_bf16 v[96:99], a[24:27], v[28:31], v[96:99]
 ds_read_b64_tr_b16 v[68:69], v12 offset:12288
 ds_read_b64_tr_b16 v[70:71], v12 offset:12800
 v_mfma_f32_16x16x32_bf16 v[100:103], a[24:27], v[64:67], v[100:103]
 ds_read_b128 a[0:3], v4 offset:20480
 s_waitcnt lgkmcnt(7)
 v_mfma_f32_16x16x32_bf16 v[104:107], a[28:31], v[28:31], v[104:107]
 ds_read_b128 a[4:7], v4 offset:21504
 ds_read_b128 a[8:11], v4 offset:22528
 v_mfma_f32_16x16x32_bf16 v[108:111], a[28:31], v[64:67], v[108:111]
 ds_read_b128 a[12:15], v4 offset:23552
 s_waitcnt lgkmcnt(9)
 v_mfma_f32_16x16x32_bf16 v[112:115], a[32:35], v[28:31], v[112:115]
 ds_read_b128 a[16:19], v4 offset:24576
 v_mfma_f32_16x16x32_bf16 v[116:119], a[32:35], v[64:67], v[116:119]
 v_mov_b32 v15, 0x5a
 v_cndmask_b32 v14, v14, v15, vcc
 s_waitcnt lgkmcnt(9)
 v_mfma_f32_16x16x32_bf16 v[120:123], a[36:39], v[28:31], v[120:123]
 v_add_u32 v14, v14, v8
 v_mfma_f32_16x16x32_bf16 v[124:127], a[36:39], v[64:67], v[124:127]
 v_lshl_add_u32 v14, v14, 6, v7
 v_mov_b32 v15, 4
 s_waitcnt lgkmcnt(4)
 v_mfma_f32_16x16x32_bf16 v[88:91], a[0:3], v[32:35], v[88:91]
 ds_read_b64_tr_b16 v[36:37], v11 offset:20480
 v_mfma_f32_16x16x32_bf16 v[92:95], a[0:3], v[68:71], v[92:95]
 ds_read_b64_tr_b16 v[38:39], v11 offset:20992
 s_waitcnt lgkmcnt(5)
 v_mfma_f32_16x16x32_bf16 v[96:99], a[4:7], v[32:35], v[96:99]
 ds_read_b64_tr_b16 v[72:73], v12 offset:16384
 v_mfma_f32_16x16x32_bf16 v[100:103], a[4:7], v[68:71], v[100:103]
 ds_read_b64_tr_b16 v[74:75], v12 offset:16896
 ds_read_b128 a[20:23], v4 offset:25600
 s_waitcnt lgkmcnt(7)
 v_mfma_f32_16x16x32_bf16 v[104:107], a[8:11], v[32:35], v[104:107]
 ds_read_b128 a[24:27], v4 offset:26624
 v_mfma_f32_16x16x32_bf16 v[108:111], a[8:11], v[68:71], v[108:111]
 ds_read_b128 a[28:31], v4 offset:27648
 s_waitcnt lgkmcnt(8)
 v_mfma_f32_16x16x32_bf16 v[112:115], a[12:15], v[32:35], v[112:115]
 ds_read_b128 a[32:35], v4 offset:28672
 ds_read_b128 a[36:39], v4 offset:29696
 v_mfma_f32_16x16x32_bf16 v[116:119], a[12:15], v[68:71], v[116:119]
 v_cndmask_b32 v15, v15, 2, vcc
 s_waitcnt lgkmcnt(9)
 v_mfma_f32_16x16x32_bf16 v[120:123], a[16:19], v[32:35], v[120:123]
 v_add_u32 v6, -16, v7
 v_mfma_f32_16x16x32_bf16 v[124:127], a[16:19], v[68:71], v[124:127]
 v_lshl_add_u32 v128, v8, 2, v6
 v_and_b32 v5, 1, v5
 s_waitcnt lgkmcnt(4)
 v_mfma_f32_16x16x32_bf16 v[88:91], a[20:23], v[36:39], v[88:91]
 ds_read_b64_tr_b16 v[40:41], v11 offset:24576
 v_mfma_f32_16x16x32_bf16 v[92:95], a[20:23], v[72:75], v[92:95]
 ds_read_b64_tr_b16 v[42:43], v11 offset:25088
 s_waitcnt lgkmcnt(5)
 v_mfma_f32_16x16x32_bf16 v[96:99], a[24:27], v[36:39], v[96:99]
 ds_read_b64_tr_b16 v[76:77], v12 offset:20480
 ds_read_b64_tr_b16 v[78:79], v12 offset:20992
 v_mfma_f32_16x16x32_bf16 v[100:103], a[24:27], v[72:75], v[100:103]
 ds_read_b128 a[0:3], v4 offset:30720
 s_waitcnt lgkmcnt(7)
 v_mfma_f32_16x16x32_bf16 v[104:107], a[28:31], v[36:39], v[104:107]
 ds_read_b128 a[4:7], v4 offset:31744
 ds_read_b128 a[8:11], v4 offset:32768
 v_mfma_f32_16x16x32_bf16 v[108:111], a[28:31], v[72:75], v[108:111]
 ds_read_b128 a[12:15], v4 offset:33792
 s_waitcnt lgkmcnt(9)
 v_mfma_f32_16x16x32_bf16 v[112:115], a[32:35], v[36:39], v[112:115]
 ds_read_b128 a[16:19], v4 offset:34816
 v_mfma_f32_16x16x32_bf16 v[116:119], a[32:35], v[72:75], v[116:119]
 v_lshl_add_u32 v128, v5, 3, v128
 v_add_u32 v5, 10, v128
 s_waitcnt lgkmcnt(9)
 v_mfma_f32_16x16x32_bf16 v[120:123], a[36:39], v[36:39], v[120:123]
 v_cndmask_b32 v128, v128, v5, vcc
 v_mfma_f32_16x16x32_bf16 v[124:127], a[36:39], v[72:75], v[124:127]
 v_add_u32 v128, 0x1200, v128
 v_cmp_lt_u32 vcc, 15, v7
 s_waitcnt lgkmcnt(4)
 v_mfma_f32_16x16x32_bf16 v[88:91], a[0:3], v[40:43], v[88:91]
 ds_read_b64_tr_b16 v[44:45], v11 offset:28672
 v_mfma_f32_16x16x32_bf16 v[92:95], a[0:3], v[76:79], v[92:95]
 ds_read_b64_tr_b16 v[46:47], v11 offset:29184
 s_waitcnt lgkmcnt(5)
 v_mfma_f32_16x16x32_bf16 v[96:99], a[4:7], v[40:43], v[96:99]
 ds_read_b64_tr_b16 v[80:81], v12 offset:24576
 ds_read_b64_tr_b16 v[82:83], v12 offset:25088
 v_mfma_f32_16x16x32_bf16 v[100:103], a[4:7], v[76:79], v[100:103]
 ds_read_b128 a[20:23], v4 offset:35840
 s_waitcnt lgkmcnt(7)
 v_mfma_f32_16x16x32_bf16 v[104:107], a[8:11], v[40:43], v[104:107]
 ds_read_b128 a[24:27], v4 offset:36864
 ds_read_b128 a[28:31], v4 offset:37888
 v_mfma_f32_16x16x32_bf16 v[108:111], a[8:11], v[76:79], v[108:111]
 ds_read_b128 a[32:35], v4 offset:38912
 s_waitcnt lgkmcnt(9)
 v_mfma_f32_16x16x32_bf16 v[112:115], a[12:15], v[40:43], v[112:115]
 ds_read_b128 a[36:39], v4 offset:39936
 v_mfma_f32_16x16x32_bf16 v[116:119], a[12:15], v[76:79], v[116:119]
 v_cndmask_b32 v14, v14, v128, vcc
 v_cndmask_b32 v15, v15, 1, vcc
 s_waitcnt lgkmcnt(9)
 v_mfma_f32_16x16x32_bf16 v[120:123], a[16:19], v[40:43], v[120:123]
 v_add_u32 v14, v14, v13
 v_mfma_f32_16x16x32_bf16 v[124:127], a[16:19], v[76:79], v[124:127]
 v_lshl_add_u32 v14, v3, 4, v14
 v_lshlrev_b32 v14, 4, v14
 s_waitcnt lgkmcnt(4)
 v_mfma_f32_16x16x32_bf16 v[88:91], a[20:23], v[44:47], v[88:91]
 ds_read_b64_tr_b16 v[48:49], v11 offset:32768
 v_mfma_f32_16x16x32_bf16 v[92:95], a[20:23], v[80:83], v[92:95]
 ds_read_b64_tr_b16 v[50:51], v11 offset:33280
 s_waitcnt lgkmcnt(5)
 v_mfma_f32_16x16x32_bf16 v[96:99], a[24:27], v[44:47], v[96:99]
 ds_read_b64_tr_b16 v[84:85], v12 offset:28672
 ds_read_b64_tr_b16 v[86:87], v12 offset:29184
 v_mfma_f32_16x16x32_bf16 v[100:103], a[24:27], v[80:83], v[100:103]
 ds_read_b128 a[0:3], v4 offset:40960
 s_waitcnt lgkmcnt(7)
 v_mfma_f32_16x16x32_bf16 v[104:107], a[28:31], v[44:47], v[104:107]
 ds_read_b128 a[4:7], v4 offset:41984
 ds_read_b128 a[8:11], v4 offset:43008
 v_mfma_f32_16x16x32_bf16 v[108:111], a[28:31], v[80:83], v[108:111]
 ds_read_b128 a[12:15], v4 offset:44032
 s_waitcnt lgkmcnt(9)
 v_mfma_f32_16x16x32_bf16 v[112:115], a[32:35], v[44:47], v[112:115]
 ds_read_b128 a[16:19], v4 offset:45056
 v_mfma_f32_16x16x32_bf16 v[116:119], a[32:35], v[80:83], v[116:119]
 v_lshlrev_b32 v15, 10, v15
 s_lshl_b32 s39, s24, 1
 s_waitcnt lgkmcnt(9)
 v_mfma_f32_16x16x32_bf16 v[120:123], a[36:39], v[44:47], v[120:123]
 v_mad_u32_u24 v5, v15, s39, v14
 v_mfma_f32_16x16x32_bf16 v[124:127], a[36:39], v[80:83], v[124:127]
 v_add_u32 v6, v5, v15
 s_lshr_b32 s39, s27, 1
 s_waitcnt lgkmcnt(4)
 v_mfma_f32_16x16x32_bf16 v[88:91], a[0:3], v[48:51], v[88:91]
 v_mfma_f32_16x16x32_bf16 v[92:95], a[0:3], v[84:87], v[92:95]
 v_mad_u32_u24 v7, v15, s39, v14
 s_waitcnt lgkmcnt(3)
 v_mfma_f32_16x16x32_bf16 v[96:99], a[4:7], v[48:51], v[96:99]
 v_mfma_f32_16x16x32_bf16 v[100:103], a[4:7], v[84:87], v[100:103]
 s_and_b32 s3, s27, 1
 s_waitcnt lgkmcnt(2)
 v_mfma_f32_16x16x32_bf16 v[104:107], a[8:11], v[48:51], v[104:107]
 v_mfma_f32_16x16x32_bf16 v[108:111], a[8:11], v[84:87], v[108:111]
 s_lshl_b32 s3, s3, 3
 s_waitcnt lgkmcnt(1)
 v_mfma_f32_16x16x32_bf16 v[112:115], a[12:15], v[48:51], v[112:115]
 v_mfma_f32_16x16x32_bf16 v[116:119], a[12:15], v[84:87], v[116:119]
 s_mov_b32 s38, 0x250000
 s_waitcnt lgkmcnt(0)
 v_mfma_f32_16x16x32_bf16 v[120:123], a[16:19], v[48:51], v[120:123]
 v_mfma_f32_16x16x32_bf16 v[124:127], a[16:19], v[84:87], v[124:127]
 s_add_u32 s39, s3, s38
 v_add_f32 v88, v88, v92
 v_add_f32 v89, v89, v93
 v_sub_f32 v90, v90, v94
 v_sub_f32 v91, v91, v95
 v_mul_f32 v88, v9, v88
 v_mul_f32 v89, v10, v89
 v_mul_f32 v90, s36, v90
 v_mul_f32 v91, s36, v91
 v_cvt_pk_bf16_f32 v92, v88, v89
 v_cvt_pk_bf16_f32 v93, v90, v91
 v_add_f32 v96, v96, v100
 v_add_f32 v97, v97, v101
 v_sub_f32 v98, v98, v102
 v_sub_f32 v99, v99, v103
 v_mul_f32 v96, s36, v96
 v_mul_f32 v97, s36, v97
 v_mul_f32 v98, s36, v98
 v_mul_f32 v99, s36, v99
 v_cvt_pk_bf16_f32 v94, v96, v97
 v_cvt_pk_bf16_f32 v95, v98, v99
 buffer_store_dwordx4 v[92:95], v5, s[8:11], s38 offen
 v_add_f32 v104, v104, v108
 v_add_f32 v105, v105, v109
 v_sub_f32 v106, v106, v110
 v_sub_f32 v107, v107, v111
 v_mul_f32 v104, s36, v104
 v_mul_f32 v105, s36, v105
 v_mul_f32 v106, s36, v106
 v_mul_f32 v107, s36, v107
 v_cvt_pk_bf16_f32 v108, v104, v105
 v_cvt_pk_bf16_f32 v109, v106, v107
 v_add_f32 v112, v112, v116
 v_add_f32 v113, v113, v117
 v_sub_f32 v114, v114, v118
 v_sub_f32 v115, v115, v119
 v_mul_f32 v112, s36, v112
 v_mul_f32 v113, s36, v113
 v_mul_f32 v114, s36, v114
 v_mul_f32 v115, s36, v115
 v_cvt_pk_bf16_f32 v110, v112, v113
 v_cvt_pk_bf16_f32 v111, v114, v115
 buffer_store_dwordx4 v[108:111], v6, s[8:11], s38 offen
 s_cmp_eq_u32 s21, 0
 s_cbranch_scc1 L_j3_no5
 v_add_f32 v120, v120, v124
 v_add_f32 v121, v121, v125
 v_sub_f32 v122, v122, v126
 v_sub_f32 v123, v123, v127
 v_mul_f32 v120, s36, v120
 v_mul_f32 v121, s36, v121
 v_mul_f32 v122, s36, v122
 v_mul_f32 v123, s36, v123
 v_cvt_pk_bf16_f32 v124, v120, v121
 v_cvt_pk_bf16_f32 v125, v122, v123
 buffer_store_dwordx2 v[124:125], v7, s[8:11], s39 offen
L_j3_no5:
 s_branch L_k1_end
L_k1_t1:
 v_mul_u32_u24 v11, 576, v2
 s_lshl_b32 s3, s20, 2
 v_add_u32 v13, s3, v3
 v_lshl_add_u32 v11, v13, 3, v11
 v_lshl_add_u32 v13, v13, 2, 1
 v_add_u32 v12, 46080, v11
 v_add_u32 v11, 119808, v11
 v_lshlrev_b32 v13, 13, v13
 v_lshl_add_u32 v13, v2, 4, v13
 s_and_b32 s3, s47, 3
 s_lshl_b32 s38, s3, 11
 s_lshr_b32 s3, s47, 2
 s_lshl_b32 s3, s3, 8
 s_add_u32 s38, s38, s3
 s_add_u32 s38, s38, 0x4a0000
 s_mov_b32 s39, s38
 v_lshlrev_b32 v14, 4, v2
 v_add_u32 v15, 2121728, v13
 s_cmp_eq_u32 s20, 1
 s_cselect_b32 s3, 3, 7
 v_cmp_eq_u32 vcc, s3, v3
 s_nop 1
 v_cndmask_b32 v14, v15, v14, vcc
 s_mov_b32 s40, 0x05040100
 s_mov_b32 s41, 0x07060302
 ds_read_b64 v[16:17], v11 offset:0
 ds_read_b64 v[18:19], v12 offset:0
 ds_read_b64 v[20:21], v11 offset:9216
 ds_read_b64 v[22:23], v12 offset:9216
 ds_read_b64 v[24:25], v11 offset:18432
 ds_read_b64 v[26:27], v12 offset:18432
 ds_read_b64 v[28:29], v11 offset:27648
 ds_read_b64 v[30:31], v12 offset:27648
 ds_read_b64 v[32:33], v11 offset:128
 ds_read_b64 v[34:35], v12 offset:128
 ds_read_b64 v[36:37], v11 offset:9344
 ds_read_b64 v[38:39], v12 offset:9344
 ds_read_b64 v[40:41], v11 offset:18560
 ds_read_b64 v[42:43], v12 offset:18560
 ds_read_b64 v[44:45], v11 offset:27776
 ds_read_b64 v[46:47], v12 offset:27776
 s_waitcnt lgkmcnt(14)
 v_perm_b32 v48, v18, v16, s40
 s_waitcnt lgkmcnt(12)
 v_perm_b32 v49, v22, v20, s40
 s_waitcnt lgkmcnt(10)
 v_perm_b32 v50, v26, v24, s40
 s_waitcnt lgkmcnt(8)
 v_perm_b32 v51, v30, v28, s40
 buffer_store_dwordx4 v[48:51], v13, s[8:11], s38 offen
 s_add_u32 s38, s38, 8192
 v_perm_b32 v52, v18, v16, s41
 v_perm_b32 v53, v22, v20, s41
 v_perm_b32 v54, v26, v24, s41
 v_perm_b32 v55, v30, v28, s41
 buffer_store_dwordx4 v[52:55], v13, s[8:11], s38 offen
 s_add_u32 s38, s38, 8192
 v_perm_b32 v56, v19, v17, s40
 v_perm_b32 v57, v23, v21, s40
 v_perm_b32 v58, v27, v25, s40
 v_perm_b32 v59, v31, v29, s40
 buffer_store_dwordx4 v[56:59], v13, s[8:11], s38 offen
 s_add_u32 s38, s38, 8192
 v_perm_b32 v60, v19, v17, s41
 v_perm_b32 v61, v23, v21, s41
 v_perm_b32 v62, v27, v25, s41
 v_perm_b32 v63, v31, v29, s41
 buffer_store_dwordx4 v[60:63], v13, s[8:11], s38 offen
 s_add_u32 s38, s38, 499712
 ds_read_b64 v[16:17], v11 offset:256
 ds_read_b64 v[18:19], v12 offset:256
 ds_read_b64 v[20:21], v11 offset:9472
 ds_read_b64 v[22:23], v12 offset:9472
 ds_read_b64 v[24:25], v11 offset:18688
 ds_read_b64 v[26:27], v12 offset:18688
 ds_read_b64 v[28:29], v11 offset:27904
 ds_read_b64 v[30:31], v12 offset:27904
 s_waitcnt lgkmcnt(14)
 v_perm_b32 v64, v34, v32, s40
 s_waitcnt lgkmcnt(12)
 v_perm_b32 v65, v38, v36, s40
 s_waitcnt lgkmcnt(10)
 v_perm_b32 v66, v42, v40, s40
 s_waitcnt lgkmcnt(8)
 v_perm_b32 v67, v46, v44, s40
 buffer_store_dwordx4 v[64:67], v13, s[8:11], s38 offen
 s_add_u32 s38, s38, 8192
 v_perm_b32 v68, v34, v32, s41
 v_perm_b32 v69, v38, v36, s41
 v_perm_b32 v70, v42, v40, s41
 v_perm_b32 v71, v46, v44, s41
 buffer_store_dwordx4 v[68:71], v13, s[8:11], s38 offen
 s_add_u32 s38, s38, 8192
 v_perm_b32 v72, v35, v33, s40
 v_perm_b32 v73, v39, v37, s40
 v_perm_b32 v74, v43, v41, s40
 v_perm_b32 v75, v47, v45, s40
 buffer_store_dwordx4 v[72:75], v13, s[8:11], s38 offen
 s_add_u32 s38, s38, 8192
 v_perm_b32 v76, v35, v33, s41
 v_perm_b32 v77, v39, v37, s41
 v_perm_b32 v78, v43, v41, s41
 v_perm_b32 v79, v47, v45, s41
 buffer_store_dwordx4 v[76:79], v13, s[8:11], s38 offen
 s_add_u32 s38, s38, 499712
 ds_read_b64 v[32:33], v11 offset:384
 ds_read_b64 v[34:35], v12 offset:384
 ds_read_b64 v[36:37], v11 offset:9600
 ds_read_b64 v[38:39], v12 offset:9600
 ds_read_b64 v[40:41], v11 offset:18816
 ds_read_b64 v[42:43], v12 offset:18816
 ds_read_b64 v[44:45], v11 offset:28032
 ds_read_b64 v[46:47], v12 offset:28032
 s_waitcnt lgkmcnt(14)
 v_perm_b32 v48, v18, v16, s40
 s_waitcnt lgkmcnt(12)
 v_perm_b32 v49, v22, v20, s40
 s_waitcnt lgkmcnt(10)
 v_perm_b32 v50, v26, v24, s40
 s_waitcnt lgkmcnt(8)
 v_perm_b32 v51, v30, v28, s40
 buffer_store_dwordx4 v[48:51], v13, s[8:11], s38 offen
 s_add_u32 s38, s38, 8192
 v_perm_b32 v52, v18, v16, s41
 v_perm_b32 v53, v22, v20, s41
 v_perm_b32 v54, v26, v24, s41
 v_perm_b32 v55, v30, v28, s41
 buffer_store_dwordx4 v[52:55], v13, s[8:11], s38 offen
 s_add_u32 s38, s38, 8192
 v_perm_b32 v56, v19, v17, s40
 v_perm_b32 v57, v23, v21, s40
 v_perm_b32 v58, v27, v25, s40
 v_perm_b32 v59, v31, v29, s40
 buffer_store_dwordx4 v[56:59], v13, s[8:11], s38 offen
 s_add_u32 s38, s38, 8192
 v_perm_b32 v60, v19, v17, s41
 v_perm_b32 v61, v23, v21, s41
 v_perm_b32 v62, v27, v25, s41
 v_perm_b32 v63, v31, v29, s41
 buffer_store_dwordx4 v[60:63], v13, s[8:11], s38 offen
 s_add_u32 s38, s38, 499712
 ds_read_b64 v[16:17], v11 offset:512
 ds_read_b64 v[18:19], v12 offset:512
 ds_read_b64 v[20:21], v11 offset:9728
 ds_read_b64 v[22:23], v12 offset:9728
 ds_read_b64 v[24:25], v11 offset:18944
 ds_read_b64 v[26:27], v12 offset:18944
 ds_read_b64 v[28:29], v11 offset:28160
 ds_read_b64 v[30:31], v12 offset:28160
 s_waitcnt lgkmcnt(14)
 v_perm_b32 v64, v34, v32, s40
 s_waitcnt lgkmcnt(12)
 v_perm_b32 v65, v38, v36, s40
 s_waitcnt lgkmcnt(10)
 v_perm_b32 v66, v42, v40, s40
 s_waitcnt lgkmcnt(8)
 v_perm_b32 v67, v46, v44, s40
 buffer_store_dwordx4 v[64:67], v13, s[8:11], s38 offen
 s_add_u32 s38, s38, 8192
 v_perm_b32 v68, v34, v32, s41
 v_perm_b32 v69, v38, v36, s41
 v_perm_b32 v70, v42, v40, s41
 v_perm_b32 v71, v46, v44, s41
 buffer_store_dwordx4 v[68:71], v13, s[8:11], s38 offen
 s_add_u32 s38, s38, 8192
 v_perm_b32 v72, v35, v33, s40
 v_perm_b32 v73, v39, v37, s40
 v_perm_b32 v74, v43, v41, s40
 v_perm_b32 v75, v47, v45, s40
 buffer_store_dwordx4 v[72:75], v13, s[8:11], s38 offen
 s_add_u32 s38, s38, 8192
 v_perm_b32 v76, v35, v33, s41
 v_perm_b32 v77, v39, v37, s41
 v_perm_b32 v78, v43, v41, s41
 v_perm_b32 v79, v47, v45, s41
 buffer_store_dwordx4 v[76:79], v13, s[8:11], s38 offen
 s_add_u32 s38, s38, 499712
 s_cmp_ge_u32 s20, 2
 s_cbranch_scc1 L_k1_end
 s_waitcnt lgkmcnt(6)
 v_perm_b32 v48, v18, v16, s40
 s_waitcnt lgkmcnt(4)
 v_perm_b32 v49, v22, v20, s40
 s_waitcnt lgkmcnt(2)
 v_perm_b32 v50, v26, v24, s40
 s_waitcnt lgkmcnt(0)
 v_perm_b32 v51, v30, v28, s40
 buffer_store_dwordx4 v[48:51], v13, s[8:11], s38 offen
 s_add_u32 s38, s38, 8192
 v_perm_b32 v52, v18, v16, s41
 v_perm_b32 v53, v22, v20, s41
 v_perm_b32 v54, v26, v24, s41
 v_perm_b32 v55, v30, v28, s41
 buffer_store_dwordx4 v[52:55], v13, s[8:11], s38 offen
 s_add_u32 s38, s38, 8192
 v_perm_b32 v56, v19, v17, s40
 v_perm_b32 v57, v23, v21, s40
 v_perm_b32 v58, v27, v25, s40
 v_perm_b32 v59, v31, v29, s40
 buffer_store_dwordx4 v[56:59], v13, s[8:11], s38 offen
 s_add_u32 s38, s38, 8192
 v_perm_b32 v60, v19, v17, s41
 v_perm_b32 v61, v23, v21, s41
 v_perm_b32 v62, v27, v25, s41
 v_perm_b32 v63, v31, v29, s41
 buffer_store_dwordx4 v[60:63], v14, s[8:11], s39 offen
L_k1_end:
 s_endpgm
L_k1_exit:
 s_endpgm
.globl kp_kernel
.p2align 8
.type kp_kernel,@function
kp_kernel:
 s_cmp_ge_u32 s2, 256
 s_cbranch_scc1 L_kp_exit
 s_load_dwordx2 s[4:5], s[0:1], 64
 s_load_dwordx2 s[6:7], s[0:1], 48
 s_load_dwordx2 s[52:53], s[0:1], 40
 v_lshrrev_b32 v1, 6, v0
 s_nop 0
 v_readfirstlane_b32 s20, v1
 v_and_b32 v1, 63, v0
 v_and_b32 v2, 15, v0
 v_bfe_u32 v3, v0, 4, 2
 v_lshlrev_b32 v4, 4, v1
 s_and_b32 s3, s2, 7
 s_lshr_b32 s21, s2, 3
 s_lshr_b32 s22, s3, 1
 s_lshl_b32 s22, s22, 2
 s_and_b32 s23, s21, 3
 s_add_u32 s22, s22, s23
 s_and_b32 s23, s3, 1
 s_lshl_b32 s23, s23, 3
 s_lshr_b32 s21, s21, 2
 s_add_u32 s23, s23, s21
 s_lshl2_add_u32 s24, s22, s20
 s_mul_i32 s60, s23, 129024
 s_lshl_b32 s3, s20, 10
 s_add_u32 s60, s60, s3
 s_add_u32 s60, s60, 0x250000
 s_mov_b32 s45, 0
 s_bfe_u32 s98, s2, 0x20003
 s_lshl_b32 s98, s98, 6
 s_lshr_b32 s3, s2, 5
 s_lshl3_add_u32 s98, s3, s98
 s_and_b32 s3, s2, 7
 s_add_u32 s98, s98, s3
 s_cmp_ge_u32 s98, 144
 s_cbranch_scc1 L_kp_side
L_kp_layer:
 s_cmp_ge_u32 s98, 144
 s_cbranch_scc1 L_kp_pref
 s_cmp_eq_u32 s45, 0
 s_cselect_b32 s40, 0x0, 0x0
 s_mov_b32 s3, 0xc00000
 s_cselect_b32 s40, s40, s3
 s_mov_b32 s41, 0x940000
 s_mov_b32 s3, 0xe50000
 s_cselect_b32 s41, s41, s3
 s_mov_b32 s42, 0x18c0000
 s_mov_b32 s3, 0x15a0000
 s_cselect_b32 s42, s42, s3
 s_lshr_b32 s25, s20, 1
 s_and_b32 s26, s20, 1
 s_lshl_b32 s30, s20, 13
 s_add_u32 s30, s30, s42
 s_add_u32 s31, s30, 4096
 s_mul_i32 s33, s98, 16640
 s_lshl_b32 s3, s20, 12
 s_add_u32 s33, s33, s3
 s_add_u32 s44, s33, s40
 s_add_u32 s33, s33, s41
 s_lshl_b32 s29, s98, 14
 s_lshl_b32 s28, s20, 11
 s_add_u32 s29, s29, s28
 s_add_u32 s29, s29, 0x4a0000
 s_add_u32 s35, s29, 8192
 v_add_u32 v5, 92160, v4
 s_cmp_lg_u32 s45, 0
 s_cbranch_scc1 L_p2_l1
 s_lshl_b32 s3, s20, 4
 v_add_u32 v216, s3, v2
 v_cvt_f32_u32 v216, v216
 v_mul_f32 v216, 0x3c800000, v216
 v_lshlrev_b32 v218, 2, v3
 v_cvt_f32_u32 v218, v218
 v_mul_f32 v217, v216, v218
 s_mul_i32 s3, s20, 6144
 v_add_u32 v7, s3, v5
 v_fmamk_f32 v208, v216, 0x00000000, v217
 v_fmamk_f32 v209, v216, 0x3f800000, v217
 v_cos_f32 v210, v208
 v_cos_f32 v211, v209
 v_sin_f32 v212, v208
 v_sin_f32 v213, v209
 v_cvt_pk_bf16_f32 v32, v210, v211
 v_cvt_pk_bf16_f32 v40, v212, v213
 v_cvt_pk_bf16_f32 v48, -v212, -v213
 v_fmamk_f32 v208, v216, 0x40000000, v217
 v_fmamk_f32 v209, v216, 0x40400000, v217
 v_cos_f32 v210, v208
 v_cos_f32 v211, v209
 v_sin_f32 v212, v208
 v_sin_f32 v213, v209
 v_cvt_pk_bf16_f32 v33, v210, v211
 v_cvt_pk_bf16_f32 v41, v212, v213
 v_cvt_pk_bf16_f32 v49, -v212, -v213
 v_fmamk_f32 v208, v216, 0x41800000, v217
 v_fmamk_f32 v209, v216, 0x41880000, v217
 v_cos_f32 v210, v208
 v_cos_f32 v211, v209
 v_sin_f32 v212, v208
 v_sin_f32 v213, v209
 v_cvt_pk_bf16_f32 v34, v210, v211
 v_cvt_pk_bf16_f32 v42, v212, v213
 v_cvt_pk_bf16_f32 v50, -v212, -v213
 v_fmamk_f32 v208, v216, 0x41900000, v217
 v_fmamk_f32 v209, v216, 0x41980000, v217
 v_cos_f32 v210, v208
 v_cos_f32 v211, v209
 v_sin_f32 v212, v208
 v_sin_f32 v213, v209
 v_cvt_pk_bf16_f32 v35, v210, v211
 v_cvt_pk_bf16_f32 v43, v212, v213
 v_cvt_pk_bf16_f32 v51, -v212, -v213
 s_waitcnt lgkmcnt(0)
 s_mov_b32 s8, s4
 s_mov_b32 s9, s5
 s_mov_b32 s10, 0x2000000
 s_mov_b32 s11, 0x20000
 s_add_u32 s61, s60, 0
 s_lshl_b32 s3, s20, 10
 s_add_u32 m0, s3, 0
 buffer_load_dwordx4 v[120:123], v4, s[8:11], s30 offen offset:0 sc1
 ds_write_b128 v7, v[32:35] offset:16384
 ds_write_b128 v7, v[40:43] offset:18432
 ds_write_b128 v7, v[48:51] offset:20480
 v_fmamk_f32 v208, v216, 0x42000000, v217
 v_fmamk_f32 v209, v216, 0x42040000, v217
 v_cos_f32 v210, v208
 buffer_load_dwordx4 v[124:127], v4, s[8:11], s30 offen offset:1024 sc1
 v_cos_f32 v211, v209
 v_sin_f32 v212, v208
 v_sin_f32 v213, v209
 v_cvt_pk_bf16_f32 v36, v210, v211
 v_cvt_pk_bf16_f32 v44, v212, v213
 v_cvt_pk_bf16_f32 v52, -v212, -v213
 buffer_load_dwordx4 v[128:131], v4, s[8:11], s30 offen offset:2048 sc1
 v_fmamk_f32 v208, v216, 0x42080000, v217
 v_fmamk_f32 v209, v216, 0x420c0000, v217
 v_cos_f32 v210, v208
 v_cos_f32 v211, v209
 v_sin_f32 v212, v208
 v_sin_f32 v213, v209
 buffer_load_dwordx4 v[132:135], v4, s[8:11], s30 offen offset:3072 sc1
 v_cvt_pk_bf16_f32 v37, v210, v211
 v_cvt_pk_bf16_f32 v45, v212, v213
 v_cvt_pk_bf16_f32 v53, -v212, -v213
 v_fmamk_f32 v208, v216, 0x42400000, v217
 v_fmamk_f32 v209, v216, 0x42440000, v217
 v_cos_f32 v210, v208
 buffer_load_dwordx4 v[136:139], v4, s[8:11], s31 offen offset:0 sc1
 v_cos_f32 v211, v209
 v_sin_f32 v212, v208
 v_sin_f32 v213, v209
 v_cvt_pk_bf16_f32 v38, v210, v211
 v_cvt_pk_bf16_f32 v46, v212, v213
 v_cvt_pk_bf16_f32 v54, -v212, -v213
 buffer_load_dwordx4 v[140:143], v4, s[8:11], s31 offen offset:1024 sc1
 v_fmamk_f32 v208, v216, 0x42480000, v217
 v_fmamk_f32 v209, v216, 0x424c0000, v217
 v_cos_f32 v210, v208
 v_cos_f32 v211, v209
 v_sin_f32 v212, v208
 v_sin_f32 v213, v209
 v_cvt_pk_bf16_f32 v39, v210, v211
 buffer_load_dwordx4 v[144:147], v4, s[8:11], s31 offen offset:2048 sc1
 v_cvt_pk_bf16_f32 v47, v212, v213
 v_cvt_pk_bf16_f32 v55, -v212, -v213
 ds_write_b128 v7, v[36:39] offset:17408
 ds_write_b128 v7, v[44:47] offset:19456
 ds_write_b128 v7, v[52:55] offset:21504
 s_lshl_b32 s3, s25, 4
 buffer_load_dwordx4 v[148:151], v4, s[8:11], s31 offen offset:3072 sc1
 v_add_u32 v219, s3, v2
 v_cvt_f32_u32 v219, v219
 v_mul_f32 v219, 0x3d000000, v219
 s_lshl_b32 s3, s26, 4
 v_cvt_f32_u32 v220, s3
 v_add_f32 v220, v220, v218
 buffer_load_dwordx4 v[8:11], v4, s[8:11], s44 offen offset:0 sc1
 v_mul_f32 v220, v220, v219
 s_lshl_b32 s3, s25, 10
 s_lshl3_add_u32 s3, s26, s3
 v_add_u32 v7, s3, v5
 v_fmamk_f32 v208, v219, 0x00000000, v220
 v_fmamk_f32 v209, v219, 0x3f800000, v220
 buffer_load_dwordx4 v[12:15], v4, s[8:11], s44 offen offset:1024 sc1
 v_cos_f32 v210, v208
 v_cos_f32 v211, v209
 v_sin_f32 v212, v208
 v_sin_f32 v213, v209
 v_cvt_pk_bf16_f32 v152, v210, v211
 v_cvt_pk_bf16_f32 v154, v212, v213
 buffer_load_dwordx4 v[16:19], v4, s[8:11], s44 offen offset:2048 sc1
 v_cvt_pk_bf16_f32 v156, -v212, -v213
 v_fmamk_f32 v208, v219, 0x40000000, v220
 v_fmamk_f32 v209, v219, 0x40400000, v220
 v_cos_f32 v210, v208
 v_cos_f32 v211, v209
 v_sin_f32 v212, v208
 buffer_load_dwordx4 v[20:23], v4, s[8:11], s44 offen offset:3072 sc1
 v_sin_f32 v213, v209
 v_cvt_pk_bf16_f32 v153, v210, v211
 v_cvt_pk_bf16_f32 v155, v212, v213
 v_cvt_pk_bf16_f32 v157, -v212, -v213
 ds_write_b64 v7, v[152:153] offset:40960
 ds_write_b64 v7, v[154:155] offset:43008
 ds_write_b64 v7, v[156:157] offset:45056
 s_mul_i32 s3, s25, 12288
 v_add_u32 v222, s3, v5
 s_waitcnt lgkmcnt(0)
 s_barrier
 s_mul_i32 s3, s20, 6144
 v_add_u32 v221, s3, v5
 v_mul_f32 v216, 0x3d000000, v216
 v_mul_f32 v217, 0x3d000000, v217
 v_fmamk_f32 v208, v216, 0x00000000, v217
 v_cos_f32 v56, v208
 ds_read_b128 a[136:139], v221 offset:16384
 v_sin_f32 v64, v208
 v_fmamk_f32 v209, v216, 0x3f800000, v217
 v_cos_f32 v57, v209
 ds_read_b128 a[140:143], v221 offset:17408
 v_sin_f32 v65, v209
 v_fmamk_f32 v208, v216, 0x40000000, v217
 v_cos_f32 v58, v208
 ds_read_b128 a[144:147], v221 offset:18432
 v_sin_f32 v66, v208
 v_fmamk_f32 v209, v216, 0x40400000, v217
 v_cos_f32 v59, v209
 v_sin_f32 v67, v209
 ds_read_b128 a[148:151], v221 offset:19456
 v_fmamk_f32 v208, v216, 0x41800000, v217
 v_cos_f32 v60, v208
 v_sin_f32 v68, v208
 ds_read_b128 a[152:155], v221 offset:20480
 v_fmamk_f32 v209, v216, 0x41880000, v217
 v_cos_f32 v61, v209
 v_sin_f32 v69, v209
 ds_read_b128 a[156:159], v221 offset:21504
 buffer_load_dwordx4 v[176:179], v4, s[8:11], s29 offen offset:0
 v_fmamk_f32 v208, v216, 0x41900000, v217
 v_cos_f32 v62, v208
 v_sin_f32 v70, v208
 v_fmamk_f32 v209, v216, 0x41980000, v217
 ds_read_b128 a[64:67], v5 offset:40960
 v_cos_f32 v63, v209
 v_sin_f32 v71, v209
 s_lshl_b32 s3, s20, 4
 ds_read_b128 a[68:71], v5 offset:41984
 v_cvt_f32_u32 v220, s3
 v_add_f32 v220, v220, v218
 v_cvt_f32_u32 v219, v2
 ds_read_b128 a[72:75], v5 offset:43008
 v_add_f32 v216, 0x00000000, v219
 v_mul_f32 v216, 0x3a000000, v216
 v_mul_f32 v217, v216, v220
 ds_read_b128 a[76:79], v5 offset:44032
 v_fmamk_f32 v208, v216, 0x00000000, v217
 v_cos_f32 v72, v208
 v_sin_f32 v80, v208
 v_fmamk_f32 v209, v216, 0x3f800000, v217
 ds_read_b128 a[80:83], v5 offset:45056
 v_cos_f32 v73, v209
 v_sin_f32 v81, v209
 v_fmamk_f32 v208, v216, 0x40000000, v217
 ds_read_b128 a[84:87], v5 offset:46080
 buffer_load_dwordx4 v[180:183], v4, s[8:11], s29 offen offset:1024
 v_cos_f32 v74, v208
 v_sin_f32 v82, v208
 v_fmamk_f32 v209, v216, 0x40400000, v217
 ds_read_b128 a[88:91], v222 offset:16384
 v_cos_f32 v75, v209
 v_sin_f32 v83, v209
 v_add_f32 v216, 0x41800000, v219
 v_mul_f32 v216, 0x3a000000, v216
 ds_read_b128 a[92:95], v222 offset:17408
 v_mul_f32 v217, v216, v220
 v_fmamk_f32 v208, v216, 0x00000000, v217
 v_cos_f32 v76, v208
 ds_read_b128 a[96:99], v222 offset:18432
 v_sin_f32 v84, v208
 v_fmamk_f32 v209, v216, 0x3f800000, v217
 v_cos_f32 v77, v209
 ds_read_b128 a[100:103], v222 offset:19456
 v_sin_f32 v85, v209
 v_fmamk_f32 v208, v216, 0x40000000, v217
 v_cos_f32 v78, v208
 ds_read_b128 a[104:107], v222 offset:20480
 v_sin_f32 v86, v208
 v_fmamk_f32 v209, v216, 0x40400000, v217
 v_cos_f32 v79, v209
 v_sin_f32 v87, v209
 ds_read_b128 a[108:111], v222 offset:21504
 buffer_load_dwordx4 v[192:195], v4, s[8:11], s35 offen offset:0
 v_and_b32 v208, 1, v2
 v_lshlrev_b32 v208, 4, v208
 v_mov_b32 v209, 0x3f80
 ds_read_b128 a[112:115], v222 offset:22528
 v_lshlrev_b32 v208, v208, v209
 v_lshrrev_b32 v209, 1, v2
 v_lshlrev_b32 v210, 1, v3
 ds_read_b128 a[116:119], v222 offset:23552
 v_cmp_eq_u32 vcc, v209, v210
 s_nop 1
 v_cndmask_b32 v224, 0, v208, vcc
 v_add_u32 v210, 1, v210
 v_cmp_eq_u32 vcc, v209, v210
 ds_read_b128 a[120:123], v222 offset:24576
 s_nop 0
 v_cndmask_b32 v228, 0, v208, vcc
 v_accvgpr_write_b32 a160, v224
 v_accvgpr_write_b32 a164, v228
 ds_read_b128 a[124:127], v222 offset:25600
 v_accvgpr_write_b32 a161, v224
 v_accvgpr_write_b32 a165, v228
 v_accvgpr_write_b32 a162, v224
 ds_read_b128 a[128:131], v222 offset:26624
 v_accvgpr_write_b32 a166, v228
 v_accvgpr_write_b32 a163, v224
 v_accvgpr_write_b32 a167, v228
 ds_read_b128 a[132:135], v222 offset:27648
 buffer_load_dwordx4 v[196:199], v4, s[8:11], s35 offen offset:1024
 s_waitcnt vmcnt(4) lgkmcnt(0)
 s_branch L_p2_go
L_p2_l1:
 s_add_u32 s61, s60, 0
 s_lshl_b32 s3, s20, 10
 s_add_u32 m0, s3, 0
 s_lshl_b32 s3, s25, 10
 s_lshl3_add_u32 s3, s26, s3
 v_add_u32 v7, s3, v5
 s_waitcnt vmcnt(3)
 buffer_load_dwordx4 v[176:179], v4, s[8:11], s29 offen offset:0
 v_accvgpr_read_b32 v56, a168
 v_accvgpr_read_b32 v57, a169
 s_waitcnt vmcnt(3)
 buffer_load_dwordx4 v[180:183], v4, s[8:11], s29 offen offset:1024
 v_accvgpr_read_b32 v58, a170
 v_accvgpr_read_b32 v59, a171
 s_waitcnt vmcnt(3)
 buffer_load_dwordx4 v[192:195], v4, s[8:11], s35 offen offset:0
 v_accvgpr_read_b32 v60, a172
 v_accvgpr_read_b32 v61, a173
 s_waitcnt vmcnt(3)
 buffer_load_dwordx4 v[196:199], v4, s[8:11], s35 offen offset:1024
 v_accvgpr_read_b32 v62, a174
 v_accvgpr_read_b32 v63, a175
 v_accvgpr_read_b32 v64, a176
 buffer_load_dwordx4 v4, s[8:11], s61 offen lds
 s_add_u32 s61, s61, 4096
 s_add_u32 m0, m0, 4096
 v_accvgpr_read_b32 v65, a177
 v_accvgpr_read_b32 v66, a178
 buffer_load_dwordx4 v4, s[8:11], s61 offen lds
 s_add_u32 s61, s61, 4096
 s_add_u32 m0, m0, 4096
 v_accvgpr_read_b32 v67, a179
 v_accvgpr_read_b32 v68, a180
 buffer_load_dwordx4 v4, s[8:11], s61 offen lds
 s_add_u32 s61, s61, 4096
 s_add_u32 m0, m0, 4096
 v_accvgpr_read_b32 v69, a181
 v_accvgpr_read_b32 v70, a182
 v_accvgpr_read_b32 v71, a183
 buffer_load_dwordx4 v4, s[8:11], s61 offen lds
 s_add_u32 s61, s61, 4096
 s_add_u32 m0, m0, 4096
 v_accvgpr_read_b32 v72, a184
 v_accvgpr_read_b32 v73, a185
 buffer_load_dwordx4 v4, s[8:11], s61 offen lds
 s_add_u32 s61, s61, 4096
 s_add_u32 m0, m0, 4096
 v_accvgpr_read_b32 v74, a186
 v_accvgpr_read_b32 v75, a187
 buffer_load_dwordx4 v4, s[8:11], s61 offen lds
 s_add_u32 s61, s61, 4096
 s_add_u32 m0, m0, 4096
 v_accvgpr_read_b32 v76, a188
 v_accvgpr_read_b32 v77, a189
 buffer_load_dwordx4 v4, s[8:11], s61 offen lds
 s_add_u32 s61, s61, 4096
 s_add_u32 m0, m0, 4096
 v_accvgpr_read_b32 v78, a190
 v_accvgpr_read_b32 v79, a191
 v_accvgpr_read_b32 v80, a192
 buffer_load_dwordx4 v4, s[8:11], s61 offen lds
 s_add_u32 s61, s61, 4096
 s_add_u32 m0, m0, 4096
 v_accvgpr_read_b32 v81, a193
 v_accvgpr_read_b32 v82, a194
 buffer_load_dwordx4 v4, s[8:11], s61 offen lds
 s_add_u32 s61, s61, 4096
 s_add_u32 m0, m0, 4096
 v_accvgpr_read_b32 v83, a195
 v_accvgpr_read_b32 v84, a196
 buffer_load_dwordx4 v4, s[8:11], s61 offen lds
 s_add_u32 s61, s61, 4096
 s_add_u32 m0, m0, 4096
 v_accvgpr_read_b32 v85, a197
 v_accvgpr_read_b32 v86, a198
 v_accvgpr_read_b32 v87, a199
 s_mov_b32 s34, 0
L_p2_poll:
 buffer_load_dwordx4 v[120:123], v4, s[8:11], s30 offen offset:0 sc1
 buffer_load_dwordx4 v[124:127], v4, s[8:11], s30 offen offset:1024 sc1
 buffer_load_dwordx4 v[128:131], v4, s[8:11], s30 offen offset:2048 sc1
 buffer_load_dwordx4 v[132:135], v4, s[8:11], s30 offen offset:3072 sc1
 buffer_load_dwordx4 v[136:139], v4, s[8:11], s31 offen offset:0 sc1
 buffer_load_dwordx4 v[140:143], v4, s[8:11], s31 offen offset:1024 sc1
 buffer_load_dwordx4 v[144:147], v4, s[8:11], s31 offen offset:2048 sc1
 buffer_load_dwordx4 v[148:151], v4, s[8:11], s31 offen offset:3072 sc1
 buffer_load_dwordx4 v[8:11], v4, s[8:11], s44 offen offset:0 sc1
 buffer_load_dwordx4 v[12:15], v4, s[8:11], s44 offen offset:1024 sc1
 buffer_load_dwordx4 v[16:19], v4, s[8:11], s44 offen offset:2048 sc1
 buffer_load_dwordx4 v[20:23], v4, s[8:11], s44 offen offset:3072 sc1
 s_waitcnt vmcnt(11)
 v_max_u32 v208, v120, v121
 v_max3_u32 v208, v122, v123, v208
 s_waitcnt vmcnt(10)
 v_max3_u32 v208, v124, v125, v208
 v_max3_u32 v208, v126, v127, v208
 s_waitcnt vmcnt(9)
 v_max3_u32 v208, v128, v129, v208
 v_max3_u32 v208, v130, v131, v208
 s_waitcnt vmcnt(8)
 v_max3_u32 v208, v132, v133, v208
 v_max3_u32 v208, v134, v135, v208
 s_waitcnt vmcnt(7)
 v_max3_u32 v208, v136, v137, v208
 v_max3_u32 v208, v138, v139, v208
 s_waitcnt vmcnt(6)
 v_max3_u32 v208, v140, v141, v208
 v_max3_u32 v208, v142, v143, v208
 s_waitcnt vmcnt(5)
 v_max3_u32 v208, v144, v145, v208
 v_max3_u32 v208, v146, v147, v208
 s_waitcnt vmcnt(4)
 v_max3_u32 v208, v148, v149, v208
 v_max3_u32 v208, v150, v151, v208
 s_waitcnt vmcnt(3)
 v_max3_u32 v208, v8, v9, v208
 v_max3_u32 v208, v10, v11, v208
 s_waitcnt vmcnt(2)
 v_max3_u32 v208, v12, v13, v208
 v_max3_u32 v208, v14, v15, v208
 s_waitcnt vmcnt(1)
 v_max3_u32 v208, v16, v17, v208
 v_max3_u32 v208, v18, v19, v208
 s_waitcnt vmcnt(0)
 v_max3_u32 v208, v20, v21, v208
 v_max3_u32 v208, v22, v23, v208
 v_cmp_eq_u32 vcc, -1, v208
 s_add_u32 s34, s34, 1
 s_cmp_gt_u32 s34, 131072
 s_cbranch_scc1 L_p2_go
 s_cbranch_vccnz L_p2_poll
L_p2_go:
 s_mov_b32 s32, 0x45e38e39
 v_mov_b32 v223, 0x4227c5ac
 s_lshl_b32 s3, s20, 10
 v_add_u32 v222, s3, v5
 s_cmp_eq_u32 s98, 0
 s_cselect_b32 s31, 0, 0xffff0000
 v_mfma_f32_16x16x32_bf16 v[24:27], a[160:163], v[120:123], 0
 v_mfma_f32_16x16x32_bf16 v[24:27], a[160:163], v[124:127], v[24:27]
 v_mfma_f32_16x16x32_bf16 v[24:27], a[164:167], v[128:131], v[24:27]
 v_mfma_f32_16x16x32_bf16 v[24:27], a[164:167], v[132:135], v[24:27]
 v_mfma_f32_16x16x32_bf16 v[28:31], a[160:163], v[136:139], 0
 v_mfma_f32_16x16x32_bf16 v[28:31], a[160:163], v[140:143], v[28:31]
 v_mfma_f32_16x16x32_bf16 v[28:31], a[164:167], v[144:147], v[28:31]
 v_mfma_f32_16x16x32_bf16 v[28:31], a[164:167], v[148:151], v[28:31]
 v_lshlrev_b32 v88, 16, v8
 v_and_b32 v96, s31, v8
 v_lshlrev_b32 v89, 16, v10
 v_and_b32 v97, s31, v10
 v_lshlrev_b32 v90, 16, v12
 v_and_b32 v98, s31, v12
 v_lshlrev_b32 v91, 16, v14
 v_and_b32 v99, s31, v14
 v_lshlrev_b32 v92, 16, v16
 v_and_b32 v100, s31, v16
 v_lshlrev_b32 v93, 16, v18
 v_and_b32 v101, s31, v18
 v_lshlrev_b32 v94, 16, v20
 v_and_b32 v102, s31, v20
 v_lshlrev_b32 v95, 16, v22
 v_and_b32 v103, s31, v22
 v_lshlrev_b32 v104, 16, v9
 v_and_b32 v112, 0xffff0000, v9
 v_lshlrev_b32 v105, 16, v11
 v_and_b32 v113, 0xffff0000, v11
 v_lshlrev_b32 v106, 16, v13
 v_and_b32 v114, 0xffff0000, v13
 v_lshlrev_b32 v107, 16, v15
 v_and_b32 v115, 0xffff0000, v15
 v_lshlrev_b32 v108, 16, v17
 v_and_b32 v116, 0xffff0000, v17
 v_lshlrev_b32 v109, 16, v19
 v_and_b32 v117, 0xffff0000, v19
 v_lshlrev_b32 v110, 16, v21
 v_and_b32 v118, 0xffff0000, v21
 v_lshlrev_b32 v111, 16, v23
 v_and_b32 v119, 0xffff0000, v23
 v_fma_f32 v24, v24, s32, v223
 v_rsq_f32 v24, v24
 v_fma_f32 v25, v25, s32, v223
 v_rsq_f32 v25, v25
 v_fma_f32 v26, v26, s32, v223
 v_rsq_f32 v26, v26
 v_fma_f32 v27, v27, s32, v223
 v_rsq_f32 v27, v27
 v_fma_f32 v28, v28, s32, v223
 v_rsq_f32 v28, v28
 v_fma_f32 v29, v29, s32, v223
 v_rsq_f32 v29, v29
 v_fma_f32 v30, v30, s32, v223
 v_rsq_f32 v30, v30
 v_fma_f32 v31, v31, s32, v223
 v_rsq_f32 v31, v31
 v_pk_mul_f32 v[208:209], v[88:89], v[24:25]
 v_pk_mul_f32 v[210:211], v[96:97], v[24:25]
 v_cvt_pk_bf16_f32 v152, v208, v209
 v_cvt_pk_bf16_f32 v156, v210, v211
 v_pk_mul_f32 v[208:209], v[90:91], v[26:27]
 v_pk_mul_f32 v[210:211], v[98:99], v[26:27]
 v_cvt_pk_bf16_f32 v153, v208, v209
 v_cvt_pk_bf16_f32 v157, v210, v211
 v_pk_mul_f32 v[208:209], v[92:93], v[28:29]
 v_pk_mul_f32 v[210:211], v[100:101], v[28:29]
 v_cvt_pk_bf16_f32 v154, v208, v209
 v_cvt_pk_bf16_f32 v158, v210, v211
 v_pk_mul_f32 v[208:209], v[94:95], v[30:31]
 v_pk_mul_f32 v[210:211], v[102:103], v[30:31]
 v_cvt_pk_bf16_f32 v155, v208, v209
 v_cvt_pk_bf16_f32 v159, v210, v211
 ds_write_b128 v222, v[152:155] offset:0
 ds_write_b128 v222, v[156:159] offset:4096
 v_pk_mul_f32 v[208:209], v[104:105], v[24:25]
 v_pk_mul_f32 v[210:211], v[112:113], v[24:25]
 v_cvt_pk_bf16_f32 v160, v208, v209
 v_cvt_pk_bf16_f32 v164, v210, v211
 v_pk_mul_f32 v[208:209], v[106:107], v[26:27]
 v_pk_mul_f32 v[210:211], v[114:115], v[26:27]
 v_cvt_pk_bf16_f32 v161, v208, v209
 v_cvt_pk_bf16_f32 v165, v210, v211
 v_pk_mul_f32 v[208:209], v[108:109], v[28:29]
 v_pk_mul_f32 v[210:211], v[116:117], v[28:29]
 v_cvt_pk_bf16_f32 v162, v208, v209
 v_cvt_pk_bf16_f32 v166, v210, v211
 v_pk_mul_f32 v[208:209], v[110:111], v[30:31]
 v_pk_mul_f32 v[210:211], v[118:119], v[30:31]
 v_cvt_pk_bf16_f32 v163, v208, v209
 v_cvt_pk_bf16_f32 v167, v210, v211
 ds_write_b128 v222, v[160:163] offset:8192
 ds_write_b128 v222, v[164:167] offset:12288
 s_waitcnt vmcnt(0) lgkmcnt(0)
 s_barrier
 ds_read_b128 a[0:3], v5 offset:0
 ds_read_b128 a[16:19], v5 offset:4096
 ds_read_b128 a[8:11], v5 offset:2048
 ds_read_b128 a[24:27], v5 offset:6144
 ds_read_b128 a[4:7], v5 offset:1024
 ds_read_b128 a[20:23], v5 offset:5120
 ds_read_b128 a[12:15], v5 offset:3072
 ds_read_b128 a[28:31], v5 offset:7168
 s_waitcnt lgkmcnt(7)
 v_mfma_f32_16x16x32_bf16 v[120:123], a[0:3], a[136:139], 0
 v_lshlrev_b32 v168, 16, v176
 v_and_b32 v176, 0xffff0000, v176
 s_waitcnt lgkmcnt(6)
 v_mfma_f32_16x16x32_bf16 v[128:131], a[16:19], a[136:139], 0
 v_lshlrev_b32 v169, 16, v177
 v_and_b32 v177, 0xffff0000, v177
 ds_read_b128 a[32:35], v5 offset:8192
 v_mfma_f32_16x16x32_bf16 v[120:123], a[16:19], a[144:147], v[120:123]
 v_lshlrev_b32 v170, 16, v178
 v_and_b32 v178, 0xffff0000, v178
 v_mfma_f32_16x16x32_bf16 v[128:131], a[0:3], a[152:155], v[128:131]
 v_lshlrev_b32 v171, 16, v179
 v_and_b32 v179, 0xffff0000, v179
 ds_read_b128 a[48:51], v5 offset:12288
 s_waitcnt lgkmcnt(7)
 v_mfma_f32_16x16x32_bf16 v[120:123], a[8:11], a[140:143], v[120:123]
 v_lshlrev_b32 v172, 16, v180
 v_and_b32 v180, 0xffff0000, v180
 s_waitcnt lgkmcnt(6)
 v_mfma_f32_16x16x32_bf16 v[128:131], a[24:27], a[140:143], v[128:131]
 v_lshlrev_b32 v173, 16, v181
 v_and_b32 v181, 0xffff0000, v181
 ds_read_b128 a[40:43], v5 offset:10240
 v_mfma_f32_16x16x32_bf16 v[120:123], a[24:27], a[148:151], v[120:123]
 v_lshlrev_b32 v174, 16, v182
 v_and_b32 v182, 0xffff0000, v182
 v_mfma_f32_16x16x32_bf16 v[128:131], a[8:11], a[156:159], v[128:131]
 v_lshlrev_b32 v175, 16, v183
 v_and_b32 v183, 0xffff0000, v183
 ds_read_b128 a[56:59], v5 offset:14336
 s_waitcnt lgkmcnt(7)
 v_mfma_f32_16x16x32_bf16 v[124:127], a[4:7], a[136:139], 0
 v_lshlrev_b32 v184, 16, v192
 v_and_b32 v192, 0xffff0000, v192
 s_waitcnt lgkmcnt(6)
 v_mfma_f32_16x16x32_bf16 v[132:135], a[20:23], a[136:139], 0
 v_lshlrev_b32 v185, 16, v193
 v_and_b32 v193, 0xffff0000, v193
 ds_read_b128 a[36:39], v5 offset:9216
 v_mfma_f32_16x16x32_bf16 v[124:127], a[20:23], a[144:147], v[124:127]
 v_lshlrev_b32 v186, 16, v194
 v_and_b32 v194, 0xffff0000, v194
 v_mfma_f32_16x16x32_bf16 v[132:135], a[4:7], a[152:155], v[132:135]
 v_lshlrev_b32 v187, 16, v195
 v_and_b32 v195, 0xffff0000, v195
 ds_read_b128 a[52:55], v5 offset:13312
 s_waitcnt lgkmcnt(7)
 v_mfma_f32_16x16x32_bf16 v[124:127], a[12:15], a[140:143], v[124:127]
 v_lshlrev_b32 v188, 16, v196
 v_and_b32 v196, 0xffff0000, v196
 s_waitcnt lgkmcnt(6)
 v_mfma_f32_16x16x32_bf16 v[132:135], a[28:31], a[140:143], v[132:135]
 v_lshlrev_b32 v189, 16, v197
 v_and_b32 v197, 0xffff0000, v197
 ds_read_b128 a[44:47], v5 offset:11264
 v_mfma_f32_16x16x32_bf16 v[124:127], a[28:31], a[148:151], v[124:127]
 v_lshlrev_b32 v190, 16, v198
 v_and_b32 v198, 0xffff0000, v198
 v_mfma_f32_16x16x32_bf16 v[132:135], a[12:15], a[156:159], v[132:135]
 v_lshlrev_b32 v191, 16, v199
 v_and_b32 v199, 0xffff0000, v199
 ds_read_b128 a[60:63], v5 offset:15360
 s_waitcnt lgkmcnt(7)
 v_mfma_f32_16x16x32_bf16 v[136:139], a[32:35], a[136:139], 0
 v_mul_f32 v200, v120, v56
 v_mul_f32 v202, v128, v56
 s_waitcnt lgkmcnt(6)
 v_mfma_f32_16x16x32_bf16 v[144:147], a[48:51], a[136:139], 0
 v_fmac_f32 v200, v128, v64
 v_fma_f32 v202, -v120, v64, v202
 v_mfma_f32_16x16x32_bf16 v[136:139], a[48:51], a[144:147], v[136:139]
 v_mul_f32 v201, v121, v57
 v_mul_f32 v203, v129, v57
 v_mfma_f32_16x16x32_bf16 v[144:147], a[32:35], a[152:155], v[144:147]
 v_fmac_f32 v201, v129, v65
 v_fma_f32 v203, -v121, v65, v203
 s_waitcnt lgkmcnt(5)
 v_mfma_f32_16x16x32_bf16 v[136:139], a[40:43], a[140:143], v[136:139]
 v_cvt_pk_bf16_f32 v152, v200, v201
 v_cvt_pk_bf16_f32 v156, v202, v203
 s_waitcnt lgkmcnt(4)
 v_mfma_f32_16x16x32_bf16 v[144:147], a[56:59], a[140:143], v[144:147]
 v_mul_f32 v200, v122, v58
 v_mul_f32 v202, v130, v58
 v_mfma_f32_16x16x32_bf16 v[136:139], a[56:59], a[148:151], v[136:139]
 v_fmac_f32 v200, v130, v66
 v_fma_f32 v202, -v122, v66, v202
 v_mfma_f32_16x16x32_bf16 v[144:147], a[40:43], a[156:159], v[144:147]
 v_mul_f32 v201, v123, v59
 v_mul_f32 v203, v131, v59
 s_waitcnt lgkmcnt(3)
 v_mfma_f32_16x16x32_bf16 v[140:143], a[36:39], a[136:139], 0
 v_fmac_f32 v201, v131, v67
 v_fma_f32 v203, -v123, v67, v203
 s_waitcnt lgkmcnt(2)
 v_mfma_f32_16x16x32_bf16 v[148:151], a[52:55], a[136:139], 0
 v_cvt_pk_bf16_f32 v153, v200, v201
 v_cvt_pk_bf16_f32 v157, v202, v203
 v_mfma_f32_16x16x32_bf16 v[140:143], a[52:55], a[144:147], v[140:143]
 v_mul_f32 v200, v124, v60
 v_mul_f32 v202, v132, v60
 v_mfma_f32_16x16x32_bf16 v[148:151], a[36:39], a[152:155], v[148:151]
 v_fmac_f32 v200, v132, v68
 v_fma_f32 v202, -v124, v68, v202
 s_waitcnt lgkmcnt(1)
 v_mfma_f32_16x16x32_bf16 v[140:143], a[44:47], a[140:143], v[140:143]
 v_mul_f32 v201, v125, v61
 v_mul_f32 v203, v133, v61
 s_waitcnt lgkmcnt(0)
 v_mfma_f32_16x16x32_bf16 v[148:151], a[60:63], a[140:143], v[148:151]
 v_fmac_f32 v201, v133, v69
 v_fma_f32 v203, -v125, v69, v203
 v_mfma_f32_16x16x32_bf16 v[140:143], a[60:63], a[148:151], v[140:143]
 v_cvt_pk_bf16_f32 v154, v200, v201
 v_cvt_pk_bf16_f32 v158, v202, v203
 v_mfma_f32_16x16x32_bf16 v[148:151], a[44:47], a[156:159], v[148:151]
 v_mul_f32 v200, v126, v62
 v_mul_f32 v202, v134, v62
 v_fmac_f32 v200, v134, v70
 v_fma_f32 v202, -v126, v70, v202
 v_mul_f32 v201, v127, v63
 v_mul_f32 v203, v135, v63
 v_fmac_f32 v201, v135, v71
 v_fma_f32 v203, -v127, v71, v203
 v_cvt_pk_bf16_f32 v155, v200, v201
 v_cvt_pk_bf16_f32 v159, v202, v203
 s_nop 0
 v_mfma_f32_16x16x32_bf16 v[120:123], a[64:67], v[152:155], 0
 v_mul_f32 v204, v136, v56
 v_mul_f32 v206, v144, v56
 v_mfma_f32_16x16x32_bf16 v[128:131], a[64:67], v[156:159], 0
 v_fmac_f32 v204, v144, v64
 v_fma_f32 v206, -v136, v64, v206
 v_mfma_f32_16x16x32_bf16 v[120:123], a[72:75], v[156:159], v[120:123]
 v_mul_f32 v205, v137, v57
 v_mul_f32 v207, v145, v57
 v_mfma_f32_16x16x32_bf16 v[128:131], a[80:83], v[152:155], v[128:131]
 v_fmac_f32 v205, v145, v65
 v_fma_f32 v207, -v137, v65, v207
 v_mfma_f32_16x16x32_bf16 v[124:127], a[68:71], v[152:155], 0
 v_cvt_pk_bf16_f32 v160, v204, v205
 v_cvt_pk_bf16_f32 v164, v206, v207
 v_mfma_f32_16x16x32_bf16 v[132:135], a[68:71], v[156:159], 0
 v_mul_f32 v204, v138, v58
 v_mul_f32 v206, v146, v58
 v_mfma_f32_16x16x32_bf16 v[124:127], a[76:79], v[156:159], v[124:127]
 v_fmac_f32 v204, v146, v66
 v_fma_f32 v206, -v138, v66, v206
 v_mfma_f32_16x16x32_bf16 v[132:135], a[84:87], v[152:155], v[132:135]
 v_mul_f32 v205, v139, v59
 v_mul_f32 v207, v147, v59
 v_fmac_f32 v205, v147, v67
 v_fma_f32 v207, -v139, v67, v207
 v_cvt_pk_bf16_f32 v161, v204, v205
 v_cvt_pk_bf16_f32 v165, v206, v207
 v_mul_f32 v204, v140, v60
 v_mul_f32 v206, v148, v60
 v_fmac_f32 v204, v148, v68
 v_fma_f32 v206, -v140, v68, v206
 v_mul_f32 v205, v141, v61
 v_mul_f32 v207, v149, v61
 v_fmac_f32 v205, v149, v69
 v_fma_f32 v207, -v141, v69, v207
 v_cvt_pk_bf16_f32 v162, v204, v205
 v_cvt_pk_bf16_f32 v166, v206, v207
 v_mul_f32 v204, v142, v62
 v_mul_f32 v206, v150, v62
 v_fmac_f32 v204, v150, v70
 v_fma_f32 v206, -v142, v70, v206
 v_mul_f32 v205, v143, v63
 v_mul_f32 v207, v151, v63
 v_fmac_f32 v205, v151, v71
 v_fma_f32 v207, -v143, v71, v207
 v_cvt_pk_bf16_f32 v163, v204, v205
 v_cvt_pk_bf16_f32 v167, v206, v207
 s_nop 0
 v_mfma_f32_16x16x32_bf16 v[136:139], a[64:67], v[160:163], 0
 v_mul_f32 v200, v120, v168
 v_mul_f32 v202, v128, v168
 v_mfma_f32_16x16x32_bf16 v[144:147], a[64:67], v[164:167], 0
 v_fma_f32 v200, -v128, v176, v200
 v_fmac_f32 v202, v120, v176
 v_mfma_f32_16x16x32_bf16 v[136:139], a[72:75], v[164:167], v[136:139]
 v_mul_f32 v201, v121, v169
 v_mul_f32 v203, v129, v169
 v_mfma_f32_16x16x32_bf16 v[144:147], a[80:83], v[160:163], v[144:147]
 v_fma_f32 v201, -v129, v177, v201
 v_fmac_f32 v203, v121, v177
 v_mfma_f32_16x16x32_bf16 v[140:143], a[68:71], v[160:163], 0
 v_cvt_pk_bf16_f32 v152, v200, v201
 v_cvt_pk_bf16_f32 v156, v202, v203
 v_mfma_f32_16x16x32_bf16 v[148:151], a[68:71], v[164:167], 0
 v_mul_f32 v200, v122, v170
 v_mul_f32 v202, v130, v170
 v_mfma_f32_16x16x32_bf16 v[140:143], a[76:79], v[164:167], v[140:143]
 v_fma_f32 v200, -v130, v178, v200
 v_fmac_f32 v202, v122, v178
 v_mfma_f32_16x16x32_bf16 v[148:151], a[84:87], v[160:163], v[148:151]
 v_mul_f32 v201, v123, v171
 v_mul_f32 v203, v131, v171
 v_fma_f32 v201, -v131, v179, v201
 v_fmac_f32 v203, v123, v179
 v_cvt_pk_bf16_f32 v153, v200, v201
 v_cvt_pk_bf16_f32 v157, v202, v203
 v_mul_f32 v200, v124, v172
 v_mul_f32 v202, v132, v172
 v_fma_f32 v200, -v132, v180, v200
 v_fmac_f32 v202, v124, v180
 v_mul_f32 v201, v125, v173
 v_mul_f32 v203, v133, v173
 v_fma_f32 v201, -v133, v181, v201
 v_fmac_f32 v203, v125, v181
 v_cvt_pk_bf16_f32 v154, v200, v201
 v_cvt_pk_bf16_f32 v158, v202, v203
 v_mul_f32 v200, v126, v174
 v_mul_f32 v202, v134, v174
 v_fma_f32 v200, -v134, v182, v200
 v_fmac_f32 v202, v126, v182
 v_mul_f32 v201, v127, v175
 v_mul_f32 v203, v135, v175
 v_fma_f32 v201, -v135, v183, v201
 v_fmac_f32 v203, v127, v183
 v_cvt_pk_bf16_f32 v155, v200, v201
 v_cvt_pk_bf16_f32 v159, v202, v203
 s_nop 0
 v_mfma_f32_16x16x32_bf16 v[120:123], v[152:155], a[64:67], 0
 v_mul_f32 v204, v136, v184
 v_mul_f32 v206, v144, v184
 v_mfma_f32_16x16x32_bf16 v[128:131], v[156:159], a[64:67], 0
 v_fma_f32 v204, -v144, v192, v204
 v_fmac_f32 v206, v136, v192
 v_mfma_f32_16x16x32_bf16 v[120:123], v[156:159], a[80:83], v[120:123]
 v_mul_f32 v205, v137, v185
 v_mul_f32 v207, v145, v185
 v_mfma_f32_16x16x32_bf16 v[128:131], v[152:155], a[72:75], v[128:131]
 v_fma_f32 v205, -v145, v193, v205
 v_fmac_f32 v207, v137, v193
 v_mfma_f32_16x16x32_bf16 v[124:127], v[152:155], a[68:71], 0
 v_cvt_pk_bf16_f32 v160, v204, v205
 v_cvt_pk_bf16_f32 v164, v206, v207
 v_mfma_f32_16x16x32_bf16 v[132:135], v[156:159], a[68:71], 0
 v_mul_f32 v204, v138, v186
 v_mul_f32 v206, v146, v186
 v_mfma_f32_16x16x32_bf16 v[124:127], v[156:159], a[84:87], v[124:127]
 v_fma_f32 v204, -v146, v194, v204
 v_fmac_f32 v206, v138, v194
 v_mfma_f32_16x16x32_bf16 v[132:135], v[152:155], a[76:79], v[132:135]
 v_mul_f32 v205, v139, v187
 v_mul_f32 v207, v147, v187
 v_fma_f32 v205, -v147, v195, v205
 v_fmac_f32 v207, v139, v195
 v_cvt_pk_bf16_f32 v161, v204, v205
 v_cvt_pk_bf16_f32 v165, v206, v207
 v_mul_f32 v204, v140, v188
 v_mul_f32 v206, v148, v188
 v_fma_f32 v204, -v148, v196, v204
 v_fmac_f32 v206, v140, v196
 v_mul_f32 v205, v141, v189
 v_mul_f32 v207, v149, v189
 v_fma_f32 v205, -v149, v197, v205
 v_fmac_f32 v207, v141, v197
 v_cvt_pk_bf16_f32 v162, v204, v205
 v_cvt_pk_bf16_f32 v166, v206, v207
 v_mul_f32 v204, v142, v190
 v_mul_f32 v206, v150, v190
 v_fma_f32 v204, -v150, v198, v204
 v_fmac_f32 v206, v142, v198
 v_mul_f32 v205, v143, v191
 v_mul_f32 v207, v151, v191
 v_fma_f32 v205, -v151, v199, v205
 v_fmac_f32 v207, v143, v199
 v_cvt_pk_bf16_f32 v163, v204, v205
 v_cvt_pk_bf16_f32 v167, v206, v207
 s_nop 0
 v_mfma_f32_16x16x32_bf16 v[136:139], v[160:163], a[64:67], 0
 v_mul_f32 v200, v120, v72
 v_mul_f32 v202, v128, v72
 v_mfma_f32_16x16x32_bf16 v[144:147], v[164:167], a[64:67], 0
 v_fma_f32 v200, -v128, v80, v200
 v_fmac_f32 v202, v120, v80
 v_mfma_f32_16x16x32_bf16 v[136:139], v[164:167], a[80:83], v[136:139]
 v_mul_f32 v201, v121, v73
 v_mul_f32 v203, v129, v73
 v_mfma_f32_16x16x32_bf16 v[144:147], v[160:163], a[72:75], v[144:147]
 v_fma_f32 v201, -v129, v81, v201
 v_fmac_f32 v203, v121, v81
 v_mfma_f32_16x16x32_bf16 v[140:143], v[160:163], a[68:71], 0
 v_cvt_pk_bf16_f32 v152, v200, v201
 v_cvt_pk_bf16_f32 v156, v202, v203
 v_mfma_f32_16x16x32_bf16 v[148:151], v[164:167], a[68:71], 0
 v_mul_f32 v200, v122, v74
 v_mul_f32 v202, v130, v74
 v_mfma_f32_16x16x32_bf16 v[140:143], v[164:167], a[84:87], v[140:143]
 v_fma_f32 v200, -v130, v82, v200
 v_fmac_f32 v202, v122, v82
 v_mfma_f32_16x16x32_bf16 v[148:151], v[160:163], a[76:79], v[148:151]
 v_mul_f32 v201, v123, v75
 v_mul_f32 v203, v131, v75
 v_fma_f32 v201, -v131, v83, v201
 v_fmac_f32 v203, v123, v83
 v_cvt_pk_bf16_f32 v153, v200, v201
 v_cvt_pk_bf16_f32 v157, v202, v203
 v_mul_f32 v200, v124, v76
 v_mul_f32 v202, v132, v76
 v_fma_f32 v200, -v132, v84, v200
 v_fmac_f32 v202, v124, v84
 v_mul_f32 v201, v125, v77
 v_mul_f32 v203, v133, v77
 v_fma_f32 v201, -v133, v85, v201
 v_fmac_f32 v203, v125, v85
 v_cvt_pk_bf16_f32 v154, v200, v201
 v_cvt_pk_bf16_f32 v158, v202, v203
 v_mul_f32 v200, v126, v78
 v_mul_f32 v202, v134, v78
 v_fma_f32 v200, -v134, v86, v200
 v_fmac_f32 v202, v126, v86
 v_mul_f32 v201, v127, v79
 v_mul_f32 v203, v135, v79
 v_fma_f32 v201, -v135, v87, v201
 v_fmac_f32 v203, v127, v87
 v_cvt_pk_bf16_f32 v155, v200, v201
 v_cvt_pk_bf16_f32 v159, v202, v203
 ds_write_b64 v7, v[152:153] offset:47104
 ds_write_b64 v7, v[154:155] offset:49152
 ds_write_b64 v7, v[156:157] offset:51200
 ds_write_b64 v7, v[158:159] offset:53248
 v_mul_f32 v204, v136, v72
 v_mul_f32 v206, v144, v72
 v_fma_f32 v204, -v144, v80, v204
 v_fmac_f32 v206, v136, v80
 v_mul_f32 v205, v137, v73
 v_mul_f32 v207, v145, v73
 v_fma_f32 v205, -v145, v81, v205
 v_fmac_f32 v207, v137, v81
 v_cvt_pk_bf16_f32 v160, v204, v205
 v_cvt_pk_bf16_f32 v164, v206, v207
 v_mul_f32 v204, v138, v74
 v_mul_f32 v206, v146, v74
 v_fma_f32 v204, -v146, v82, v204
 v_fmac_f32 v206, v138, v82
 v_mul_f32 v205, v139, v75
 v_mul_f32 v207, v147, v75
 v_fma_f32 v205, -v147, v83, v205
 v_fmac_f32 v207, v139, v83
 v_cvt_pk_bf16_f32 v161, v204, v205
 v_cvt_pk_bf16_f32 v165, v206, v207
 v_mul_f32 v204, v140, v76
 v_mul_f32 v206, v148, v76
 v_fma_f32 v204, -v148, v84, v204
 v_fmac_f32 v206, v140, v84
 v_mul_f32 v205, v141, v77
 v_mul_f32 v207, v149, v77
 v_fma_f32 v205, -v149, v85, v205
 v_fmac_f32 v207, v141, v85
 v_cvt_pk_bf16_f32 v162, v204, v205
 v_cvt_pk_bf16_f32 v166, v206, v207
 v_mul_f32 v204, v142, v78
 v_mul_f32 v206, v150, v78
 v_fma_f32 v204, -v150, v86, v204
 v_fmac_f32 v206, v142, v86
 v_mul_f32 v205, v143, v79
 v_mul_f32 v207, v151, v79
 v_fma_f32 v205, -v151, v87, v205
 v_fmac_f32 v207, v143, v87
 v_cvt_pk_bf16_f32 v163, v204, v205
 v_cvt_pk_bf16_f32 v167, v206, v207
 ds_write_b64 v7, v[160:161] offset:55296
 ds_write_b64 v7, v[162:163] offset:57344
 ds_write_b64 v7, v[164:165] offset:59392
 ds_write_b64 v7, v[166:167] offset:61440
 s_lshl_b32 s3, s26, 11
 v_add_u32 v222, s3, v5
 s_or_b32 s31, s31, 0xffff
 s_waitcnt lgkmcnt(0)
 s_barrier
 ds_read_b128 a[0:3], v222 offset:47104
 ds_read_b128 a[8:11], v222 offset:51200
 ds_read_b128 a[4:7], v222 offset:48128
 ds_read_b128 a[12:15], v222 offset:52224
 ds_read_b128 a[32:35], v222 offset:55296
 ds_read_b128 a[40:43], v222 offset:59392
 ds_read_b128 a[36:39], v222 offset:56320
 ds_read_b128 a[44:47], v222 offset:60416
 s_waitcnt lgkmcnt(7)
 v_mfma_f32_16x16x32_bf16 v[88:91], a[88:91], a[0:3], v[88:91]
 s_waitcnt lgkmcnt(6)
 v_mfma_f32_16x16x32_bf16 v[96:99], a[88:91], a[8:11], v[96:99]
 v_mfma_f32_16x16x32_bf16 v[88:91], a[104:107], a[8:11], v[88:91]
 v_mfma_f32_16x16x32_bf16 v[96:99], a[96:99], a[0:3], v[96:99]
 s_waitcnt lgkmcnt(5)
 v_mfma_f32_16x16x32_bf16 v[88:91], a[92:95], a[4:7], v[88:91]
 s_waitcnt lgkmcnt(4)
 v_mfma_f32_16x16x32_bf16 v[96:99], a[92:95], a[12:15], v[96:99]
 v_mfma_f32_16x16x32_bf16 v[88:91], a[108:111], a[12:15], v[88:91]
 v_mfma_f32_16x16x32_bf16 v[96:99], a[100:103], a[4:7], v[96:99]
 s_waitcnt lgkmcnt(3)
 v_mfma_f32_16x16x32_bf16 v[104:107], a[88:91], a[32:35], v[104:107]
 s_waitcnt lgkmcnt(2)
 v_mfma_f32_16x16x32_bf16 v[112:115], a[88:91], a[40:43], v[112:115]
 v_mfma_f32_16x16x32_bf16 v[104:107], a[104:107], a[40:43], v[104:107]
 v_mfma_f32_16x16x32_bf16 v[112:115], a[96:99], a[32:35], v[112:115]
 s_waitcnt lgkmcnt(1)
 v_mfma_f32_16x16x32_bf16 v[104:107], a[92:95], a[36:39], v[104:107]
 s_waitcnt lgkmcnt(0)
 v_mfma_f32_16x16x32_bf16 v[112:115], a[92:95], a[44:47], v[112:115]
 v_mfma_f32_16x16x32_bf16 v[104:107], a[108:111], a[44:47], v[104:107]
 v_mfma_f32_16x16x32_bf16 v[112:115], a[100:103], a[36:39], v[112:115]
 v_mfma_f32_16x16x32_bf16 v[92:95], a[112:115], a[0:3], v[92:95]
 v_mfma_f32_16x16x32_bf16 v[100:103], a[112:115], a[8:11], v[100:103]
 v_mfma_f32_16x16x32_bf16 v[92:95], a[128:131], a[8:11], v[92:95]
 v_mfma_f32_16x16x32_bf16 v[100:103], a[120:123], a[0:3], v[100:103]
 v_mfma_f32_16x16x32_bf16 v[92:95], a[116:119], a[4:7], v[92:95]
 v_mfma_f32_16x16x32_bf16 v[100:103], a[116:119], a[12:15], v[100:103]
 v_mfma_f32_16x16x32_bf16 v[92:95], a[132:135], a[12:15], v[92:95]
 v_mfma_f32_16x16x32_bf16 v[100:103], a[124:127], a[4:7], v[100:103]
 v_mfma_f32_16x16x32_bf16 v[108:111], a[112:115], a[32:35], v[108:111]
 v_cvt_pk_bf16_f32 v152, v88, v96
 v_bfi_b32 v152, s31, v152, v8
 v_mfma_f32_16x16x32_bf16 v[116:119], a[112:115], a[40:43], v[116:119]
 v_cvt_pk_bf16_f32 v153, v104, v112
 v_min_u32 v152, -2, v152
 v_min_u32 v153, -2, v153
 v_mfma_f32_16x16x32_bf16 v[108:111], a[128:131], a[40:43], v[108:111]
 v_cvt_pk_bf16_f32 v154, v89, v97
 v_bfi_b32 v154, s31, v154, v10
 v_cvt_pk_bf16_f32 v155, v105, v113
 v_mfma_f32_16x16x32_bf16 v[116:119], a[120:123], a[32:35], v[116:119]
 v_min_u32 v154, -2, v154
 v_min_u32 v155, -2, v155
 buffer_store_dwordx4 v[152:155], v4, s[8:11], s33 offen offset:0 sc1
 v_mfma_f32_16x16x32_bf16 v[108:111], a[116:119], a[36:39], v[108:111]
 v_cvt_pk_bf16_f32 v156, v90, v98
 v_bfi_b32 v156, s31, v156, v12
 v_mfma_f32_16x16x32_bf16 v[116:119], a[116:119], a[44:47], v[116:119]
 v_cvt_pk_bf16_f32 v157, v106, v114
 v_min_u32 v156, -2, v156
 v_min_u32 v157, -2, v157
 v_mfma_f32_16x16x32_bf16 v[108:111], a[132:135], a[44:47], v[108:111]
 v_cvt_pk_bf16_f32 v158, v91, v99
 v_bfi_b32 v158, s31, v158, v14
 v_cvt_pk_bf16_f32 v159, v107, v115
 v_mfma_f32_16x16x32_bf16 v[116:119], a[124:127], a[36:39], v[116:119]
 v_min_u32 v158, -2, v158
 v_min_u32 v159, -2, v159
 buffer_store_dwordx4 v[156:159], v4, s[8:11], s33 offen offset:1024 sc1
 v_cvt_pk_bf16_f32 v160, v92, v100
 v_bfi_b32 v160, s31, v160, v16
 s_nop 2
 v_cvt_pk_bf16_f32 v161, v108, v116
 v_min_u32 v160, -2, v160
 v_min_u32 v161, -2, v161
 v_cvt_pk_bf16_f32 v162, v93, v101
 v_bfi_b32 v162, s31, v162, v18
 v_cvt_pk_bf16_f32 v163, v109, v117
 v_min_u32 v162, -2, v162
 v_min_u32 v163, -2, v163
 buffer_store_dwordx4 v[160:163], v4, s[8:11], s33 offen offset:2048 sc1
 v_cvt_pk_bf16_f32 v164, v94, v102
 v_bfi_b32 v164, s31, v164, v20
 v_cvt_pk_bf16_f32 v165, v110, v118
 v_min_u32 v164, -2, v164
 v_min_u32 v165, -2, v165
 v_cvt_pk_bf16_f32 v166, v95, v103
 v_bfi_b32 v166, s31, v166, v22
 v_cvt_pk_bf16_f32 v167, v111, v119
 v_min_u32 v166, -2, v166
 v_min_u32 v167, -2, v167
 buffer_store_dwordx4 v[164:167], v4, s[8:11], s33 offen offset:3072 sc1
 s_cmp_lg_u32 s45, 0
 s_cbranch_scc1 L_kp_kv1
 buffer_load_dwordx4 v4, s[8:11], s61 offen lds
 s_add_u32 s61, s61, 4096
 s_add_u32 m0, m0, 4096
 v_accvgpr_write_b32 a168, v56
 v_accvgpr_write_b32 a169, v57
 v_accvgpr_write_b32 a170, v58
 buffer_load_dwordx4 v4, s[8:11], s61 offen lds
 s_add_u32 s61, s61, 4096
 s_add_u32 m0, m0, 4096
 v_accvgpr_write_b32 a171, v59
 v_accvgpr_write_b32 a172, v60
 v_accvgpr_write_b32 a173, v61
 buffer_load_dwordx4 v4, s[8:11], s61 offen lds
 s_add_u32 s61, s61, 4096
 s_add_u32 m0, m0, 4096
 v_accvgpr_write_b32 a174, v62
 v_accvgpr_write_b32 a175, v63
 v_accvgpr_write_b32 a176, v64
 buffer_load_dwordx4 v4, s[8:11], s61 offen lds
 s_add_u32 s61, s61, 4096
 s_add_u32 m0, m0, 4096
 v_accvgpr_write_b32 a177, v65
 v_accvgpr_write_b32 a178, v66
 v_accvgpr_write_b32 a179, v67
 buffer_load_dwordx4 v4, s[8:11], s61 offen lds
 s_add_u32 s61, s61, 4096
 s_add_u32 m0, m0, 4096
 v_accvgpr_write_b32 a180, v68
 v_accvgpr_write_b32 a181, v69
 v_accvgpr_write_b32 a182, v70
 v_accvgpr_write_b32 a183, v71
 buffer_load_dwordx4 v4, s[8:11], s61 offen lds
 s_add_u32 s61, s61, 4096
 s_add_u32 m0, m0, 4096
 v_accvgpr_write_b32 a184, v72
 v_accvgpr_write_b32 a185, v73
 v_accvgpr_write_b32 a186, v74
 buffer_load_dwordx4 v4, s[8:11], s61 offen lds
 s_add_u32 s61, s61, 4096
 s_add_u32 m0, m0, 4096
 v_accvgpr_write_b32 a187, v75
 v_accvgpr_write_b32 a188, v76
 v_accvgpr_write_b32 a189, v77
 buffer_load_dwordx4 v4, s[8:11], s61 offen lds
 s_add_u32 s61, s61, 4096
 s_add_u32 m0, m0, 4096
 v_accvgpr_write_b32 a190, v78
 v_accvgpr_write_b32 a191, v79
 v_accvgpr_write_b32 a192, v80
 buffer_load_dwordx4 v4, s[8:11], s61 offen lds
 s_add_u32 s61, s61, 4096
 s_add_u32 m0, m0, 4096
 v_accvgpr_write_b32 a193, v81
 v_accvgpr_write_b32 a194, v82
 v_accvgpr_write_b32 a195, v83
 buffer_load_dwordx4 v4, s[8:11], s61 offen lds
 s_add_u32 s61, s61, 4096
 s_add_u32 m0, m0, 4096
 v_accvgpr_write_b32 a196, v84
 v_accvgpr_write_b32 a197, v85
 v_accvgpr_write_b32 a198, v86
 v_accvgpr_write_b32 a199, v87
L_kp_kv1:
 buffer_load_dwordx4 v4, s[8:11], s61 offen lds
 s_add_u32 s61, s61, 4096
 s_add_u32 m0, m0, 4096
 s_nop 0
 buffer_load_dwordx4 v4, s[8:11], s61 offen lds
 s_add_u32 s61, s61, 4096
 s_add_u32 m0, m0, 4096
 s_nop 0
 buffer_load_dwordx4 v4, s[8:11], s61 offen lds
 s_add_u32 s61, s61, 4096
 s_add_u32 m0, m0, 4096
 s_nop 0
 buffer_load_dwordx4 v4, s[8:11], s61 offen lds
 s_add_u32 s61, s61, 4096
 s_add_u32 m0, m0, 4096
 s_nop 0
 buffer_load_dwordx4 v4, s[8:11], s61 offen lds
 s_add_u32 s61, s61, 4096
 s_add_u32 m0, m0, 4096
 s_nop 0
 buffer_load_dwordx4 v4, s[8:11], s61 offen lds
 s_add_u32 s61, s61, 4096
 s_add_u32 m0, m0, 4096
 s_nop 0
 buffer_load_dwordx4 v4, s[8:11], s61 offen lds
 s_add_u32 s61, s61, 4096
 s_add_u32 m0, m0, 4096
 s_nop 0
 buffer_load_dwordx4 v4, s[8:11], s61 offen lds
 s_add_u32 s61, s61, 4096
 s_add_u32 m0, m0, 4096
 s_nop 0
 buffer_load_dwordx4 v4, s[8:11], s61 offen lds
 s_add_u32 s61, s61, 4096
 s_add_u32 m0, m0, 4096
 s_nop 0
 buffer_load_dwordx4 v4, s[8:11], s61 offen lds
 s_add_u32 s61, s61, 4096
 s_add_u32 m0, m0, 4096
 s_nop 0
 buffer_load_dwordx4 v4, s[8:11], s61 offen lds
 s_add_u32 s61, s61, 4096
 s_add_u32 m0, m0, 4096
 s_nop 0
 buffer_load_dwordx4 v4, s[8:11], s61 offen lds
 s_add_u32 s61, s61, 4096
 s_add_u32 m0, m0, 4096
 s_cmp_ge_u32 s20, 2
 s_cbranch_scc1 L_p2_n22
 buffer_load_dwordx4 v4, s[8:11], s61 offen lds
 s_add_u32 s61, s61, 4096
 s_add_u32 m0, m0, 4096
L_p2_n22:
L_kp_p3:
 s_and_b32 s3, s2, 7
 s_lshr_b32 s21, s2, 3
 s_lshr_b32 s22, s3, 1
 s_lshl_b32 s22, s22, 2
 s_and_b32 s23, s21, 3
 s_add_u32 s22, s22, s23
 s_and_b32 s23, s3, 1
 s_lshl_b32 s23, s23, 3
 s_lshr_b32 s21, s21, 2
 s_add_u32 s23, s23, s21
 s_lshl2_add_u32 s24, s22, s20
 s_cmp_eq_u32 s45, 0
 s_mov_b32 s40, 0x940000
 s_mov_b32 s3, 0xe50000
 s_cselect_b32 s40, s40, s3
 s_mov_b32 s41, 0x6f0000
 s_mov_b32 s3, 0x10a0000
 s_cselect_b32 s41, s41, s3
 s_mov_b32 s42, 0xb90000
 s_mov_b32 s3, 0x1540000
 s_cselect_b32 s42, s42, s3
 s_mul_i32 s25, s24, 37376
 s_lshl_b32 s31, s24, 8
 s_add_u32 s26, s31, s40
 s_add_u32 s27, s26, 16640
 v_add_u32 v5, 0x10000, v4
 v_mul_u32_u24 v6, 33280, v3
 v_lshl_add_u32 v6, v2, 4, v6
 v_cmp_eq_u32 vcc, 0, v3
 v_mov_b32 v10, 0xffff
 s_nop 0
 v_cndmask_b32 v10, -1, v10, vcc
 s_mov_b32 s56, 0x3f317218
 s_mov_b32 s57, 0x3f317218
 s_mov_b32 s58, 0x35c1a2a0
 s_mov_b32 s16, s8
 s_mov_b32 s17, s9
 s_cmp_eq_u32 s45, 0
 s_cselect_b32 s18, 0x15a8000, 0
 s_mov_b32 s19, 0x20000
 s_lshl2_add_u32 s28, s2, s20
 s_mul_i32 s28, s28, 10240
 s_add_u32 s28, s28, 0xc00000
 v_mov_b32 v232, -1
 v_mov_b32 v233, -1
 v_mov_b32 v234, -1
 v_mov_b32 v235, -1
 s_cmp_lt_u32 s98, 144
 s_cbranch_scc1 L_p3_gok
 v_mov_b32 v9, 0
 s_mov_b32 s34, 0
 s_mov_b64 exec, 1
L_p3_gate:
 buffer_load_dword v7, v9, s[8:11], s26 offen sc1
 s_waitcnt vmcnt(0)
 v_cmp_eq_u32 vcc, -1, v7
 s_add_u32 s34, s34, 1
 s_cmp_gt_u32 s34, 131072
 s_cbranch_scc1 L_p3_gx
 s_cbranch_vccnz L_p3_gate
L_p3_gx:
 s_mov_b64 exec, -1
L_p3_gok:
 s_mov_b32 s59, 0
 buffer_load_dwordx4 v[16:19], v6, s[8:11], s26 offen sc1
 s_add_u32 s26, s26, 133120
 buffer_load_dwordx4 v[20:23], v6, s[8:11], s27 offen sc1
 s_add_u32 s27, s27, 133120
 buffer_load_dwordx4 v[24:27], v6, s[8:11], s26 offen sc1
 s_add_u32 s26, s26, 133120
 buffer_load_dwordx4 v[28:31], v6, s[8:11], s27 offen sc1
 s_add_u32 s27, s27, 133120
 buffer_load_dwordx4 v[32:35], v6, s[8:11], s26 offen sc1
 s_add_u32 s26, s26, 133120
 buffer_load_dwordx4 v[36:39], v6, s[8:11], s27 offen sc1
 s_add_u32 s27, s27, 133120
 buffer_load_dwordx4 v[40:43], v6, s[8:11], s26 offen sc1
 s_add_u32 s26, s26, 133120
 buffer_load_dwordx4 v[44:47], v6, s[8:11], s27 offen sc1
 s_add_u32 s27, s27, 133120
 buffer_load_dwordx4 v[48:51], v6, s[8:11], s26 offen sc1
 s_add_u32 s26, s26, 133120
 buffer_load_dwordx4 v[52:55], v6, s[8:11], s27 offen sc1
 s_add_u32 s27, s27, 133120
 buffer_load_dwordx4 v[56:59], v6, s[8:11], s26 offen sc1
 s_add_u32 s26, s26, 133120
 buffer_load_dwordx4 v[60:63], v6, s[8:11], s27 offen sc1
 s_add_u32 s27, s27, 133120
 s_waitcnt vmcnt(12)
 s_barrier
 ds_read_b128 a[0:3], v4 offset:0
 ds_read_b128 a[4:7], v4 offset:1024
 ds_read_b128 a[8:11], v4 offset:2048
 ds_read_b128 a[12:15], v4 offset:3072
 ds_read_b128 a[16:19], v5 offset:8192
 s_waitcnt vmcnt(11)
 v_max_u32 v8, v16, v17
 v_max3_u32 v8, v18, v19, v8
 s_waitcnt vmcnt(10)
 v_max3_u32 v8, v20, v21, v8
 v_max3_u32 v8, v22, v23, v8
 v_cmp_eq_u32 vcc, -1, v8
 s_cbranch_vccnz L_p3_f0
L_p3_o0:
 v_swap_b32 v18, v20
 v_swap_b32 v19, v21
 v_and_b32 v224, v10, v16
 v_mov_b32 v225, v17
 v_mov_b32 v226, v18
 v_mov_b32 v227, v19
 v_and_b32 v228, v10, v20
 v_mov_b32 v229, v21
 v_mov_b32 v230, v22
 v_mov_b32 v231, v23
 v_lshlrev_b32 v9, 8, v2
 s_mov_b32 s36, 0x18d0000
 s_waitcnt lgkmcnt(4)
 v_mfma_f32_16x16x32_bf16 v[160:163], v[16:19], a[0:3], 0
 v_mfma_f32_16x16x32_bf16 v[164:167], v[20:23], a[0:3], 0
 ds_read_b128 a[20:23], v4 offset:4096
 s_waitcnt lgkmcnt(4)
 v_mfma_f32_16x16x32_bf16 v[168:171], v[16:19], a[4:7], 0
 ds_read_b128 a[24:27], v4 offset:5120
 v_mfma_f32_16x16x32_bf16 v[172:175], v[20:23], a[4:7], 0
 ds_read_b128 a[28:31], v4 offset:6144
 s_waitcnt lgkmcnt(5)
 v_mfma_f32_16x16x32_bf16 v[176:179], v[16:19], a[8:11], 0
 buffer_load_dwordx4 v[64:67], v6, s[8:11], s26 offen sc1
 s_add_u32 s26, s26, 133120
 v_mfma_f32_16x16x32_bf16 v[180:183], v[20:23], a[8:11], 0
 ds_read_b128 a[32:35], v4 offset:7168
 s_waitcnt lgkmcnt(5)
 v_mfma_f32_16x16x32_bf16 v[184:187], v[16:19], a[12:15], 0
 ds_read_b128 a[36:39], v5 offset:9216
 v_mfma_f32_16x16x32_bf16 v[188:191], v[20:23], a[12:15], 0
 buffer_load_dwordx4 v[68:71], v6, s[8:11], s27 offen sc1
 s_add_u32 s27, s27, 133120
 s_waitcnt lgkmcnt(5)
 v_mfma_f32_16x16x32_bf16 v[192:195], v[16:19], a[16:19], 0
 s_waitcnt vmcnt(11)
 v_max_u32 v8, v24, v25
 v_max3_u32 v8, v26, v27, v8
 s_waitcnt vmcnt(10)
 v_max3_u32 v8, v28, v29, v8
 v_mfma_f32_16x16x32_bf16 v[196:199], v[20:23], a[16:19], 0
 v_max3_u32 v8, v30, v31, v8
 v_cmp_eq_u32 vcc, -1, v8
 s_cbranch_vccnz L_p3_f1
L_p3_o1:
 v_mfma_f32_16x16x32_bf16 v[200:203], v[224:227], v[224:227], 0
 v_swap_b32 v26, v28
 v_swap_b32 v27, v29
 v_mfma_f32_16x16x32_bf16 v[204:207], v[228:231], v[228:231], 0
 s_waitcnt lgkmcnt(4)
 v_mfma_f32_16x16x32_bf16 v[160:163], v[24:27], a[20:23], v[160:163]
 ds_read_b128 a[0:3], v4 offset:8192
 v_mfma_f32_16x16x32_bf16 v[164:167], v[28:31], a[20:23], v[164:167]
 ds_read_b128 a[4:7], v4 offset:9216
 s_waitcnt lgkmcnt(5)
 v_mfma_f32_16x16x32_bf16 v[168:171], v[24:27], a[24:27], v[168:171]
 buffer_load_dwordx4 v[72:75], v6, s[8:11], s26 offen sc1
 s_add_u32 s26, s26, 133120
 v_mfma_f32_16x16x32_bf16 v[172:175], v[28:31], a[24:27], v[172:175]
 ds_read_b128 a[8:11], v4 offset:10240
 s_waitcnt lgkmcnt(5)
 v_mfma_f32_16x16x32_bf16 v[176:179], v[24:27], a[28:31], v[176:179]
 ds_read_b128 a[12:15], v4 offset:11264
 v_mfma_f32_16x16x32_bf16 v[180:183], v[28:31], a[28:31], v[180:183]
 buffer_load_dwordx4 v[76:79], v6, s[8:11], s27 offen sc1
 s_add_u32 s27, s27, 133120
 s_waitcnt lgkmcnt(5)
 v_mfma_f32_16x16x32_bf16 v[184:187], v[24:27], a[32:35], v[184:187]
 ds_read_b128 a[16:19], v5 offset:10240
 v_mfma_f32_16x16x32_bf16 v[188:191], v[28:31], a[32:35], v[188:191]
 buffer_load_dwordx4 v4, s[8:11], s61 offen lds
 s_add_u32 s61, s61, 4096
 s_add_u32 m0, m0, 4096
 s_waitcnt lgkmcnt(5)
 v_mfma_f32_16x16x32_bf16 v[192:195], v[24:27], a[36:39], v[192:195]
 s_waitcnt vmcnt(12)
 v_max_u32 v8, v32, v33
 v_max3_u32 v8, v34, v35, v8
 s_waitcnt vmcnt(11)
 v_max3_u32 v8, v36, v37, v8
 v_mfma_f32_16x16x32_bf16 v[196:199], v[28:31], a[36:39], v[196:199]
 v_max3_u32 v8, v38, v39, v8
 v_cmp_eq_u32 vcc, -1, v8
 s_cbranch_vccnz L_p3_f2
L_p3_o2:
 v_mfma_f32_16x16x32_bf16 v[200:203], v[24:27], v[24:27], v[200:203]
 v_swap_b32 v34, v36
 v_swap_b32 v35, v37
 v_mfma_f32_16x16x32_bf16 v[204:207], v[28:31], v[28:31], v[204:207]
 s_waitcnt lgkmcnt(4)
 v_mfma_f32_16x16x32_bf16 v[160:163], v[32:35], a[0:3], v[160:163]
 ds_read_b128 a[20:23], v4 offset:12288
 v_mfma_f32_16x16x32_bf16 v[164:167], v[36:39], a[0:3], v[164:167]
 ds_read_b128 a[24:27], v4 offset:13312
 s_waitcnt lgkmcnt(5)
 v_mfma_f32_16x16x32_bf16 v[168:171], v[32:35], a[4:7], v[168:171]
 buffer_load_dwordx4 v[80:83], v6, s[8:11], s26 offen sc1
 s_add_u32 s26, s26, 133120
 v_mfma_f32_16x16x32_bf16 v[172:175], v[36:39], a[4:7], v[172:175]
 ds_read_b128 a[28:31], v4 offset:14336
 s_waitcnt lgkmcnt(5)
 v_mfma_f32_16x16x32_bf16 v[176:179], v[32:35], a[8:11], v[176:179]
 ds_read_b128 a[32:35], v4 offset:15360
 v_mfma_f32_16x16x32_bf16 v[180:183], v[36:39], a[8:11], v[180:183]
 buffer_load_dwordx4 v[84:87], v6, s[8:11], s27 offen sc1
 s_add_u32 s27, s27, 133120
 s_waitcnt lgkmcnt(5)
 v_mfma_f32_16x16x32_bf16 v[184:187], v[32:35], a[12:15], v[184:187]
 ds_read_b128 a[36:39], v5 offset:11264
 v_mfma_f32_16x16x32_bf16 v[188:191], v[36:39], a[12:15], v[188:191]
 buffer_store_dwordx4 v[232:235], v4, s[16:19], s28 offen sc1
 s_add_u32 s28, s28, 1024
 s_waitcnt lgkmcnt(5)
 v_mfma_f32_16x16x32_bf16 v[192:195], v[32:35], a[16:19], v[192:195]
 s_waitcnt vmcnt(13)
 v_max_u32 v8, v40, v41
 v_max3_u32 v8, v42, v43, v8
 s_waitcnt vmcnt(12)
 v_max3_u32 v8, v44, v45, v8
 v_mfma_f32_16x16x32_bf16 v[196:199], v[36:39], a[16:19], v[196:199]
 v_max3_u32 v8, v46, v47, v8
 v_cmp_eq_u32 vcc, -1, v8
 s_cbranch_vccnz L_p3_f3
L_p3_o3:
 v_mfma_f32_16x16x32_bf16 v[200:203], v[32:35], v[32:35], v[200:203]
 v_swap_b32 v42, v44
 v_swap_b32 v43, v45
 v_mfma_f32_16x16x32_bf16 v[204:207], v[36:39], v[36:39], v[204:207]
 s_waitcnt lgkmcnt(4)
 v_mfma_f32_16x16x32_bf16 v[160:163], v[40:43], a[20:23], v[160:163]
 ds_read_b128 a[0:3], v4 offset:16384
 v_mfma_f32_16x16x32_bf16 v[164:167], v[44:47], a[20:23], v[164:167]
 ds_read_b128 a[4:7], v4 offset:17408
 s_waitcnt lgkmcnt(5)
 v_mfma_f32_16x16x32_bf16 v[168:171], v[40:43], a[24:27], v[168:171]
 buffer_load_dwordx4 v[88:91], v6, s[8:11], s26 offen sc1
 s_add_u32 s26, s26, 133120
 v_mfma_f32_16x16x32_bf16 v[172:175], v[44:47], a[24:27], v[172:175]
 ds_read_b128 a[8:11], v4 offset:18432
 s_waitcnt lgkmcnt(5)
 v_mfma_f32_16x16x32_bf16 v[176:179], v[40:43], a[28:31], v[176:179]
 ds_read_b128 a[12:15], v4 offset:19456
 v_mfma_f32_16x16x32_bf16 v[180:183], v[44:47], a[28:31], v[180:183]
 buffer_load_dwordx4 v[92:95], v6, s[8:11], s27 offen sc1
 s_add_u32 s27, s27, 133120
 s_waitcnt lgkmcnt(5)
 v_mfma_f32_16x16x32_bf16 v[184:187], v[40:43], a[32:35], v[184:187]
 ds_read_b128 a[16:19], v5 offset:12288
 v_mfma_f32_16x16x32_bf16 v[188:191], v[44:47], a[32:35], v[188:191]
 buffer_load_dwordx4 v4, s[8:11], s61 offen lds
 s_add_u32 s61, s61, 4096
 s_add_u32 m0, m0, 4096
 s_waitcnt lgkmcnt(5)
 v_mfma_f32_16x16x32_bf16 v[192:195], v[40:43], a[36:39], v[192:195]
 s_waitcnt vmcnt(14)
 v_max_u32 v8, v48, v49
 v_max3_u32 v8, v50, v51, v8
 s_waitcnt vmcnt(13)
 v_max3_u32 v8, v52, v53, v8
 v_mfma_f32_16x16x32_bf16 v[196:199], v[44:47], a[36:39], v[196:199]
 v_max3_u32 v8, v54, v55, v8
 v_cmp_eq_u32 vcc, -1, v8
 s_cbranch_vccnz L_p3_f4
L_p3_o4:
 v_mfma_f32_16x16x32_bf16 v[200:203], v[40:43], v[40:43], v[200:203]
 v_swap_b32 v50, v52
 v_swap_b32 v51, v53
 v_mfma_f32_16x16x32_bf16 v[204:207], v[44:47], v[44:47], v[204:207]
 s_waitcnt lgkmcnt(4)
 v_mfma_f32_16x16x32_bf16 v[160:163], v[48:51], a[0:3], v[160:163]
 ds_read_b128 a[20:23], v4 offset:20480
 v_mfma_f32_16x16x32_bf16 v[164:167], v[52:55], a[0:3], v[164:167]
 ds_read_b128 a[24:27], v4 offset:21504
 s_waitcnt lgkmcnt(5)
 v_mfma_f32_16x16x32_bf16 v[168:171], v[48:51], a[4:7], v[168:171]
 buffer_load_dwordx4 v[96:99], v6, s[8:11], s26 offen sc1
 s_add_u32 s26, s26, 133120
 v_mfma_f32_16x16x32_bf16 v[172:175], v[52:55], a[4:7], v[172:175]
 ds_read_b128 a[28:31], v4 offset:22528
 s_waitcnt lgkmcnt(5)
 v_mfma_f32_16x16x32_bf16 v[176:179], v[48:51], a[8:11], v[176:179]
 ds_read_b128 a[32:35], v4 offset:23552
 v_mfma_f32_16x16x32_bf16 v[180:183], v[52:55], a[8:11], v[180:183]
 buffer_load_dwordx4 v[100:103], v6, s[8:11], s27 offen sc1
 s_add_u32 s27, s27, 133120
 s_waitcnt lgkmcnt(5)
 v_mfma_f32_16x16x32_bf16 v[184:187], v[48:51], a[12:15], v[184:187]
 ds_read_b128 a[36:39], v5 offset:13312
 v_mfma_f32_16x16x32_bf16 v[188:191], v[52:55], a[12:15], v[188:191]
 buffer_store_dwordx4 v[232:235], v4, s[16:19], s28 offen sc1
 s_add_u32 s28, s28, 1024
 s_waitcnt lgkmcnt(5)
 v_mfma_f32_16x16x32_bf16 v[192:195], v[48:51], a[16:19], v[192:195]
 s_waitcnt vmcnt(15)
 v_max_u32 v8, v56, v57
 v_max3_u32 v8, v58, v59, v8
 s_waitcnt vmcnt(14)
 v_max3_u32 v8, v60, v61, v8
 v_mfma_f32_16x16x32_bf16 v[196:199], v[52:55], a[16:19], v[196:199]
 v_max3_u32 v8, v62, v63, v8
 v_cmp_eq_u32 vcc, -1, v8
 s_cbranch_vccnz L_p3_f5
L_p3_o5:
 v_mfma_f32_16x16x32_bf16 v[200:203], v[48:51], v[48:51], v[200:203]
 v_swap_b32 v58, v60
 v_swap_b32 v59, v61
 v_mfma_f32_16x16x32_bf16 v[204:207], v[52:55], v[52:55], v[204:207]
 s_waitcnt lgkmcnt(4)
 v_mfma_f32_16x16x32_bf16 v[160:163], v[56:59], a[20:23], v[160:163]
 ds_read_b128 a[0:3], v4 offset:24576
 v_mfma_f32_16x16x32_bf16 v[164:167], v[60:63], a[20:23], v[164:167]
 ds_read_b128 a[4:7], v4 offset:25600
 s_waitcnt lgkmcnt(5)
 v_mfma_f32_16x16x32_bf16 v[168:171], v[56:59], a[24:27], v[168:171]
 buffer_load_dwordx4 v[104:107], v6, s[8:11], s26 offen sc1
 s_add_u32 s26, s26, 133120
 v_mfma_f32_16x16x32_bf16 v[172:175], v[60:63], a[24:27], v[172:175]
 ds_read_b128 a[8:11], v4 offset:26624
 s_waitcnt lgkmcnt(5)
 v_mfma_f32_16x16x32_bf16 v[176:179], v[56:59], a[28:31], v[176:179]
 ds_read_b128 a[12:15], v4 offset:27648
 v_mfma_f32_16x16x32_bf16 v[180:183], v[60:63], a[28:31], v[180:183]
 buffer_load_dwordx4 v[108:111], v6, s[8:11], s27 offen sc1
 s_add_u32 s27, s27, 133120
 s_waitcnt lgkmcnt(5)
 v_mfma_f32_16x16x32_bf16 v[184:187], v[56:59], a[32:35], v[184:187]
 ds_read_b128 a[16:19], v5 offset:14336
 v_mfma_f32_16x16x32_bf16 v[188:191], v[60:63], a[32:35], v[188:191]
 buffer_load_dwordx4 v4, s[8:11], s61 offen lds
 s_add_u32 s61, s61, 4096
 s_add_u32 m0, m0, 4096
 s_waitcnt lgkmcnt(5)
 v_mfma_f32_16x16x32_bf16 v[192:195], v[56:59], a[36:39], v[192:195]
 s_waitcnt vmcnt(16)
 v_max_u32 v8, v64, v65
 v_max3_u32 v8, v66, v67, v8
 s_waitcnt vmcnt(15)
 v_max3_u32 v8, v68, v69, v8
 v_mfma_f32_16x16x32_bf16 v[196:199], v[60:63], a[36:39], v[196:199]
 v_max3_u32 v8, v70, v71, v8
 v_cmp_eq_u32 vcc, -1, v8
 s_cbranch_vccnz L_p3_f6
L_p3_o6:
 v_mfma_f32_16x16x32_bf16 v[200:203], v[56:59], v[56:59], v[200:203]
 v_swap_b32 v66, v68
 v_swap_b32 v67, v69
 v_mfma_f32_16x16x32_bf16 v[204:207], v[60:63], v[60:63], v[204:207]
 s_waitcnt lgkmcnt(4)
 v_mfma_f32_16x16x32_bf16 v[160:163], v[64:67], a[0:3], v[160:163]
 ds_read_b128 a[20:23], v4 offset:28672
 v_mfma_f32_16x16x32_bf16 v[164:167], v[68:71], a[0:3], v[164:167]
 ds_read_b128 a[24:27], v4 offset:29696
 s_waitcnt lgkmcnt(5)
 v_mfma_f32_16x16x32_bf16 v[168:171], v[64:67], a[4:7], v[168:171]
 buffer_load_dwordx4 v[112:115], v6, s[8:11], s26 offen sc1
 s_add_u32 s26, s26, 133120
 v_mfma_f32_16x16x32_bf16 v[172:175], v[68:71], a[4:7], v[172:175]
 ds_read_b128 a[28:31], v4 offset:30720
 s_waitcnt lgkmcnt(5)
 v_mfma_f32_16x16x32_bf16 v[176:179], v[64:67], a[8:11], v[176:179]
 ds_read_b128 a[32:35], v4 offset:31744
 v_mfma_f32_16x16x32_bf16 v[180:183], v[68:71], a[8:11], v[180:183]
 buffer_load_dwordx4 v[116:119], v6, s[8:11], s27 offen sc1
 s_add_u32 s27, s27, 133120
 s_waitcnt lgkmcnt(5)
 v_mfma_f32_16x16x32_bf16 v[184:187], v[64:67], a[12:15], v[184:187]
 ds_read_b128 a[36:39], v5 offset:15360
 v_mfma_f32_16x16x32_bf16 v[188:191], v[68:71], a[12:15], v[188:191]
 buffer_store_dwordx4 v[232:235], v4, s[16:19], s28 offen sc1
 s_add_u32 s28, s28, 1024
 s_waitcnt lgkmcnt(5)
 v_mfma_f32_16x16x32_bf16 v[192:195], v[64:67], a[16:19], v[192:195]
 s_waitcnt vmcnt(17)
 v_max_u32 v8, v72, v73
 v_max3_u32 v8, v74, v75, v8
 s_waitcnt vmcnt(16)
 v_max3_u32 v8, v76, v77, v8
 v_mfma_f32_16x16x32_bf16 v[196:199], v[68:71], a[16:19], v[196:199]
 v_max3_u32 v8, v78, v79, v8
 v_cmp_eq_u32 vcc, -1, v8
 s_cbranch_vccnz L_p3_f7
L_p3_o7:
 v_mfma_f32_16x16x32_bf16 v[200:203], v[64:67], v[64:67], v[200:203]
 v_swap_b32 v74, v76
 v_swap_b32 v75, v77
 v_mfma_f32_16x16x32_bf16 v[204:207], v[68:71], v[68:71], v[204:207]
 s_waitcnt lgkmcnt(4)
 v_mfma_f32_16x16x32_bf16 v[160:163], v[72:75], a[20:23], v[160:163]
 ds_read_b128 a[0:3], v4 offset:32768
 v_mfma_f32_16x16x32_bf16 v[164:167], v[76:79], a[20:23], v[164:167]
 ds_read_b128 a[4:7], v4 offset:33792
 s_waitcnt lgkmcnt(5)
 v_mfma_f32_16x16x32_bf16 v[168:171], v[72:75], a[24:27], v[168:171]
 buffer_load_dwordx4 v[120:123], v6, s[8:11], s26 offen sc1
 s_add_u32 s26, s26, 133120
 v_mfma_f32_16x16x32_bf16 v[172:175], v[76:79], a[24:27], v[172:175]
 ds_read_b128 a[8:11], v4 offset:34816
 s_waitcnt lgkmcnt(5)
 v_mfma_f32_16x16x32_bf16 v[176:179], v[72:75], a[28:31], v[176:179]
 ds_read_b128 a[12:15], v4 offset:35840
 v_mfma_f32_16x16x32_bf16 v[180:183], v[76:79], a[28:31], v[180:183]
 buffer_load_dwordx4 v[124:127], v6, s[8:11], s27 offen sc1
 s_add_u32 s27, s27, 133120
 s_waitcnt lgkmcnt(5)
 v_mfma_f32_16x16x32_bf16 v[184:187], v[72:75], a[32:35], v[184:187]
 ds_read_b128 a[16:19], v5 offset:16384
 v_mfma_f32_16x16x32_bf16 v[188:191], v[76:79], a[32:35], v[188:191]
 buffer_load_dwordx4 v4, s[8:11], s61 offen lds
 s_add_u32 s61, s61, 4096
 s_add_u32 m0, m0, 4096
 s_waitcnt lgkmcnt(5)
 v_mfma_f32_16x16x32_bf16 v[192:195], v[72:75], a[36:39], v[192:195]
 s_waitcnt vmcnt(17)
 v_max_u32 v8, v80, v81
 v_max3_u32 v8, v82, v83, v8
 s_waitcnt vmcnt(16)
 v_max3_u32 v8, v84, v85, v8
 v_mfma_f32_16x16x32_bf16 v[196:199], v[76:79], a[36:39], v[196:199]
 v_max3_u32 v8, v86, v87, v8
 v_cmp_eq_u32 vcc, -1, v8
 s_cbranch_vccnz L_p3_f8
L_p3_o8:
 v_mfma_f32_16x16x32_bf16 v[200:203], v[72:75], v[72:75], v[200:203]
 v_swap_b32 v82, v84
 v_swap_b32 v83, v85
 v_mfma_f32_16x16x32_bf16 v[204:207], v[76:79], v[76:79], v[204:207]
 s_waitcnt lgkmcnt(4)
 v_mfma_f32_16x16x32_bf16 v[160:163], v[80:83], a[0:3], v[160:163]
 ds_read_b128 a[20:23], v4 offset:36864
 v_mfma_f32_16x16x32_bf16 v[164:167], v[84:87], a[0:3], v[164:167]
 ds_read_b128 a[24:27], v4 offset:37888
 s_waitcnt lgkmcnt(5)
 v_mfma_f32_16x16x32_bf16 v[168:171], v[80:83], a[4:7], v[168:171]
 buffer_load_dwordx4 v[128:131], v6, s[8:11], s26 offen sc1
 s_add_u32 s26, s26, 133120
 v_mfma_f32_16x16x32_bf16 v[172:175], v[84:87], a[4:7], v[172:175]
 ds_read_b128 a[28:31], v4 offset:38912
 s_waitcnt lgkmcnt(5)
 v_mfma_f32_16x16x32_bf16 v[176:179], v[80:83], a[8:11], v[176:179]
 ds_read_b128 a[32:35], v4 offset:39936
 v_mfma_f32_16x16x32_bf16 v[180:183], v[84:87], a[8:11], v[180:183]
 buffer_load_dwordx4 v[132:135], v6, s[8:11], s27 offen sc1
 s_add_u32 s27, s27, 133120
 s_waitcnt lgkmcnt(5)
 v_mfma_f32_16x16x32_bf16 v[184:187], v[80:83], a[12:15], v[184:187]
 ds_read_b128 a[36:39], v5 offset:17408
 v_mfma_f32_16x16x32_bf16 v[188:191], v[84:87], a[12:15], v[188:191]
 buffer_store_dwordx4 v[232:235], v4, s[16:19], s28 offen sc1
 s_add_u32 s28, s28, 1024
 s_waitcnt lgkmcnt(5)
 v_mfma_f32_16x16x32_bf16 v[192:195], v[80:83], a[16:19], v[192:195]
 s_waitcnt vmcnt(17)
 v_max_u32 v8, v88, v89
 v_max3_u32 v8, v90, v91, v8
 s_waitcnt vmcnt(16)
 v_max3_u32 v8, v92, v93, v8
 v_mfma_f32_16x16x32_bf16 v[196:199], v[84:87], a[16:19], v[196:199]
 v_max3_u32 v8, v94, v95, v8
 v_cmp_eq_u32 vcc, -1, v8
 s_cbranch_vccnz L_p3_f9
L_p3_o9:
 v_mfma_f32_16x16x32_bf16 v[200:203], v[80:83], v[80:83], v[200:203]
 v_swap_b32 v90, v92
 v_swap_b32 v91, v93
 v_mfma_f32_16x16x32_bf16 v[204:207], v[84:87], v[84:87], v[204:207]
 s_waitcnt lgkmcnt(4)
 v_mfma_f32_16x16x32_bf16 v[160:163], v[88:91], a[20:23], v[160:163]
 ds_read_b128 a[0:3], v4 offset:40960
 v_mfma_f32_16x16x32_bf16 v[164:167], v[92:95], a[20:23], v[164:167]
 ds_read_b128 a[4:7], v4 offset:41984
 s_waitcnt lgkmcnt(5)
 v_mfma_f32_16x16x32_bf16 v[168:171], v[88:91], a[24:27], v[168:171]
 buffer_load_dwordx4 v[136:139], v6, s[8:11], s26 offen sc1
 s_add_u32 s26, s26, 133120
 v_mfma_f32_16x16x32_bf16 v[172:175], v[92:95], a[24:27], v[172:175]
 ds_read_b128 a[8:11], v4 offset:43008
 s_waitcnt lgkmcnt(5)
 v_mfma_f32_16x16x32_bf16 v[176:179], v[88:91], a[28:31], v[176:179]
 ds_read_b128 a[12:15], v4 offset:44032
 v_mfma_f32_16x16x32_bf16 v[180:183], v[92:95], a[28:31], v[180:183]
 buffer_load_dwordx4 v[140:143], v6, s[8:11], s27 offen sc1
 s_add_u32 s27, s27, 133120
 s_waitcnt lgkmcnt(5)
 v_mfma_f32_16x16x32_bf16 v[184:187], v[88:91], a[32:35], v[184:187]
 ds_read_b128 a[16:19], v5 offset:18432
 v_mfma_f32_16x16x32_bf16 v[188:191], v[92:95], a[32:35], v[188:191]
 buffer_load_dwordx4 v4, s[8:11], s61 offen lds
 s_add_u32 s61, s61, 4096
 s_add_u32 m0, m0, 4096
 s_waitcnt lgkmcnt(5)
 v_mfma_f32_16x16x32_bf16 v[192:195], v[88:91], a[36:39], v[192:195]
 s_waitcnt vmcnt(17)
 v_max_u32 v8, v96, v97
 v_max3_u32 v8, v98, v99, v8
 s_waitcnt vmcnt(16)
 v_max3_u32 v8, v100, v101, v8
 v_mfma_f32_16x16x32_bf16 v[196:199], v[92:95], a[36:39], v[196:199]
 v_max3_u32 v8, v102, v103, v8
 v_cmp_eq_u32 vcc, -1, v8
 s_cbranch_vccnz L_p3_f10
L_p3_o10:
 v_mfma_f32_16x16x32_bf16 v[200:203], v[88:91], v[88:91], v[200:203]
 v_swap_b32 v98, v100
 v_swap_b32 v99, v101
 v_mfma_f32_16x16x32_bf16 v[204:207], v[92:95], v[92:95], v[204:207]
 s_waitcnt lgkmcnt(4)
 v_mfma_f32_16x16x32_bf16 v[160:163], v[96:99], a[0:3], v[160:163]
 ds_read_b128 a[20:23], v4 offset:45056
 v_mfma_f32_16x16x32_bf16 v[164:167], v[100:103], a[0:3], v[164:167]
 ds_read_b128 a[24:27], v4 offset:46080
 s_waitcnt lgkmcnt(5)
 v_mfma_f32_16x16x32_bf16 v[168:171], v[96:99], a[4:7], v[168:171]
 buffer_load_dwordx4 v[144:147], v6, s[8:11], s26 offen sc1
 s_add_u32 s26, s26, 133120
 v_mfma_f32_16x16x32_bf16 v[172:175], v[100:103], a[4:7], v[172:175]
 ds_read_b128 a[28:31], v4 offset:47104
 s_waitcnt lgkmcnt(5)
 v_mfma_f32_16x16x32_bf16 v[176:179], v[96:99], a[8:11], v[176:179]
 ds_read_b128 a[32:35], v4 offset:48128
 v_mfma_f32_16x16x32_bf16 v[180:183], v[100:103], a[8:11], v[180:183]
 buffer_load_dwordx4 v[148:151], v6, s[8:11], s27 offen sc1
 s_add_u32 s27, s27, 133120
 s_waitcnt lgkmcnt(5)
 v_mfma_f32_16x16x32_bf16 v[184:187], v[96:99], a[12:15], v[184:187]
 ds_read_b128 a[36:39], v5 offset:19456
 v_mfma_f32_16x16x32_bf16 v[188:191], v[100:103], a[12:15], v[188:191]
 buffer_store_dwordx4 v[232:235], v4, s[16:19], s28 offen sc1
 s_add_u32 s28, s28, 1024
 s_waitcnt lgkmcnt(5)
 v_mfma_f32_16x16x32_bf16 v[192:195], v[96:99], a[16:19], v[192:195]
 s_waitcnt vmcnt(17)
 v_max_u32 v8, v104, v105
 v_max3_u32 v8, v106, v107, v8
 s_waitcnt vmcnt(16)
 v_max3_u32 v8, v108, v109, v8
 v_mfma_f32_16x16x32_bf16 v[196:199], v[100:103], a[16:19], v[196:199]
 v_max3_u32 v8, v110, v111, v8
 v_cmp_eq_u32 vcc, -1, v8
 s_cbranch_vccnz L_p3_f11
L_p3_o11:
 v_mfma_f32_16x16x32_bf16 v[200:203], v[96:99], v[96:99], v[200:203]
 v_swap_b32 v106, v108
 v_swap_b32 v107, v109
 v_mfma_f32_16x16x32_bf16 v[204:207], v[100:103], v[100:103], v[204:207]
 s_waitcnt lgkmcnt(4)
 v_mfma_f32_16x16x32_bf16 v[160:163], v[104:107], a[20:23], v[160:163]
 ds_read_b128 a[0:3], v4 offset:49152
 v_mfma_f32_16x16x32_bf16 v[164:167], v[108:111], a[20:23], v[164:167]
 ds_read_b128 a[4:7], v4 offset:50176
 s_waitcnt lgkmcnt(5)
 v_mfma_f32_16x16x32_bf16 v[168:171], v[104:107], a[24:27], v[168:171]
 buffer_load_dwordx4 v[152:155], v6, s[8:11], s26 offen sc1
 s_add_u32 s26, s26, 133120
 v_mfma_f32_16x16x32_bf16 v[172:175], v[108:111], a[24:27], v[172:175]
 ds_read_b128 a[8:11], v4 offset:51200
 s_waitcnt lgkmcnt(5)
 v_mfma_f32_16x16x32_bf16 v[176:179], v[104:107], a[28:31], v[176:179]
 buffer_load_dwordx4 v[156:159], v6, s[8:11], s27 offen sc1
 s_add_u32 s27, s27, 133120
 v_mfma_f32_16x16x32_bf16 v[180:183], v[108:111], a[28:31], v[180:183]
 ds_read_b128 a[12:15], v4 offset:52224
 s_waitcnt lgkmcnt(5)
 v_mfma_f32_16x16x32_bf16 v[184:187], v[104:107], a[32:35], v[184:187]
 buffer_load_dwordx4 v4, s[8:11], s61 offen lds
 s_add_u32 s61, s61, 4096
 s_add_u32 m0, m0, 4096
 v_mfma_f32_16x16x32_bf16 v[188:191], v[108:111], a[32:35], v[188:191]
 ds_read_b128 a[16:19], v5 offset:20480
 buffer_load_dword v7, v9, s[8:11], s36 offen sc1
 s_waitcnt lgkmcnt(5)
 v_mfma_f32_16x16x32_bf16 v[192:195], v[104:107], a[36:39], v[192:195]
 s_waitcnt vmcnt(18)
 v_max_u32 v8, v112, v113
 v_max3_u32 v8, v114, v115, v8
 s_waitcnt vmcnt(17)
 v_max3_u32 v8, v116, v117, v8
 v_mfma_f32_16x16x32_bf16 v[196:199], v[108:111], a[36:39], v[196:199]
 v_max3_u32 v8, v118, v119, v8
 v_cmp_eq_u32 vcc, -1, v8
 s_cbranch_vccnz L_p3_f12
L_p3_o12:
 v_mfma_f32_16x16x32_bf16 v[200:203], v[104:107], v[104:107], v[200:203]
 v_swap_b32 v114, v116
 v_swap_b32 v115, v117
 v_mfma_f32_16x16x32_bf16 v[204:207], v[108:111], v[108:111], v[204:207]
 s_waitcnt lgkmcnt(4)
 v_mfma_f32_16x16x32_bf16 v[160:163], v[112:115], a[0:3], v[160:163]
 v_mfma_f32_16x16x32_bf16 v[164:167], v[116:119], a[0:3], v[164:167]
 ds_read_b128 a[20:23], v4 offset:53248
 s_waitcnt lgkmcnt(4)
 v_mfma_f32_16x16x32_bf16 v[168:171], v[112:115], a[4:7], v[168:171]
 ds_read_b128 a[24:27], v4 offset:54272
 v_mfma_f32_16x16x32_bf16 v[172:175], v[116:119], a[4:7], v[172:175]
 ds_read_b128 a[28:31], v4 offset:55296
 s_waitcnt lgkmcnt(5)
 v_mfma_f32_16x16x32_bf16 v[176:179], v[112:115], a[8:11], v[176:179]
 v_mfma_f32_16x16x32_bf16 v[180:183], v[116:119], a[8:11], v[180:183]
 ds_read_b128 a[32:35], v4 offset:56320
 s_waitcnt lgkmcnt(5)
 v_mfma_f32_16x16x32_bf16 v[184:187], v[112:115], a[12:15], v[184:187]
 ds_read_b128 a[36:39], v5 offset:21504
 v_mfma_f32_16x16x32_bf16 v[188:191], v[116:119], a[12:15], v[188:191]
 buffer_store_dwordx4 v[232:235], v4, s[16:19], s28 offen sc1
 s_add_u32 s28, s28, 1024
 s_waitcnt lgkmcnt(5)
 v_mfma_f32_16x16x32_bf16 v[192:195], v[112:115], a[16:19], v[192:195]
 s_waitcnt vmcnt(16)
 v_max_u32 v8, v120, v121
 v_max3_u32 v8, v122, v123, v8
 s_waitcnt vmcnt(15)
 v_max3_u32 v8, v124, v125, v8
 v_mfma_f32_16x16x32_bf16 v[196:199], v[116:119], a[16:19], v[196:199]
 v_max3_u32 v8, v126, v127, v8
 v_cmp_eq_u32 vcc, -1, v8
 s_cbranch_vccnz L_p3_f13
L_p3_o13:
 v_mfma_f32_16x16x32_bf16 v[200:203], v[112:115], v[112:115], v[200:203]
 v_swap_b32 v122, v124
 v_swap_b32 v123, v125
 v_mfma_f32_16x16x32_bf16 v[204:207], v[116:119], v[116:119], v[204:207]
 s_waitcnt lgkmcnt(4)
 v_mfma_f32_16x16x32_bf16 v[160:163], v[120:123], a[20:23], v[160:163]
 v_mfma_f32_16x16x32_bf16 v[164:167], v[124:127], a[20:23], v[164:167]
 ds_read_b128 a[0:3], v4 offset:57344
 s_waitcnt lgkmcnt(4)
 v_mfma_f32_16x16x32_bf16 v[168:171], v[120:123], a[24:27], v[168:171]
 ds_read_b128 a[4:7], v4 offset:58368
 v_mfma_f32_16x16x32_bf16 v[172:175], v[124:127], a[24:27], v[172:175]
 ds_read_b128 a[8:11], v4 offset:59392
 s_waitcnt lgkmcnt(5)
 v_mfma_f32_16x16x32_bf16 v[176:179], v[120:123], a[28:31], v[176:179]
 buffer_load_dwordx4 v4, s[8:11], s61 offen lds
 s_add_u32 s61, s61, 4096
 s_add_u32 m0, m0, 4096
 v_mfma_f32_16x16x32_bf16 v[180:183], v[124:127], a[28:31], v[180:183]
 ds_read_b128 a[12:15], v4 offset:60416
 s_waitcnt lgkmcnt(5)
 v_mfma_f32_16x16x32_bf16 v[184:187], v[120:123], a[32:35], v[184:187]
 ds_read_b128 a[16:19], v5 offset:22528
 v_mfma_f32_16x16x32_bf16 v[188:191], v[124:127], a[32:35], v[188:191]
 buffer_store_dwordx4 v[232:235], v4, s[16:19], s28 offen sc1
 s_add_u32 s28, s28, 1024
 s_waitcnt lgkmcnt(5)
 v_mfma_f32_16x16x32_bf16 v[192:195], v[120:123], a[36:39], v[192:195]
 s_waitcnt vmcnt(15)
 v_max_u32 v8, v128, v129
 v_max3_u32 v8, v130, v131, v8
 s_waitcnt vmcnt(14)
 v_max3_u32 v8, v132, v133, v8
 v_mfma_f32_16x16x32_bf16 v[196:199], v[124:127], a[36:39], v[196:199]
 v_max3_u32 v8, v134, v135, v8
 v_cmp_eq_u32 vcc, -1, v8
 s_cbranch_vccnz L_p3_f14
L_p3_o14:
 v_mfma_f32_16x16x32_bf16 v[200:203], v[120:123], v[120:123], v[200:203]
 v_swap_b32 v130, v132
 v_swap_b32 v131, v133
 v_mfma_f32_16x16x32_bf16 v[204:207], v[124:127], v[124:127], v[204:207]
 s_waitcnt lgkmcnt(4)
 v_mfma_f32_16x16x32_bf16 v[160:163], v[128:131], a[0:3], v[160:163]
 v_mfma_f32_16x16x32_bf16 v[164:167], v[132:135], a[0:3], v[164:167]
 ds_read_b128 a[20:23], v4 offset:61440
 s_waitcnt lgkmcnt(4)
 v_mfma_f32_16x16x32_bf16 v[168:171], v[128:131], a[4:7], v[168:171]
 ds_read_b128 a[24:27], v4 offset:62464
 v_mfma_f32_16x16x32_bf16 v[172:175], v[132:135], a[4:7], v[172:175]
 ds_read_b128 a[28:31], v4 offset:63488
 s_waitcnt lgkmcnt(5)
 v_mfma_f32_16x16x32_bf16 v[176:179], v[128:131], a[8:11], v[176:179]
 v_mfma_f32_16x16x32_bf16 v[180:183], v[132:135], a[8:11], v[180:183]
 ds_read_b128 a[32:35], v4 offset:64512
 s_waitcnt lgkmcnt(5)
 v_mfma_f32_16x16x32_bf16 v[184:187], v[128:131], a[12:15], v[184:187]
 ds_read_b128 a[36:39], v5 offset:23552
 v_mfma_f32_16x16x32_bf16 v[188:191], v[132:135], a[12:15], v[188:191]
 buffer_store_dwordx4 v[232:235], v4, s[16:19], s28 offen sc1
 s_add_u32 s28, s28, 1024
 s_waitcnt lgkmcnt(5)
 v_mfma_f32_16x16x32_bf16 v[192:195], v[128:131], a[16:19], v[192:195]
 s_waitcnt vmcnt(13)
 v_max_u32 v8, v136, v137
 v_max3_u32 v8, v138, v139, v8
 s_waitcnt vmcnt(12)
 v_max3_u32 v8, v140, v141, v8
 v_mfma_f32_16x16x32_bf16 v[196:199], v[132:135], a[16:19], v[196:199]
 v_max3_u32 v8, v142, v143, v8
 v_cmp_eq_u32 vcc, -1, v8
 s_cbranch_vccnz L_p3_f15
L_p3_o15:
 v_mfma_f32_16x16x32_bf16 v[200:203], v[128:131], v[128:131], v[200:203]
 v_swap_b32 v138, v140
 v_swap_b32 v139, v141
 v_mfma_f32_16x16x32_bf16 v[204:207], v[132:135], v[132:135], v[204:207]
 s_waitcnt lgkmcnt(4)
 v_mfma_f32_16x16x32_bf16 v[160:163], v[136:139], a[20:23], v[160:163]
 v_mfma_f32_16x16x32_bf16 v[164:167], v[140:143], a[20:23], v[164:167]
 ds_read_b128 a[0:3], v5 offset:0
 s_waitcnt lgkmcnt(4)
 v_mfma_f32_16x16x32_bf16 v[168:171], v[136:139], a[24:27], v[168:171]
 ds_read_b128 a[4:7], v5 offset:1024
 v_mfma_f32_16x16x32_bf16 v[172:175], v[140:143], a[24:27], v[172:175]
 ds_read_b128 a[8:11], v5 offset:2048
 s_waitcnt lgkmcnt(5)
 v_mfma_f32_16x16x32_bf16 v[176:179], v[136:139], a[28:31], v[176:179]
 buffer_load_dwordx4 v4, s[8:11], s61 offen lds
 s_add_u32 s61, s61, 4096
 s_add_u32 m0, m0, 4096
 v_mfma_f32_16x16x32_bf16 v[180:183], v[140:143], a[28:31], v[180:183]
 ds_read_b128 a[12:15], v5 offset:3072
 s_waitcnt lgkmcnt(5)
 v_mfma_f32_16x16x32_bf16 v[184:187], v[136:139], a[32:35], v[184:187]
 ds_read_b128 a[16:19], v5 offset:24576
 v_mfma_f32_16x16x32_bf16 v[188:191], v[140:143], a[32:35], v[188:191]
 buffer_store_dwordx4 v[232:235], v4, s[16:19], s28 offen sc1
 s_add_u32 s28, s28, 1024
 s_waitcnt lgkmcnt(5)
 v_mfma_f32_16x16x32_bf16 v[192:195], v[136:139], a[36:39], v[192:195]
 s_waitcnt vmcnt(12)
 v_max_u32 v8, v144, v145
 v_max3_u32 v8, v146, v147, v8
 s_waitcnt vmcnt(11)
 v_max3_u32 v8, v148, v149, v8
 v_mfma_f32_16x16x32_bf16 v[196:199], v[140:143], a[36:39], v[196:199]
 v_max3_u32 v8, v150, v151, v8
 v_cmp_eq_u32 vcc, -1, v8
 s_cbranch_vccnz L_p3_f16
L_p3_o16:
 v_mfma_f32_16x16x32_bf16 v[200:203], v[136:139], v[136:139], v[200:203]
 v_swap_b32 v146, v148
 v_swap_b32 v147, v149
 v_mfma_f32_16x16x32_bf16 v[204:207], v[140:143], v[140:143], v[204:207]
 s_waitcnt lgkmcnt(4)
 v_mfma_f32_16x16x32_bf16 v[160:163], v[144:147], a[0:3], v[160:163]
 v_mfma_f32_16x16x32_bf16 v[164:167], v[148:151], a[0:3], v[164:167]
 ds_read_b128 a[20:23], v5 offset:4096
 s_waitcnt lgkmcnt(4)
 v_mfma_f32_16x16x32_bf16 v[168:171], v[144:147], a[4:7], v[168:171]
 ds_read_b128 a[24:27], v5 offset:5120
 v_mfma_f32_16x16x32_bf16 v[172:175], v[148:151], a[4:7], v[172:175]
 ds_read_b128 a[28:31], v5 offset:6144
 s_waitcnt lgkmcnt(5)
 v_mfma_f32_16x16x32_bf16 v[176:179], v[144:147], a[8:11], v[176:179]
 v_mfma_f32_16x16x32_bf16 v[180:183], v[148:151], a[8:11], v[180:183]
 ds_read_b128 a[32:35], v5 offset:7168
 s_waitcnt lgkmcnt(5)
 v_mfma_f32_16x16x32_bf16 v[184:187], v[144:147], a[12:15], v[184:187]
 ds_read_b128 a[36:39], v5 offset:25600
 v_mfma_f32_16x16x32_bf16 v[188:191], v[148:151], a[12:15], v[188:191]
 buffer_store_dwordx4 v[232:235], v4, s[16:19], s28 offen sc1
 s_add_u32 s28, s28, 1024
 s_waitcnt lgkmcnt(5)
 v_mfma_f32_16x16x32_bf16 v[192:195], v[144:147], a[16:19], v[192:195]
 s_waitcnt vmcnt(10)
 v_max_u32 v8, v152, v153
 v_max3_u32 v8, v154, v155, v8
 s_waitcnt vmcnt(9)
 v_max3_u32 v8, v156, v157, v8
 v_mfma_f32_16x16x32_bf16 v[196:199], v[148:151], a[16:19], v[196:199]
 v_max3_u32 v8, v158, v159, v8
 v_cmp_eq_u32 vcc, -1, v8
 s_cbranch_vccnz L_p3_f17
L_p3_o17:
 v_mfma_f32_16x16x32_bf16 v[200:203], v[144:147], v[144:147], v[200:203]
 v_swap_b32 v154, v156
 v_swap_b32 v155, v157
 v_mfma_f32_16x16x32_bf16 v[204:207], v[148:151], v[148:151], v[204:207]
 s_waitcnt lgkmcnt(4)
 v_mfma_f32_16x16x32_bf16 v[160:163], v[152:155], a[20:23], v[160:163]
 v_mfma_f32_16x16x32_bf16 v[164:167], v[156:159], a[20:23], v[164:167]
 s_waitcnt lgkmcnt(3)
 v_mfma_f32_16x16x32_bf16 v[168:171], v[152:155], a[24:27], v[168:171]
 v_mfma_f32_16x16x32_bf16 v[172:175], v[156:159], a[24:27], v[172:175]
 s_waitcnt lgkmcnt(2)
 v_mfma_f32_16x16x32_bf16 v[176:179], v[152:155], a[28:31], v[176:179]
 v_mfma_f32_16x16x32_bf16 v[180:183], v[156:159], a[28:31], v[180:183]
 s_waitcnt lgkmcnt(1)
 v_mfma_f32_16x16x32_bf16 v[184:187], v[152:155], a[32:35], v[184:187]
 v_mfma_f32_16x16x32_bf16 v[188:191], v[156:159], a[32:35], v[188:191]
 buffer_load_dwordx4 v4, s[8:11], s61 offen lds
 s_add_u32 s61, s61, 4096
 s_add_u32 m0, m0, 4096
 s_waitcnt lgkmcnt(0)
 v_mfma_f32_16x16x32_bf16 v[192:195], v[152:155], a[36:39], v[192:195]
 v_mfma_f32_16x16x32_bf16 v[196:199], v[156:159], a[36:39], v[196:199]
 v_mfma_f32_16x16x32_bf16 v[200:203], v[152:155], v[152:155], v[200:203]
 v_mfma_f32_16x16x32_bf16 v[204:207], v[156:159], v[156:159], v[204:207]
 v_and_b32 v13, 3, v2
 v_cmp_eq_u32 s[46:47], 1, v13
 v_cmp_eq_u32 s[48:49], 2, v13
 v_cmp_eq_u32 s[50:51], 3, v13
 v_lshrrev_b32 v12, 2, v2
 v_cmp_eq_u32 s[52:53], v12, v3
 v_mov_b32 v11, 1.0
 s_mov_b32 s32, 0x3ae38e39
 v_mov_b32 v12, 0x3727c5ac
 v_mov_b32 v13, 0x3fb8aa3b
 v_cndmask_b32 v14, v200, v201, s[46:47]
 v_cndmask_b32 v14, v14, v202, s[48:49]
 v_cndmask_b32 v14, v14, v203, s[50:51]
 v_fma_f32 v14, v14, s32, v12
 v_rsq_f32 v14, v14
 s_nop 0
 v_cndmask_b32 v14, 0, v14, s[52:53]
 v_cndmask_b32 v15, v204, v205, s[46:47]
 v_cndmask_b32 v15, v15, v206, s[48:49]
 v_cndmask_b32 v15, v15, v207, s[50:51]
 v_fma_f32 v15, v15, s32, v12
 v_rsq_f32 v15, v15
 s_nop 0
 v_cndmask_b32 v15, 0, v15, s[52:53]
 v_mfma_f32_16x16x4_f32 v[208:211], v14, v11, 0
 s_nop 0
 v_mfma_f32_16x16x4_f32 v[212:215], v15, v11, 0
 v_mfma_f32_16x16x4_f32 v[216:219], v14, v13, 0
 v_mfma_f32_16x16x4_f32 v[220:223], v15, v13, 0
 v_mfma_f32_16x16x4_f32 v[224:227], v13, v14, 0
 v_mfma_f32_16x16x4_f32 v[228:231], v13, v15, 0
 v_cmp_lt_u32 s[46:47], 7, v2
 v_cmp_gt_u32 s[48:49], 4, v2
 v_and_b32 v13, 10, v2
 v_cmp_eq_u32 s[50:51], 2, v13
 v_cmp_eq_u32 s[52:53], 2, v3
 v_cmp_eq_u32 s[54:55], 3, v3
 s_mov_b32 s34, 0
L_p3_jchk:
 s_waitcnt vmcnt(8)
 v_cmp_gt_u32 vcc, 7, v7
 s_cbranch_vccz L_p3_jok
 s_add_u32 s34, s34, 1
 s_cmp_gt_u32 s34, 131072
 s_cbranch_scc1 L_p3_jok
 buffer_load_dword v7, v9, s[8:11], s36 offen sc1
 s_waitcnt vmcnt(0)
 s_branch L_p3_jchk
L_p3_jok:
 s_lshr_b32 s3, s2, 5
 s_mul_i32 s61, s3, 92160
 s_lshl_b32 s3, s20, 10
 s_add_u32 s61, s61, s3
 s_mov_b32 m0, s3
 s_mul_i32 s62, s23, 55296
 s_add_u32 s62, s62, s3
 s_add_u32 s62, s62, 0x1780000
 s_add_u32 s63, s3, 92160
 s_cmp_eq_u32 s45, 0
 s_mov_b32 s3, 0x16c0000
 s_cselect_b32 s3, 0x1600000, s3
 s_cselect_b32 s18, 0, s10
 s_add_u32 s61, s61, s3
 v_mov_b32 v252, v224
 v_mov_b32 v254, v228
 v_pk_mul_f32 v[176:177], v[176:177], v[208:209]
 v_cvt_pk_bf16_f32 v240, v176, v177
 v_pk_mul_f32 v[178:179], v[178:179], v[210:211]
 v_cvt_pk_bf16_f32 v241, v178, v179
 v_pk_mul_f32 v[180:181], v[180:181], v[212:213]
 v_cvt_pk_bf16_f32 v242, v180, v181
 v_pk_mul_f32 v[182:183], v[182:183], v[214:215]
 v_cvt_pk_bf16_f32 v243, v182, v183
 v_pk_mul_f32 v[160:161], v[160:161], v[216:217]
 v_exp_f32_e64 v224, v160 clamp
 v_exp_f32_e64 v225, v161 clamp
 v_max_f32 v160, s58, v160
 v_max_f32 v161, s58, v161
 v_pk_fma_f32 v[160:161], v[160:161], s[56:57], v[224:225]
 v_cvt_pk_bf16_f32 v232, v160, v161
 v_pk_mul_f32 v[162:163], v[162:163], v[218:219]
 v_exp_f32_e64 v226, v162 clamp
 v_exp_f32_e64 v227, v163 clamp
 v_max_f32 v162, s58, v162
 v_max_f32 v163, s58, v163
 v_pk_fma_f32 v[162:163], v[162:163], s[56:57], v[226:227]
 v_cvt_pk_bf16_f32 v233, v162, v163
 v_pk_mul_f32 v[164:165], v[164:165], v[220:221]
 v_exp_f32_e64 v224, v164 clamp
 v_exp_f32_e64 v225, v165 clamp
 v_max_f32 v164, s58, v164
 v_max_f32 v165, s58, v165
 v_pk_fma_f32 v[164:165], v[164:165], s[56:57], v[224:225]
 v_cvt_pk_bf16_f32 v234, v164, v165
 v_pk_mul_f32 v[166:167], v[166:167], v[222:223]
 v_exp_f32_e64 v226, v166 clamp
 v_exp_f32_e64 v227, v167 clamp
 v_max_f32 v166, s58, v166
 v_max_f32 v167, s58, v167
 v_pk_fma_f32 v[166:167], v[166:167], s[56:57], v[226:227]
 v_cvt_pk_bf16_f32 v235, v166, v167
 v_pk_mul_f32 v[228:229], v[192:193], v[216:217]
 v_exp_f32_e64 v224, v228 clamp
 v_exp_f32_e64 v225, v229 clamp
 v_max_f32 v228, s58, v228
 v_max_f32 v229, s58, v229
 v_pk_fma_f32 v[228:229], v[228:229], s[56:57], v[224:225]
 v_pk_mul_f32 v[192:193], v[192:193], v[208:209]
 v_cndmask_b32 v192, v192, v228, s[46:47]
 v_cndmask_b32 v192, v192, 1.0, s[50:51]
 v_cndmask_b32 v193, v193, v229, s[46:47]
 v_cndmask_b32 v193, v193, 1.0, s[50:51]
 v_cvt_pk_bf16_f32 v248, v192, v193
 v_pk_mul_f32 v[228:229], v[194:195], v[218:219]
 v_exp_f32_e64 v226, v228 clamp
 v_exp_f32_e64 v227, v229 clamp
 v_max_f32 v228, s58, v228
 v_max_f32 v229, s58, v229
 v_pk_fma_f32 v[228:229], v[228:229], s[56:57], v[226:227]
 v_pk_mul_f32 v[194:195], v[194:195], v[210:211]
 v_cndmask_b32 v194, v194, v228, s[46:47]
 v_cndmask_b32 v194, v194, 1.0, s[50:51]
 v_cndmask_b32 v195, v195, v229, s[46:47]
 v_cndmask_b32 v195, v195, 1.0, s[50:51]
 v_cvt_pk_bf16_f32 v249, v194, v195
 v_pk_mul_f32 v[228:229], v[196:197], v[220:221]
 v_exp_f32_e64 v224, v228 clamp
 v_exp_f32_e64 v225, v229 clamp
 v_max_f32 v228, s58, v228
 v_max_f32 v229, s58, v229
 v_pk_fma_f32 v[228:229], v[228:229], s[56:57], v[224:225]
 v_pk_mul_f32 v[196:197], v[196:197], v[212:213]
 v_cndmask_b32 v196, v196, v228, s[46:47]
 v_cndmask_b32 v196, v196, 1.0, s[50:51]
 v_cndmask_b32 v197, v197, v229, s[46:47]
 v_cndmask_b32 v197, v197, 1.0, s[50:51]
 v_cvt_pk_bf16_f32 v250, v196, v197
 v_pk_mul_f32 v[228:229], v[198:199], v[222:223]
 v_exp_f32_e64 v226, v228 clamp
 v_exp_f32_e64 v227, v229 clamp
 v_max_f32 v228, s58, v228
 v_max_f32 v229, s58, v229
 v_pk_fma_f32 v[228:229], v[228:229], s[56:57], v[226:227]
 v_pk_mul_f32 v[198:199], v[198:199], v[214:215]
 v_cndmask_b32 v198, v198, v228, s[46:47]
 v_cndmask_b32 v198, v198, 1.0, s[50:51]
 v_cndmask_b32 v199, v199, v229, s[46:47]
 v_cndmask_b32 v199, v199, 1.0, s[50:51]
 v_cvt_pk_bf16_f32 v251, v198, v199
 v_pk_mul_f32 v[184:185], v[184:185], v[208:209]
 v_cvt_pk_bf16_f32 v244, v184, v185
 v_pk_mul_f32 v[186:187], v[186:187], v[210:211]
 v_cvt_pk_bf16_f32 v245, v186, v187
 v_pk_mul_f32 v[188:189], v[188:189], v[212:213]
 v_cvt_pk_bf16_f32 v246, v188, v189
 v_pk_mul_f32 v[190:191], v[190:191], v[214:215]
 v_cvt_pk_bf16_f32 v247, v190, v191
 v_pk_mul_f32 v[168:169], v[168:169], v[216:217]
 v_exp_f32_e64 v224, v168 clamp
 v_exp_f32_e64 v225, v169 clamp
 v_max_f32 v168, s58, v168
 v_max_f32 v169, s58, v169
 v_pk_fma_f32 v[168:169], v[168:169], s[56:57], v[224:225]
 v_cvt_pk_bf16_f32 v236, v168, v169
 v_pk_mul_f32 v[170:171], v[170:171], v[218:219]
 v_exp_f32_e64 v226, v170 clamp
 v_exp_f32_e64 v227, v171 clamp
 v_max_f32 v170, s58, v170
 v_max_f32 v171, s58, v171
 v_pk_fma_f32 v[170:171], v[170:171], s[56:57], v[226:227]
 v_cvt_pk_bf16_f32 v237, v170, v171
 v_pk_mul_f32 v[172:173], v[172:173], v[220:221]
 v_exp_f32_e64 v224, v172 clamp
 v_exp_f32_e64 v225, v173 clamp
 v_max_f32 v172, s58, v172
 v_max_f32 v173, s58, v173
 v_pk_fma_f32 v[172:173], v[172:173], s[56:57], v[224:225]
 v_cvt_pk_bf16_f32 v238, v172, v173
 v_pk_mul_f32 v[174:175], v[174:175], v[222:223]
 v_exp_f32_e64 v226, v174 clamp
 v_exp_f32_e64 v227, v175 clamp
 v_max_f32 v174, s58, v174
 v_max_f32 v175, s58, v175
 v_pk_fma_f32 v[174:175], v[174:175], s[56:57], v[226:227]
 v_cvt_pk_bf16_f32 v239, v174, v175
 v_mfma_f32_16x16x32_bf16 v[160:163], v[232:235], v[240:243], 0
 v_mfma_f32_16x16x32_bf16 v[168:171], v[232:235], v[248:251], 0
 v_mfma_f32_16x16x32_bf16 v[176:179], v[248:251], v[240:243], 0
 v_mfma_f32_16x16x32_bf16 v[184:187], v[248:251], v[248:251], 0
 v_mfma_f32_16x16x32_bf16 v[180:183], v[248:251], v[244:247], 0
 v_mfma_f32_16x16x32_bf16 v[172:175], v[236:239], v[248:251], 0
 v_mfma_f32_16x16x32_bf16 v[164:167], v[236:239], v[244:247], 0
 s_lshl_b32 s3, s20, 12
 s_add_u32 s3, s3, 131072
 v_add_u32 v7, s3, v4
 s_lshl_b32 s3, s20, 10
 v_add_u32 v14, s3, v4
 v_lshrrev_b32 v15, 3, v1
 v_and_b32 v13, 7, v1
 v_lshl_add_u32 v15, v15, 4, v13
 v_lshlrev_b32 v15, 4, v15
 v_add_u32 v15, 0x800, v15
 v_add_u32 v13, 0xc00, v4
 v_cmp_gt_u32 vcc, 32, v1
 s_nop 1
 v_cndmask_b32 v15, v13, v15, vcc
 s_cmp_eq_u32 s20, 2
 s_cselect_b64 vcc, -1, 0
 v_cndmask_b32 v14, v14, v15, vcc
 v_add_u32 v14, 131072, v14
 ds_write_b128 v7, v[160:163]
 v_cndmask_b32 v176, v180, v176, s[52:53]
 v_cndmask_b32 v177, v181, v177, s[52:53]
 v_mov_b32 v178, v184
 v_mov_b32 v179, v185
 ds_write_b128 v7, v[176:179] offset:3072
 v_cndmask_b32 v168, v172, v168, s[48:49]
 v_cndmask_b32 v169, v173, v169, s[48:49]
 v_cndmask_b32 v170, v174, v170, s[48:49]
 v_cndmask_b32 v171, v175, v171, s[48:49]
 ds_write_b128 v7, v[168:171] offset:2048
 ds_write_b128 v7, v[164:167] offset:1024
 s_min_u32 s3, s20, 2
 s_mul_i32 s29, s23, 3
 s_add_u32 s29, s29, s3
 s_lshl_b32 s29, s29, 13
 s_add_u32 s29, s29, s42
 s_lshl_b32 s3, s22, 9
 s_add_u32 s30, s29, s3
 s_add_u32 s35, s29, 4096
 v_lshrrev_b32 v15, 1, v3
 v_lshl_add_u32 v15, v15, 4, v2
 v_and_b32 v13, 1, v3
 v_lshlrev_b32 v13, 3, v13
 v_lshl_add_u32 v15, v15, 4, v13
 s_waitcnt vmcnt(0) lgkmcnt(0)
 s_barrier
 s_cmp_eq_u32 s20, 3
 s_cbranch_scc1 L_p3_nopub
 ds_read_b128 v[184:187], v14 offset:0
 ds_read_b128 v[188:191], v14 offset:4096
 ds_read_b128 v[192:195], v14 offset:8192
 ds_read_b128 v[196:199], v14 offset:12288
 s_waitcnt lgkmcnt(2)
 v_pk_add_f32 v[184:185], v[184:185], v[188:189]
 s_waitcnt lgkmcnt(0)
 v_pk_add_f32 v[192:193], v[192:193], v[196:197]
 v_pk_add_f32 v[184:185], v[184:185], v[192:193]
 v_pk_add_f32 v[186:187], v[186:187], v[190:191]
 v_pk_add_f32 v[194:195], v[194:195], v[198:199]
 v_pk_add_f32 v[186:187], v[186:187], v[194:195]
 v_cvt_pk_bf16_f32 v184, v184, v185
 v_cvt_pk_bf16_f32 v185, v186, v187
 buffer_store_dwordx2 v[184:185], v15, s[8:11], s30 offen sc1
L_p3_nopub:
 ds_read_b128 a[0:3], v5 offset:26624
 ds_read_b128 a[4:7], v5 offset:27648
 ds_read_b128 a[8:11], v5 offset:28672
 ds_read_b128 a[12:15], v5 offset:29696
 ds_read_b128 a[16:19], v5 offset:30720
 ds_read_b128 a[20:23], v5 offset:31744
 s_waitcnt lgkmcnt(5)
 v_mfma_f32_16x16x32_bf16 v[160:163], a[0:3], v[16:19], 0
 v_mfma_f32_16x16x32_bf16 v[164:167], a[0:3], v[20:23], 0
 v_and_b32 v13, 1, v2
 ds_read_b128 a[24:27], v5 offset:32768
 s_waitcnt lgkmcnt(5)
 v_mfma_f32_16x16x32_bf16 v[168:171], a[4:7], v[16:19], 0
 v_lshlrev_b32 v13, 4, v13
 ds_read_b128 a[28:31], v5 offset:33792
 v_mfma_f32_16x16x32_bf16 v[172:175], a[4:7], v[20:23], 0
 v_mov_b32 v12, 0x3f80
 buffer_load_dwordx4 v4, s[8:11], s61 offen sc1 lds
 s_add_u32 s61, s61, 4096
 s_add_u32 m0, m0, 4096
 v_lshlrev_b32 v13, v13, v12
 s_waitcnt lgkmcnt(5)
 v_mfma_f32_16x16x32_bf16 v[160:163], a[8:11], v[24:27], v[160:163]
 v_mfma_f32_16x16x32_bf16 v[164:167], a[8:11], v[28:31], v[164:167]
 v_lshrrev_b32 v12, 1, v2
 ds_read_b128 a[0:3], v5 offset:34816
 s_waitcnt lgkmcnt(5)
 v_mfma_f32_16x16x32_bf16 v[168:171], a[12:15], v[24:27], v[168:171]
 v_lshlrev_b32 v15, 1, v3
 ds_read_b128 a[4:7], v5 offset:35840
 v_cmp_eq_u32 vcc, v12, v15
 v_mfma_f32_16x16x32_bf16 v[172:175], a[12:15], v[28:31], v[172:175]
 buffer_load_dwordx4 v4, s[8:11], s61 offen sc1 lds
 s_add_u32 s61, s61, 4096
 s_add_u32 m0, m0, 4096
 v_cndmask_b32 v178, 0, v13, vcc
 s_waitcnt lgkmcnt(5)
 v_mfma_f32_16x16x32_bf16 v[160:163], a[16:19], v[32:35], v[160:163]
 v_mfma_f32_16x16x32_bf16 v[164:167], a[16:19], v[36:39], v[164:167]
 v_add_u32 v15, 1, v15
 ds_read_b128 a[8:11], v5 offset:36864
 s_waitcnt lgkmcnt(5)
 v_mfma_f32_16x16x32_bf16 v[168:171], a[20:23], v[32:35], v[168:171]
 v_cmp_eq_u32 vcc, v12, v15
 ds_read_b128 a[12:15], v5 offset:37888
 s_nop 0
 v_cndmask_b32 v179, 0, v13, vcc
 v_mfma_f32_16x16x32_bf16 v[172:175], a[20:23], v[36:39], v[172:175]
 buffer_load_dwordx4 v4, s[8:11], s61 offen sc1 lds
 s_add_u32 s61, s61, 4096
 s_add_u32 m0, m0, 4096
 v_mov_b32 v176, 0
 s_waitcnt lgkmcnt(5)
 v_mfma_f32_16x16x32_bf16 v[160:163], a[24:27], v[40:43], v[160:163]
 v_mfma_f32_16x16x32_bf16 v[164:167], a[24:27], v[44:47], v[164:167]
 v_mov_b32 v177, 0
 ds_read_b128 a[16:19], v5 offset:38912
 v_mov_b32 v180, 0
 s_waitcnt lgkmcnt(5)
 v_mfma_f32_16x16x32_bf16 v[168:171], a[28:31], v[40:43], v[168:171]
 ds_read_b128 a[20:23], v5 offset:39936
 v_mov_b32 v181, 0
 v_mfma_f32_16x16x32_bf16 v[172:175], a[28:31], v[44:47], v[172:175]
 buffer_load_dwordx4 v4, s[8:11], s61 offen sc1 lds
 s_add_u32 s61, s61, 4096
 s_add_u32 m0, m0, 4096
 v_mfma_f32_16x16x32_bf16 v[224:227], v[248:251], v[178:181], 0
 s_waitcnt lgkmcnt(5)
 v_mfma_f32_16x16x32_bf16 v[160:163], a[0:3], v[48:51], v[160:163]
 v_mfma_f32_16x16x32_bf16 v[164:167], a[0:3], v[52:55], v[164:167]
 v_mfma_f32_16x16x32_bf16 v[228:231], v[248:251], v[176:179], 0
 ds_read_b128 a[24:27], v5 offset:40960
 v_and_b32 v15, 1, v3
 s_waitcnt lgkmcnt(5)
 v_mfma_f32_16x16x32_bf16 v[168:171], a[4:7], v[48:51], v[168:171]
 ds_read_b128 a[28:31], v5 offset:41984
 v_lshlrev_b32 v15, 2, v15
 v_mfma_f32_16x16x32_bf16 v[172:175], a[4:7], v[52:55], v[172:175]
 buffer_load_dwordx4 v4, s[8:11], s61 offen sc1 lds
 s_add_u32 s61, s61, 4096
 s_add_u32 m0, m0, 4096
 v_cmp_eq_u32 vcc, v12, v15
 s_waitcnt lgkmcnt(5)
 v_mfma_f32_16x16x32_bf16 v[160:163], a[8:11], v[56:59], v[160:163]
 v_cndmask_b32 v220, 0, v13, vcc
 v_mfma_f32_16x16x32_bf16 v[164:167], a[8:11], v[60:63], v[164:167]
 ds_read_b128 a[0:3], v5 offset:43008
 v_add_u32 v15, 1, v15
 s_waitcnt lgkmcnt(5)
 v_mfma_f32_16x16x32_bf16 v[168:171], a[12:15], v[56:59], v[168:171]
 ds_read_b128 a[4:7], v5 offset:44032
 v_cmp_eq_u32 vcc, v12, v15
 v_mfma_f32_16x16x32_bf16 v[172:175], a[12:15], v[60:63], v[172:175]
 buffer_load_dwordx4 v4, s[8:11], s61 offen sc1 lds
 s_add_u32 s61, s61, 4096
 s_add_u32 m0, m0, 4096
 v_cndmask_b32 v221, 0, v13, vcc
 s_waitcnt lgkmcnt(5)
 v_mfma_f32_16x16x32_bf16 v[160:163], a[16:19], v[64:67], v[160:163]
 v_add_u32 v15, 1, v15
 v_mfma_f32_16x16x32_bf16 v[164:167], a[16:19], v[68:71], v[164:167]
 ds_read_b128 a[8:11], v5 offset:45056
 v_cmp_eq_u32 vcc, v12, v15
 s_waitcnt lgkmcnt(5)
 v_mfma_f32_16x16x32_bf16 v[168:171], a[20:23], v[64:67], v[168:171]
 ds_read_b128 a[12:15], v5 offset:46080
 v_cndmask_b32 v222, 0, v13, vcc
 v_mfma_f32_16x16x32_bf16 v[172:175], a[20:23], v[68:71], v[172:175]
 v_add_u32 v15, 1, v15
 buffer_load_dwordx4 v4, s[8:11], s61 offen sc1 lds
 s_add_u32 s61, s61, 4096
 s_add_u32 m0, m0, 4096
 s_waitcnt lgkmcnt(5)
 v_mfma_f32_16x16x32_bf16 v[160:163], a[24:27], v[72:75], v[160:163]
 v_cmp_eq_u32 vcc, v12, v15
 v_mfma_f32_16x16x32_bf16 v[164:167], a[24:27], v[76:79], v[164:167]
 ds_read_b128 a[16:19], v5 offset:47104
 v_cndmask_b32 v223, 0, v13, vcc
 s_waitcnt lgkmcnt(5)
 v_mfma_f32_16x16x32_bf16 v[168:171], a[28:31], v[72:75], v[168:171]
 ds_read_b128 a[20:23], v5 offset:48128
 v_add_u32 v15, 1, v15
 v_mfma_f32_16x16x32_bf16 v[172:175], a[28:31], v[76:79], v[172:175]
 v_cvt_pk_bf16_f32 v234, v226, v227
 buffer_load_dwordx4 v4, s[8:11], s61 offen sc1 lds
 s_add_u32 s61, s61, 4096
 s_add_u32 m0, m0, 4096
 s_waitcnt lgkmcnt(5)
 v_mfma_f32_16x16x32_bf16 v[160:163], a[0:3], v[80:83], v[160:163]
 v_mov_b32 v235, 0
 v_mfma_f32_16x16x32_bf16 v[164:167], a[0:3], v[84:87], v[164:167]
 ds_read_b128 a[24:27], v5 offset:49152
 v_cvt_pk_bf16_f32 v240, v230, v231
 s_waitcnt lgkmcnt(5)
 v_mfma_f32_16x16x32_bf16 v[168:171], a[4:7], v[80:83], v[168:171]
 v_mov_b32 v241, 0
 ds_read_b128 a[28:31], v5 offset:50176
 v_mfma_f32_16x16x32_bf16 v[172:175], a[4:7], v[84:87], v[172:175]
 buffer_load_dwordx4 v4, s[8:11], s61 offen sc1 lds
 s_add_u32 s61, s61, 4096
 s_add_u32 m0, m0, 4096
 s_waitcnt lgkmcnt(5)
 v_mfma_f32_16x16x32_bf16 v[160:163], a[8:11], v[88:91], v[160:163]
 v_mfma_f32_16x16x32_bf16 v[164:167], a[8:11], v[92:95], v[164:167]
 ds_read_b128 a[0:3], v5 offset:51200
 s_waitcnt lgkmcnt(5)
 v_mfma_f32_16x16x32_bf16 v[168:171], a[12:15], v[88:91], v[168:171]
 ds_read_b128 a[4:7], v5 offset:52224
 v_mfma_f32_16x16x32_bf16 v[172:175], a[12:15], v[92:95], v[172:175]
 buffer_load_dwordx4 v4, s[8:11], s61 offen sc1 lds
 s_add_u32 s61, s61, 4096
 s_add_u32 m0, m0, 4096
 s_waitcnt lgkmcnt(5)
 v_mfma_f32_16x16x32_bf16 v[160:163], a[16:19], v[96:99], v[160:163]
 v_mfma_f32_16x16x32_bf16 v[164:167], a[16:19], v[100:103], v[164:167]
 ds_read_b128 a[8:11], v5 offset:53248
 s_waitcnt lgkmcnt(5)
 v_mfma_f32_16x16x32_bf16 v[168:171], a[20:23], v[96:99], v[168:171]
 ds_read_b128 a[12:15], v5 offset:54272
 v_mfma_f32_16x16x32_bf16 v[172:175], a[20:23], v[100:103], v[172:175]
 buffer_load_dwordx4 v[188:191], v4, s[8:11], s29 offen offset:0 sc1
 s_waitcnt lgkmcnt(5)
 v_mfma_f32_16x16x32_bf16 v[160:163], a[24:27], v[104:107], v[160:163]
 v_mfma_f32_16x16x32_bf16 v[164:167], a[24:27], v[108:111], v[164:167]
 ds_read_b128 a[16:19], v5 offset:55296
 s_waitcnt lgkmcnt(5)
 v_mfma_f32_16x16x32_bf16 v[168:171], a[28:31], v[104:107], v[168:171]
 ds_read_b128 a[20:23], v5 offset:56320
 v_mfma_f32_16x16x32_bf16 v[172:175], a[28:31], v[108:111], v[172:175]
 buffer_load_dwordx4 v[192:195], v4, s[8:11], s29 offen offset:1024 sc1
 s_waitcnt lgkmcnt(5)
 v_mfma_f32_16x16x32_bf16 v[160:163], a[0:3], v[112:115], v[160:163]
 v_mfma_f32_16x16x32_bf16 v[164:167], a[0:3], v[116:119], v[164:167]
 ds_read_b128 a[24:27], v5 offset:57344
 s_waitcnt lgkmcnt(5)
 v_mfma_f32_16x16x32_bf16 v[168:171], a[4:7], v[112:115], v[168:171]
 ds_read_b128 a[28:31], v5 offset:58368
 v_mfma_f32_16x16x32_bf16 v[172:175], a[4:7], v[116:119], v[172:175]
 buffer_load_dwordx4 v[196:199], v4, s[8:11], s29 offen offset:2048 sc1
 s_waitcnt lgkmcnt(5)
 v_mfma_f32_16x16x32_bf16 v[160:163], a[8:11], v[120:123], v[160:163]
 v_mfma_f32_16x16x32_bf16 v[164:167], a[8:11], v[124:127], v[164:167]
 ds_read_b128 a[0:3], v5 offset:59392
 s_waitcnt lgkmcnt(5)
 v_mfma_f32_16x16x32_bf16 v[168:171], a[12:15], v[120:123], v[168:171]
 ds_read_b128 a[4:7], v5 offset:60416
 v_mfma_f32_16x16x32_bf16 v[172:175], a[12:15], v[124:127], v[172:175]
 buffer_load_dwordx4 v[200:203], v4, s[8:11], s29 offen offset:3072 sc1
 s_waitcnt lgkmcnt(5)
 v_mfma_f32_16x16x32_bf16 v[160:163], a[16:19], v[128:131], v[160:163]
 v_mfma_f32_16x16x32_bf16 v[164:167], a[16:19], v[132:135], v[164:167]
 ds_read_b128 a[8:11], v5 offset:61440
 s_waitcnt lgkmcnt(5)
 v_mfma_f32_16x16x32_bf16 v[168:171], a[20:23], v[128:131], v[168:171]
 ds_read_b128 a[12:15], v5 offset:62464
 v_mfma_f32_16x16x32_bf16 v[172:175], a[20:23], v[132:135], v[172:175]
 buffer_load_dwordx4 v[204:207], v4, s[8:11], s35 offen offset:0 sc1
 s_waitcnt lgkmcnt(5)
 v_mfma_f32_16x16x32_bf16 v[160:163], a[24:27], v[136:139], v[160:163]
 v_mfma_f32_16x16x32_bf16 v[164:167], a[24:27], v[140:143], v[164:167]
 s_waitcnt lgkmcnt(4)
 v_mfma_f32_16x16x32_bf16 v[168:171], a[28:31], v[136:139], v[168:171]
 v_mfma_f32_16x16x32_bf16 v[172:175], a[28:31], v[140:143], v[172:175]
 buffer_load_dwordx4 v[208:211], v4, s[8:11], s35 offen offset:1024 sc1
 s_waitcnt lgkmcnt(3)
 v_mfma_f32_16x16x32_bf16 v[160:163], a[0:3], v[144:147], v[160:163]
 v_mfma_f32_16x16x32_bf16 v[164:167], a[0:3], v[148:151], v[164:167]
 s_waitcnt lgkmcnt(2)
 v_mfma_f32_16x16x32_bf16 v[168:171], a[4:7], v[144:147], v[168:171]
 v_mfma_f32_16x16x32_bf16 v[172:175], a[4:7], v[148:151], v[172:175]
 buffer_load_dwordx4 v[212:215], v4, s[8:11], s35 offen offset:2048 sc1
 s_waitcnt lgkmcnt(1)
 v_mfma_f32_16x16x32_bf16 v[160:163], a[8:11], v[152:155], v[160:163]
 v_mfma_f32_16x16x32_bf16 v[164:167], a[8:11], v[156:159], v[164:167]
 s_waitcnt lgkmcnt(0)
 v_mfma_f32_16x16x32_bf16 v[168:171], a[12:15], v[152:155], v[168:171]
 v_mfma_f32_16x16x32_bf16 v[172:175], a[12:15], v[156:159], v[172:175]
 buffer_load_dwordx4 v[216:219], v4, s[8:11], s35 offen offset:3072 sc1
 s_barrier
 s_mov_b32 s43, m0
 s_mov_b32 m0, s63
 v_pk_mul_f32 v[160:161], v[160:161], v[252:253] op_sel_hi:[1,0]
 v_exp_f32_e64 v228, v160 clamp
 v_exp_f32_e64 v229, v161 clamp
 v_max_f32 v160, s58, v160
 v_max_f32 v161, s58, v161
 v_pk_fma_f32 v[160:161], v[160:161], s[56:57], v[228:229]
 v_cvt_pk_bf16_f32 v232, v160, v161
 v_pk_mul_f32 v[162:163], v[162:163], v[252:253] op_sel_hi:[1,0]
 v_exp_f32_e64 v230, v162 clamp
 v_exp_f32_e64 v231, v163 clamp
 v_max_f32 v162, s58, v162
 v_max_f32 v163, s58, v163
 buffer_load_dwordx4 v4, s[16:19], s62 offen sc1 lds
 s_add_u32 s62, s62, 4096
 s_add_u32 m0, m0, 4096
 v_pk_fma_f32 v[162:163], v[162:163], s[56:57], v[230:231]
 v_cvt_pk_bf16_f32 v233, v162, v163
 v_pk_mul_f32 v[168:169], v[168:169], v[252:253] op_sel_hi:[1,0]
 v_exp_f32_e64 v228, v168 clamp
 v_exp_f32_e64 v229, v169 clamp
 v_max_f32 v168, s58, v168
 v_max_f32 v169, s58, v169
 v_pk_fma_f32 v[168:169], v[168:169], s[56:57], v[228:229]
 v_cvt_pk_bf16_f32 v236, v168, v169
 v_pk_mul_f32 v[170:171], v[170:171], v[252:253] op_sel_hi:[1,0]
 v_exp_f32_e64 v230, v170 clamp
 buffer_load_dwordx4 v4, s[16:19], s62 offen sc1 lds
 s_add_u32 s62, s62, 4096
 s_add_u32 m0, m0, 4096
 v_exp_f32_e64 v231, v171 clamp
 v_max_f32 v170, s58, v170
 v_max_f32 v171, s58, v171
 v_pk_fma_f32 v[170:171], v[170:171], s[56:57], v[230:231]
 v_cvt_pk_bf16_f32 v237, v170, v171
 v_pk_mul_f32 v[164:165], v[164:165], v[254:255] op_sel_hi:[1,0]
 v_exp_f32_e64 v228, v164 clamp
 v_exp_f32_e64 v229, v165 clamp
 v_max_f32 v164, s58, v164
 v_max_f32 v165, s58, v165
 v_pk_fma_f32 v[164:165], v[164:165], s[56:57], v[228:229]
 buffer_load_dwordx4 v4, s[16:19], s62 offen sc1 lds
 s_add_u32 s62, s62, 4096
 s_add_u32 m0, m0, 4096
 v_cvt_pk_bf16_f32 v238, v164, v165
 v_pk_mul_f32 v[166:167], v[166:167], v[254:255] op_sel_hi:[1,0]
 v_exp_f32_e64 v230, v166 clamp
 v_exp_f32_e64 v231, v167 clamp
 v_max_f32 v166, s58, v166
 v_max_f32 v167, s58, v167
 v_pk_fma_f32 v[166:167], v[166:167], s[56:57], v[230:231]
 v_cvt_pk_bf16_f32 v239, v166, v167
 v_pk_mul_f32 v[172:173], v[172:173], v[254:255] op_sel_hi:[1,0]
 v_exp_f32_e64 v228, v172 clamp
 v_exp_f32_e64 v229, v173 clamp
 buffer_load_dwordx4 v4, s[16:19], s62 offen sc1 lds
 s_add_u32 s62, s62, 4096
 s_add_u32 m0, m0, 4096
 v_max_f32 v172, s58, v172
 v_max_f32 v173, s58, v173
 v_pk_fma_f32 v[172:173], v[172:173], s[56:57], v[228:229]
 v_cvt_pk_bf16_f32 v242, v172, v173
 v_pk_mul_f32 v[174:175], v[174:175], v[254:255] op_sel_hi:[1,0]
 v_exp_f32_e64 v230, v174 clamp
 v_exp_f32_e64 v231, v175 clamp
 v_max_f32 v174, s58, v174
 v_max_f32 v175, s58, v175
 v_pk_fma_f32 v[174:175], v[174:175], s[56:57], v[230:231]
 v_cvt_pk_bf16_f32 v243, v174, v175
 buffer_load_dwordx4 v4, s[16:19], s62 offen sc1 lds
 s_add_u32 s62, s62, 4096
 s_add_u32 m0, m0, 4096
 s_mov_b32 s34, 0
 s_waitcnt vmcnt(5)
 s_branch L_p3_check
L_p3_poll:
 buffer_load_dwordx4 v[188:191], v4, s[8:11], s29 offen offset:0 sc1
 buffer_load_dwordx4 v[192:195], v4, s[8:11], s29 offen offset:1024 sc1
 buffer_load_dwordx4 v[196:199], v4, s[8:11], s29 offen offset:2048 sc1
 buffer_load_dwordx4 v[200:203], v4, s[8:11], s29 offen offset:3072 sc1
 buffer_load_dwordx4 v[204:207], v4, s[8:11], s35 offen offset:0 sc1
 buffer_load_dwordx4 v[208:211], v4, s[8:11], s35 offen offset:1024 sc1
 buffer_load_dwordx4 v[212:215], v4, s[8:11], s35 offen offset:2048 sc1
 buffer_load_dwordx4 v[216:219], v4, s[8:11], s35 offen offset:3072 sc1
 s_waitcnt vmcnt(0)
L_p3_check:
 v_mfma_f32_16x16x32_bf16 v[224:227], v[220:223], v[188:191], 0
 v_mfma_f32_16x16x32_bf16 v[224:227], v[220:223], v[192:195], v[224:227]
 v_mfma_f32_16x16x32_bf16 v[224:227], v[220:223], v[196:199], v[224:227]
 v_mfma_f32_16x16x32_bf16 v[224:227], v[220:223], v[200:203], v[224:227]
 v_mfma_f32_16x16x32_bf16 v[224:227], v[220:223], v[204:207], v[224:227]
 v_mfma_f32_16x16x32_bf16 v[224:227], v[220:223], v[208:211], v[224:227]
 v_mfma_f32_16x16x32_bf16 v[224:227], v[220:223], v[212:215], v[224:227]
 v_mfma_f32_16x16x32_bf16 v[224:227], v[220:223], v[216:219], v[224:227]
 s_add_u32 s34, s34, 1
 s_nop 6
 v_cmp_u_f32 vcc, v224, v224
 s_cmp_gt_u32 s34, 131072
 s_cbranch_scc1 L_p3_polled
 s_cbranch_vccnz L_p3_poll
L_p3_polled:
 s_nop 3
 v_cvt_pk_bf16_f32 v228, v224, v225
 v_cvt_pk_bf16_f32 v229, v226, v227
 s_lshl_b32 s3, s20, 9
 s_add_u32 s3, s3, 149504
 v_lshl_add_u32 v13, v1, 3, s3
 ds_write_b64 v13, v[228:229]
 v_lshlrev_b32 v13, 3, v1
 v_add_u32 v13, 149504, v13
 v_and_b32 v14, 3, v2
 v_lshl_add_u32 v15, v3, 4, v14
 v_lshl_add_u32 v14, v3, 3, v14
 v_lshlrev_b32 v14, 3, v14
 v_add_u32 v14, 149504, v14
 v_lshlrev_b32 v15, 3, v15
 v_add_u32 v15, 149504, v15
 v_mov_b32 v191, 0
 v_mov_b32 v193, 0
 v_mov_b32 v199, 0
 buffer_load_dwordx4 v4, s[16:19], s62 offen sc1 lds
 s_add_u32 s62, s62, 4096
 s_add_u32 m0, m0, 4096
 v_mov_b32 v201, 0
 s_lshl_b32 s3, s23, 10
 s_add_u32 s36, s25, s41
 s_add_u32 s34, s36, s3
 s_lshl_b32 s3, s23, 7
 s_add_u32 s36, s36, s3
 s_add_u32 s36, s36, 16384
 s_add_u32 s35, s34, 18688
 v_mul_u32_u24 v11, 18688, v3
 v_lshl_add_u32 v11, v2, 3, v11
 v_cmp_eq_u32 s[46:47], 0, v3
 v_mov_b32 v12, 0x358637bd
 buffer_load_dwordx4 v4, s[16:19], s62 offen sc1 lds
 s_add_u32 s62, s62, 4096
 s_add_u32 m0, m0, 4096
 s_waitcnt lgkmcnt(0)
 s_barrier
 ds_read_b32 v9, v15 offset:1028
 ds_read_b32 v10, v15 offset:1060
 ds_read_b64 v[196:197], v14 offset:1024
 ds_read_b64 v[202:203], v14 offset:1056
 ds_read_b32 v8, v13 offset:1024
 ds_read_b64 v[188:189], v13
 ds_read_b64 v[194:195], v13 offset:512
 buffer_load_dwordx4 v4, s[16:19], s62 offen sc1 lds
 s_add_u32 s62, s62, 4096
 s_add_u32 m0, m0, 4096
 s_waitcnt lgkmcnt(6)
 v_cndmask_b32 v198, 0, v9, s[52:53]
 s_waitcnt lgkmcnt(5)
 v_cndmask_b32 v200, 0, v10, s[54:55]
 s_waitcnt lgkmcnt(2)
 v_cndmask_b32 v190, 0, v8, s[52:53]
 v_cndmask_b32 v192, 0, v8, s[54:55]
 v_mfma_f32_16x16x32_bf16 v[168:171], v[196:199], v[232:235], 0
 v_mfma_f32_16x16x32_bf16 v[172:175], v[200:203], v[234:237], 0
 v_mfma_f32_16x16x32_bf16 v[212:215], v[196:199], v[238:241], 0
 v_mfma_f32_16x16x32_bf16 v[216:219], v[200:203], v[240:243], 0
 s_waitcnt lgkmcnt(1)
 v_mfma_f32_16x16x32_bf16 v[160:163], v[188:191], v[232:235], 0
 s_waitcnt lgkmcnt(0)
 v_mfma_f32_16x16x32_bf16 v[164:167], v[192:195], v[234:237], 0
 v_mfma_f32_16x16x32_bf16 v[204:207], v[188:191], v[238:241], 0
 v_mfma_f32_16x16x32_bf16 v[208:211], v[192:195], v[240:243], 0
 buffer_load_dwordx4 v4, s[16:19], s62 offen sc1 lds
 s_add_u32 s62, s62, 4096
 s_add_u32 m0, m0, 4096
 v_add_f32 v171, v171, v12
 v_rcp_f32 v171, v171
 v_add_f32 v175, v175, v12
 v_rcp_f32 v175, v175
 v_add_f32 v215, v215, v12
 v_rcp_f32 v215, v215
 v_add_f32 v219, v219, v12
 v_rcp_f32 v219, v219
 v_mul_f32 v160, v160, v171
 v_mul_f32 v161, v161, v171
 v_mul_f32 v162, v162, v171
 v_mul_f32 v163, v163, v171
 v_cvt_pk_bf16_f32 v176, v160, v161
 v_cvt_pk_bf16_f32 v177, v162, v163
 v_mul_f32 v164, v164, v175
 v_mul_f32 v165, v165, v175
 v_mul_f32 v166, v166, v175
 v_mul_f32 v167, v167, v175
 v_cvt_pk_bf16_f32 v178, v164, v165
 v_cvt_pk_bf16_f32 v179, v166, v167
 v_min_u32 v176, -2, v176
 v_min_u32 v177, -2, v177
 v_min_u32 v178, -2, v178
 v_min_u32 v179, -2, v179
 buffer_store_dwordx4 v[176:179], v4, s[8:11], s34 offen sc1
 v_mul_f32 v204, v204, v215
 v_mul_f32 v205, v205, v215
 v_mul_f32 v206, v206, v215
 v_mul_f32 v207, v207, v215
 v_cvt_pk_bf16_f32 v182, v204, v205
 v_cvt_pk_bf16_f32 v183, v206, v207
 v_mul_f32 v208, v208, v219
 v_mul_f32 v209, v209, v219
 v_mul_f32 v210, v210, v219
 v_mul_f32 v211, v211, v219
 v_cvt_pk_bf16_f32 v184, v208, v209
 v_cvt_pk_bf16_f32 v185, v210, v211
 v_min_u32 v182, -2, v182
 v_min_u32 v183, -2, v183
 v_min_u32 v184, -2, v184
 v_min_u32 v185, -2, v185
 buffer_store_dwordx4 v[182:185], v4, s[8:11], s35 offen sc1
 v_mul_f32 v168, v168, v171
 v_mul_f32 v169, v169, v171
 v_cvt_pk_bf16_f32 v180, v168, v169
 v_mul_f32 v172, v172, v175
 v_mul_f32 v173, v173, v175
 v_cvt_pk_bf16_f32 v181, v172, v173
 v_mul_f32 v212, v212, v215
 v_mul_f32 v213, v213, v215
 v_cvt_pk_bf16_f32 v186, v212, v213
 v_mul_f32 v216, v216, v219
 v_mul_f32 v217, v217, v219
 v_cvt_pk_bf16_f32 v187, v216, v217
 v_cndmask_b32 v180, v186, v180, s[46:47]
 v_cndmask_b32 v181, v187, v181, s[46:47]
 v_min_u32 v180, -2, v180
 v_min_u32 v181, -2, v181
 s_mov_b32 exec_hi, 0
 buffer_store_dwordx2 v[180:181], v11, s[8:11], s36 offen sc1
 s_mov_b32 exec_hi, -1
 s_cmp_lg_u32 s45, 0
 s_cbranch_scc1 L_p3_g
 s_mov_b32 m0, s43
 s_nop 0
 buffer_load_dwordx4 v4, s[8:11], s61 offen sc1 lds
 s_add_u32 s61, s61, 4096
 s_add_u32 m0, m0, 4096
 s_nop 0
 buffer_load_dwordx4 v4, s[8:11], s61 offen sc1 lds
 s_add_u32 s61, s61, 4096
 s_add_u32 m0, m0, 4096
 s_nop 0
 buffer_load_dwordx4 v4, s[8:11], s61 offen sc1 lds
 s_add_u32 s61, s61, 4096
 s_add_u32 m0, m0, 4096
 s_nop 0
 buffer_load_dwordx4 v4, s[8:11], s61 offen sc1 lds
 s_add_u32 s61, s61, 4096
 s_add_u32 m0, m0, 4096
 s_nop 0
 buffer_load_dwordx4 v4, s[8:11], s61 offen sc1 lds
 s_add_u32 s61, s61, 4096
 s_add_u32 m0, m0, 4096
 s_nop 0
 buffer_load_dwordx4 v4, s[8:11], s61 offen sc1 lds
 s_add_u32 s61, s61, 4096
 s_add_u32 m0, m0, 4096
 s_nop 0
 buffer_load_dwordx4 v4, s[8:11], s61 offen sc1 lds
 s_add_u32 s61, s61, 4096
 s_add_u32 m0, m0, 4096
 s_nop 0
 buffer_load_dwordx4 v4, s[8:11], s61 offen sc1 lds
 s_add_u32 s61, s61, 4096
 s_add_u32 m0, m0, 4096
 s_nop 0
 buffer_load_dwordx4 v4, s[8:11], s61 offen sc1 lds
 s_add_u32 s61, s61, 4096
 s_add_u32 m0, m0, 4096
 s_nop 0
 buffer_load_dwordx4 v4, s[8:11], s61 offen sc1 lds
 s_add_u32 s61, s61, 4096
 s_add_u32 m0, m0, 4096
 s_nop 0
 buffer_load_dwordx4 v4, s[8:11], s61 offen sc1 lds
 s_add_u32 s61, s61, 4096
 s_add_u32 m0, m0, 4096
 s_nop 0
 buffer_load_dwordx4 v4, s[8:11], s61 offen sc1 lds
 s_add_u32 s61, s61, 4096
 s_add_u32 m0, m0, 4096
 s_cmp_ge_u32 s20, 2
 s_cbranch_scc1 L_p3r0
 buffer_load_dwordx4 v4, s[8:11], s61 offen sc1 lds
 s_add_u32 s61, s61, 4096
 s_add_u32 m0, m0, 4096
L_p3r0:
 s_branch L_p3_nog
L_p3_g:
 s_cmp_ge_u32 s23, 4
 s_cbranch_scc1 L_p3_g2
 buffer_load_dwordx4 v4, s[16:19], s62 offen sc1 lds
 s_add_u32 s62, s62, 4096
 s_add_u32 m0, m0, 4096
 s_nop 0
 buffer_load_dwordx4 v4, s[16:19], s62 offen sc1 lds
 s_add_u32 s62, s62, 4096
 s_add_u32 m0, m0, 4096
 s_nop 0
 buffer_load_dwordx4 v4, s[16:19], s62 offen sc1 lds
 s_add_u32 s62, s62, 4096
 s_add_u32 m0, m0, 4096
 s_nop 0
 buffer_load_dwordx4 v4, s[16:19], s62 offen sc1 lds
 s_add_u32 s62, s62, 4096
 s_add_u32 m0, m0, 4096
 s_nop 0
 buffer_load_dwordx4 v4, s[16:19], s62 offen sc1 lds
 s_add_u32 s62, s62, 4096
 s_add_u32 m0, m0, 4096
 s_waitcnt vmcnt(8)
 s_branch L_p3_g3
L_p3_g2:
 s_waitcnt vmcnt(3)
L_p3_g3:
 s_barrier
 s_mov_b32 m0, s43
 s_mov_b32 s38, s23
 v_add_u32 v14, 92160, v4
 ds_read_b128 a[0:3], v14 offset:0
 ds_read_b128 a[4:7], v14 offset:1024
 ds_read_b128 a[8:11], v14 offset:2048
 ds_read_b128 a[12:15], v14 offset:3072
 ds_read_b128 a[16:19], v14 offset:4096
 s_waitcnt lgkmcnt(4)
 v_mfma_f32_16x16x32_bf16 v[160:163], a[0:3], v[16:19], 0
 ds_read_b128 a[20:23], v14 offset:5120
 v_mfma_f32_16x16x32_bf16 v[164:167], a[0:3], v[20:23], 0
 s_waitcnt lgkmcnt(4)
 v_mfma_f32_16x16x32_bf16 v[160:163], a[4:7], v[24:27], v[160:163]
 ds_read_b128 a[0:3], v14 offset:6144
 v_mfma_f32_16x16x32_bf16 v[164:167], a[4:7], v[28:31], v[164:167]
 s_waitcnt lgkmcnt(4)
 v_mfma_f32_16x16x32_bf16 v[160:163], a[8:11], v[32:35], v[160:163]
 ds_read_b128 a[4:7], v14 offset:7168
 v_mfma_f32_16x16x32_bf16 v[164:167], a[8:11], v[36:39], v[164:167]
 buffer_load_dwordx4 v4, s[8:11], s61 offen sc1 lds
 s_add_u32 s61, s61, 4096
 s_add_u32 m0, m0, 4096
 s_waitcnt lgkmcnt(4)
 v_mfma_f32_16x16x32_bf16 v[160:163], a[12:15], v[40:43], v[160:163]
 ds_read_b128 a[8:11], v14 offset:8192
 v_mfma_f32_16x16x32_bf16 v[164:167], a[12:15], v[44:47], v[164:167]
 s_waitcnt lgkmcnt(4)
 v_mfma_f32_16x16x32_bf16 v[160:163], a[16:19], v[48:51], v[160:163]
 ds_read_b128 a[12:15], v14 offset:9216
 v_mfma_f32_16x16x32_bf16 v[164:167], a[16:19], v[52:55], v[164:167]
 s_waitcnt lgkmcnt(4)
 v_mfma_f32_16x16x32_bf16 v[160:163], a[20:23], v[56:59], v[160:163]
 ds_read_b128 a[16:19], v14 offset:10240
 buffer_load_dwordx4 v4, s[8:11], s61 offen sc1 lds
 s_add_u32 s61, s61, 4096
 s_add_u32 m0, m0, 4096
 v_mfma_f32_16x16x32_bf16 v[164:167], a[20:23], v[60:63], v[164:167]
 s_waitcnt lgkmcnt(4)
 v_mfma_f32_16x16x32_bf16 v[160:163], a[0:3], v[64:67], v[160:163]
 ds_read_b128 a[20:23], v14 offset:11264
 v_mfma_f32_16x16x32_bf16 v[164:167], a[0:3], v[68:71], v[164:167]
 s_waitcnt lgkmcnt(4)
 v_mfma_f32_16x16x32_bf16 v[160:163], a[4:7], v[72:75], v[160:163]
 ds_read_b128 a[0:3], v14 offset:12288
 v_mfma_f32_16x16x32_bf16 v[164:167], a[4:7], v[76:79], v[164:167]
 s_waitcnt lgkmcnt(4)
 v_mfma_f32_16x16x32_bf16 v[160:163], a[8:11], v[80:83], v[160:163]
 buffer_load_dwordx4 v4, s[8:11], s61 offen sc1 lds
 s_add_u32 s61, s61, 4096
 s_add_u32 m0, m0, 4096
 ds_read_b128 a[4:7], v14 offset:13312
 v_mfma_f32_16x16x32_bf16 v[164:167], a[8:11], v[84:87], v[164:167]
 s_waitcnt lgkmcnt(4)
 v_mfma_f32_16x16x32_bf16 v[160:163], a[12:15], v[88:91], v[160:163]
 ds_read_b128 a[8:11], v14 offset:14336
 v_mfma_f32_16x16x32_bf16 v[164:167], a[12:15], v[92:95], v[164:167]
 s_waitcnt lgkmcnt(4)
 v_mfma_f32_16x16x32_bf16 v[160:163], a[16:19], v[96:99], v[160:163]
 ds_read_b128 a[12:15], v14 offset:15360
 v_mfma_f32_16x16x32_bf16 v[164:167], a[16:19], v[100:103], v[164:167]
 buffer_load_dwordx4 v4, s[8:11], s61 offen sc1 lds
 s_add_u32 s61, s61, 4096
 s_add_u32 m0, m0, 4096
 s_waitcnt lgkmcnt(4)
 v_mfma_f32_16x16x32_bf16 v[160:163], a[20:23], v[104:107], v[160:163]
 ds_read_b128 a[16:19], v14 offset:16384
 v_mfma_f32_16x16x32_bf16 v[164:167], a[20:23], v[108:111], v[164:167]
 s_waitcnt lgkmcnt(4)
 v_mfma_f32_16x16x32_bf16 v[160:163], a[0:3], v[112:115], v[160:163]
 ds_read_b128 a[20:23], v14 offset:17408
 v_mfma_f32_16x16x32_bf16 v[164:167], a[0:3], v[116:119], v[164:167]
 s_waitcnt lgkmcnt(4)
 v_mfma_f32_16x16x32_bf16 v[160:163], a[4:7], v[120:123], v[160:163]
 v_mfma_f32_16x16x32_bf16 v[164:167], a[4:7], v[124:127], v[164:167]
 buffer_load_dwordx4 v4, s[8:11], s61 offen sc1 lds
 s_add_u32 s61, s61, 4096
 s_add_u32 m0, m0, 4096
 s_waitcnt lgkmcnt(3)
 v_mfma_f32_16x16x32_bf16 v[160:163], a[8:11], v[128:131], v[160:163]
 v_mfma_f32_16x16x32_bf16 v[164:167], a[8:11], v[132:135], v[164:167]
 s_waitcnt lgkmcnt(2)
 v_mfma_f32_16x16x32_bf16 v[160:163], a[12:15], v[136:139], v[160:163]
 v_mfma_f32_16x16x32_bf16 v[164:167], a[12:15], v[140:143], v[164:167]
 s_waitcnt lgkmcnt(1)
 v_mfma_f32_16x16x32_bf16 v[160:163], a[16:19], v[144:147], v[160:163]
 v_mfma_f32_16x16x32_bf16 v[164:167], a[16:19], v[148:151], v[164:167]
 s_waitcnt lgkmcnt(0)
 v_mfma_f32_16x16x32_bf16 v[160:163], a[20:23], v[152:155], v[160:163]
 v_mfma_f32_16x16x32_bf16 v[164:167], a[20:23], v[156:159], v[164:167]
 buffer_load_dwordx4 v4, s[8:11], s61 offen sc1 lds
 s_add_u32 s61, s61, 4096
 s_add_u32 m0, m0, 4096
 s_lshr_b32 s39, s38, 1
 s_lshl_b32 s39, s39, 3
 s_and_b32 s3, s38, 1
 s_add_u32 s39, s39, s3
 s_mul_i32 s39, s39, 16640
 s_add_u32 s39, s39, s31
 s_add_u32 s39, s39, 0x12f0000
 v_add_u32 v14, 18432, v14
 s_add_u32 s38, s38, 16
 v_cvt_pk_bf16_f32 v168, v160, v161
 v_min_u32 v168, -2, v168
 v_cvt_pk_bf16_f32 v169, v162, v163
 v_min_u32 v169, -2, v169
 v_cvt_pk_bf16_f32 v170, v164, v165
 v_min_u32 v170, -2, v170
 v_cvt_pk_bf16_f32 v171, v166, v167
 v_min_u32 v171, -2, v171
 buffer_store_dwordx4 v[168:171], v6, s[8:11], s39 offen sc1
 ds_read_b128 a[0:3], v14 offset:0
 ds_read_b128 a[4:7], v14 offset:1024
 ds_read_b128 a[8:11], v14 offset:2048
 ds_read_b128 a[12:15], v14 offset:3072
 ds_read_b128 a[16:19], v14 offset:4096
 s_waitcnt lgkmcnt(4)
 v_mfma_f32_16x16x32_bf16 v[160:163], a[0:3], v[16:19], 0
 ds_read_b128 a[20:23], v14 offset:5120
 v_mfma_f32_16x16x32_bf16 v[164:167], a[0:3], v[20:23], 0
 s_waitcnt lgkmcnt(4)
 v_mfma_f32_16x16x32_bf16 v[160:163], a[4:7], v[24:27], v[160:163]
 ds_read_b128 a[0:3], v14 offset:6144
 v_mfma_f32_16x16x32_bf16 v[164:167], a[4:7], v[28:31], v[164:167]
 s_waitcnt lgkmcnt(4)
 v_mfma_f32_16x16x32_bf16 v[160:163], a[8:11], v[32:35], v[160:163]
 buffer_load_dwordx4 v4, s[8:11], s61 offen sc1 lds
 s_add_u32 s61, s61, 4096
 s_add_u32 m0, m0, 4096
 ds_read_b128 a[4:7], v14 offset:7168
 v_mfma_f32_16x16x32_bf16 v[164:167], a[8:11], v[36:39], v[164:167]
 s_waitcnt lgkmcnt(4)
 v_mfma_f32_16x16x32_bf16 v[160:163], a[12:15], v[40:43], v[160:163]
 ds_read_b128 a[8:11], v14 offset:8192
 v_mfma_f32_16x16x32_bf16 v[164:167], a[12:15], v[44:47], v[164:167]
 s_waitcnt lgkmcnt(4)
 v_mfma_f32_16x16x32_bf16 v[160:163], a[16:19], v[48:51], v[160:163]
 ds_read_b128 a[12:15], v14 offset:9216
 buffer_load_dwordx4 v4, s[8:11], s61 offen sc1 lds
 s_add_u32 s61, s61, 4096
 s_add_u32 m0, m0, 4096
 v_mfma_f32_16x16x32_bf16 v[164:167], a[16:19], v[52:55], v[164:167]
 s_waitcnt lgkmcnt(4)
 v_mfma_f32_16x16x32_bf16 v[160:163], a[20:23], v[56:59], v[160:163]
 ds_read_b128 a[16:19], v14 offset:10240
 v_mfma_f32_16x16x32_bf16 v[164:167], a[20:23], v[60:63], v[164:167]
 s_waitcnt lgkmcnt(4)
 v_mfma_f32_16x16x32_bf16 v[160:163], a[0:3], v[64:67], v[160:163]
 ds_read_b128 a[20:23], v14 offset:11264
 v_mfma_f32_16x16x32_bf16 v[164:167], a[0:3], v[68:71], v[164:167]
 buffer_load_dwordx4 v4, s[8:11], s61 offen sc1 lds
 s_add_u32 s61, s61, 4096
 s_add_u32 m0, m0, 4096
 s_waitcnt lgkmcnt(4)
 v_mfma_f32_16x16x32_bf16 v[160:163], a[4:7], v[72:75], v[160:163]
 ds_read_b128 a[0:3], v14 offset:12288
 v_mfma_f32_16x16x32_bf16 v[164:167], a[4:7], v[76:79], v[164:167]
 s_waitcnt lgkmcnt(4)
 v_mfma_f32_16x16x32_bf16 v[160:163], a[8:11], v[80:83], v[160:163]
 ds_read_b128 a[4:7], v14 offset:13312
 v_mfma_f32_16x16x32_bf16 v[164:167], a[8:11], v[84:87], v[164:167]
 s_waitcnt lgkmcnt(4)
 v_mfma_f32_16x16x32_bf16 v[160:163], a[12:15], v[88:91], v[160:163]
 buffer_load_dwordx4 v4, s[8:11], s61 offen sc1 lds
 s_add_u32 s61, s61, 4096
 s_add_u32 m0, m0, 4096
 ds_read_b128 a[8:11], v14 offset:14336
 v_mfma_f32_16x16x32_bf16 v[164:167], a[12:15], v[92:95], v[164:167]
 s_waitcnt lgkmcnt(4)
 v_mfma_f32_16x16x32_bf16 v[160:163], a[16:19], v[96:99], v[160:163]
 ds_read_b128 a[12:15], v14 offset:15360
 v_mfma_f32_16x16x32_bf16 v[164:167], a[16:19], v[100:103], v[164:167]
 s_waitcnt lgkmcnt(4)
 v_mfma_f32_16x16x32_bf16 v[160:163], a[20:23], v[104:107], v[160:163]
 ds_read_b128 a[16:19], v14 offset:16384
 buffer_load_dwordx4 v4, s[8:11], s61 offen sc1 lds
 s_add_u32 s61, s61, 4096
 s_add_u32 m0, m0, 4096
 v_mfma_f32_16x16x32_bf16 v[164:167], a[20:23], v[108:111], v[164:167]
 s_waitcnt lgkmcnt(4)
 v_mfma_f32_16x16x32_bf16 v[160:163], a[0:3], v[112:115], v[160:163]
 ds_read_b128 a[20:23], v14 offset:17408
 v_mfma_f32_16x16x32_bf16 v[164:167], a[0:3], v[116:119], v[164:167]
 s_waitcnt lgkmcnt(4)
 v_mfma_f32_16x16x32_bf16 v[160:163], a[4:7], v[120:123], v[160:163]
 v_mfma_f32_16x16x32_bf16 v[164:167], a[4:7], v[124:127], v[164:167]
 s_waitcnt lgkmcnt(3)
 v_mfma_f32_16x16x32_bf16 v[160:163], a[8:11], v[128:131], v[160:163]
 buffer_load_dwordx4 v4, s[8:11], s61 offen sc1 lds
 s_add_u32 s61, s61, 4096
 s_add_u32 m0, m0, 4096
 v_mfma_f32_16x16x32_bf16 v[164:167], a[8:11], v[132:135], v[164:167]
 s_waitcnt lgkmcnt(2)
 v_mfma_f32_16x16x32_bf16 v[160:163], a[12:15], v[136:139], v[160:163]
 v_mfma_f32_16x16x32_bf16 v[164:167], a[12:15], v[140:143], v[164:167]
 s_waitcnt lgkmcnt(1)
 v_mfma_f32_16x16x32_bf16 v[160:163], a[16:19], v[144:147], v[160:163]
 v_mfma_f32_16x16x32_bf16 v[164:167], a[16:19], v[148:151], v[164:167]
 s_waitcnt lgkmcnt(0)
 v_mfma_f32_16x16x32_bf16 v[160:163], a[20:23], v[152:155], v[160:163]
 v_mfma_f32_16x16x32_bf16 v[164:167], a[20:23], v[156:159], v[164:167]
 s_cmp_ge_u32 s20, 2
 s_cbranch_scc1 L_p3r1
 buffer_load_dwordx4 v4, s[8:11], s61 offen sc1 lds
 s_add_u32 s61, s61, 4096
 s_add_u32 m0, m0, 4096
L_p3r1:
 s_lshr_b32 s39, s38, 1
 s_lshl_b32 s39, s39, 3
 s_and_b32 s3, s38, 1
 s_add_u32 s39, s39, s3
 s_mul_i32 s39, s39, 16640
 s_add_u32 s39, s39, s31
 s_add_u32 s39, s39, 0x12f0000
 v_add_u32 v14, 18432, v14
 s_add_u32 s38, s38, 16
 v_cvt_pk_bf16_f32 v168, v160, v161
 v_min_u32 v168, -2, v168
 v_cvt_pk_bf16_f32 v169, v162, v163
 v_min_u32 v169, -2, v169
 v_cvt_pk_bf16_f32 v170, v164, v165
 v_min_u32 v170, -2, v170
 v_cvt_pk_bf16_f32 v171, v166, v167
 v_min_u32 v171, -2, v171
 buffer_store_dwordx4 v[168:171], v6, s[8:11], s39 offen sc1
 s_cmp_ge_u32 s23, 4
 s_cbranch_scc1 L_p3_nog
 s_waitcnt vmcnt(14)
 s_barrier
 ds_read_b128 a[0:3], v14 offset:0
 ds_read_b128 a[4:7], v14 offset:1024
 ds_read_b128 a[8:11], v14 offset:2048
 ds_read_b128 a[12:15], v14 offset:3072
 ds_read_b128 a[16:19], v14 offset:4096
 s_waitcnt lgkmcnt(4)
 v_mfma_f32_16x16x32_bf16 v[160:163], a[0:3], v[16:19], 0
 ds_read_b128 a[20:23], v14 offset:5120
 v_mfma_f32_16x16x32_bf16 v[164:167], a[0:3], v[20:23], 0
 s_waitcnt lgkmcnt(4)
 v_mfma_f32_16x16x32_bf16 v[160:163], a[4:7], v[24:27], v[160:163]
 ds_read_b128 a[0:3], v14 offset:6144
 v_mfma_f32_16x16x32_bf16 v[164:167], a[4:7], v[28:31], v[164:167]
 s_waitcnt lgkmcnt(4)
 v_mfma_f32_16x16x32_bf16 v[160:163], a[8:11], v[32:35], v[160:163]
 ds_read_b128 a[4:7], v14 offset:7168
 v_mfma_f32_16x16x32_bf16 v[164:167], a[8:11], v[36:39], v[164:167]
 s_waitcnt lgkmcnt(4)
 v_mfma_f32_16x16x32_bf16 v[160:163], a[12:15], v[40:43], v[160:163]
 ds_read_b128 a[8:11], v14 offset:8192
 v_mfma_f32_16x16x32_bf16 v[164:167], a[12:15], v[44:47], v[164:167]
 s_waitcnt lgkmcnt(4)
 v_mfma_f32_16x16x32_bf16 v[160:163], a[16:19], v[48:51], v[160:163]
 ds_read_b128 a[12:15], v14 offset:9216
 v_mfma_f32_16x16x32_bf16 v[164:167], a[16:19], v[52:55], v[164:167]
 s_waitcnt lgkmcnt(4)
 v_mfma_f32_16x16x32_bf16 v[160:163], a[20:23], v[56:59], v[160:163]
 ds_read_b128 a[16:19], v14 offset:10240
 v_mfma_f32_16x16x32_bf16 v[164:167], a[20:23], v[60:63], v[164:167]
 s_waitcnt lgkmcnt(4)
 v_mfma_f32_16x16x32_bf16 v[160:163], a[0:3], v[64:67], v[160:163]
 ds_read_b128 a[20:23], v14 offset:11264
 v_mfma_f32_16x16x32_bf16 v[164:167], a[0:3], v[68:71], v[164:167]
 s_waitcnt lgkmcnt(4)
 v_mfma_f32_16x16x32_bf16 v[160:163], a[4:7], v[72:75], v[160:163]
 ds_read_b128 a[0:3], v14 offset:12288
 v_mfma_f32_16x16x32_bf16 v[164:167], a[4:7], v[76:79], v[164:167]
 s_waitcnt lgkmcnt(4)
 v_mfma_f32_16x16x32_bf16 v[160:163], a[8:11], v[80:83], v[160:163]
 ds_read_b128 a[4:7], v14 offset:13312
 v_mfma_f32_16x16x32_bf16 v[164:167], a[8:11], v[84:87], v[164:167]
 s_waitcnt lgkmcnt(4)
 v_mfma_f32_16x16x32_bf16 v[160:163], a[12:15], v[88:91], v[160:163]
 ds_read_b128 a[8:11], v14 offset:14336
 v_mfma_f32_16x16x32_bf16 v[164:167], a[12:15], v[92:95], v[164:167]
 s_waitcnt lgkmcnt(4)
 v_mfma_f32_16x16x32_bf16 v[160:163], a[16:19], v[96:99], v[160:163]
 ds_read_b128 a[12:15], v14 offset:15360
 v_mfma_f32_16x16x32_bf16 v[164:167], a[16:19], v[100:103], v[164:167]
 s_waitcnt lgkmcnt(4)
 v_mfma_f32_16x16x32_bf16 v[160:163], a[20:23], v[104:107], v[160:163]
 ds_read_b128 a[16:19], v14 offset:16384
 v_mfma_f32_16x16x32_bf16 v[164:167], a[20:23], v[108:111], v[164:167]
 s_waitcnt lgkmcnt(4)
 v_mfma_f32_16x16x32_bf16 v[160:163], a[0:3], v[112:115], v[160:163]
 ds_read_b128 a[20:23], v14 offset:17408
 v_mfma_f32_16x16x32_bf16 v[164:167], a[0:3], v[116:119], v[164:167]
 s_waitcnt lgkmcnt(4)
 v_mfma_f32_16x16x32_bf16 v[160:163], a[4:7], v[120:123], v[160:163]
 v_mfma_f32_16x16x32_bf16 v[164:167], a[4:7], v[124:127], v[164:167]
 s_waitcnt lgkmcnt(3)
 v_mfma_f32_16x16x32_bf16 v[160:163], a[8:11], v[128:131], v[160:163]
 v_mfma_f32_16x16x32_bf16 v[164:167], a[8:11], v[132:135], v[164:167]
 s_waitcnt lgkmcnt(2)
 v_mfma_f32_16x16x32_bf16 v[160:163], a[12:15], v[136:139], v[160:163]
 v_mfma_f32_16x16x32_bf16 v[164:167], a[12:15], v[140:143], v[164:167]
 s_waitcnt lgkmcnt(1)
 v_mfma_f32_16x16x32_bf16 v[160:163], a[16:19], v[144:147], v[160:163]
 v_mfma_f32_16x16x32_bf16 v[164:167], a[16:19], v[148:151], v[164:167]
 s_waitcnt lgkmcnt(0)
 v_mfma_f32_16x16x32_bf16 v[160:163], a[20:23], v[152:155], v[160:163]
 v_mfma_f32_16x16x32_bf16 v[164:167], a[20:23], v[156:159], v[164:167]
 s_lshr_b32 s39, s38, 1
 s_lshl_b32 s39, s39, 3
 s_and_b32 s3, s38, 1
 s_add_u32 s39, s39, s3
 s_mul_i32 s39, s39, 16640
 s_add_u32 s39, s39, s31
 s_add_u32 s39, s39, 0x12f0000
 v_add_u32 v14, 18432, v14
 s_add_u32 s38, s38, 16
 v_cvt_pk_bf16_f32 v168, v160, v161
 v_min_u32 v168, -2, v168
 v_cvt_pk_bf16_f32 v169, v162, v163
 v_min_u32 v169, -2, v169
 v_cvt_pk_bf16_f32 v170, v164, v165
 v_min_u32 v170, -2, v170
 v_cvt_pk_bf16_f32 v171, v166, v167
 v_min_u32 v171, -2, v171
 buffer_store_dwordx4 v[168:171], v6, s[8:11], s39 offen sc1
L_p3_nog:
 s_and_b32 s23, s2, 7
 s_lshl_b32 s23, s23, 2
 s_lshr_b32 s3, s2, 3
 s_and_b32 s24, s3, 3
 s_add_u32 s23, s23, s24
 s_lshr_b32 s24, s3, 2
 s_lshl2_add_u32 s25, s23, s20
 s_and_b32 s21, s24, 1
 s_xor_b32 s21, s21, 1
 s_lshl_b32 s22, s24, 2
 s_lshr_b32 s27, s24, 1
 s_add_u32 s27, s27, 32
 s_cmp_eq_u32 s45, 0
 s_mov_b32 s40, 0x6f0000
 s_mov_b32 s3, 0x10a0000
 s_cselect_b32 s40, s40, s3
 s_mov_b32 s41, 0x940000
 s_mov_b32 s3, 0x12f0000
 s_cselect_b32 s41, s41, s3
 s_mul_i32 s28, s25, 18688
 s_add_u32 s28, s28, s40
 v_add_u32 v5, 0x10000, v4
 v_lshlrev_b32 v10, 8, v3
 v_lshl_add_u32 v10, v2, 3, v10
 v_mul_u32_u24 v6, 33280, v3
 v_lshl_add_u32 v6, v2, 4, v6
 s_lshr_b32 s30, s25, 1
 s_lshl_b32 s30, s30, 8
 s_and_b32 s3, s25, 1
 s_lshl3_add_u32 s30, s3, s30
 s_add_u32 s30, s30, s41
 s_mul_i32 s31, s24, 266240
 s_add_u32 s31, s31, s30
 s_lshr_b32 s3, s27, 1
 s_lshl_b32 s3, s3, 3
 s_and_b32 s32, s27, 1
 s_add_u32 s3, s3, s32
 s_mul_i32 s3, s3, 16640
 s_add_u32 s30, s30, s3
 s_add_u32 s29, s28, 4096
 s_add_u32 s33, s28, 8192
 s_add_u32 s35, s28, 12288
 s_add_u32 s36, s28, 16384
 s_mov_b32 s59, 0
 buffer_load_dwordx4 v[16:19], v4, s[8:11], s28 offen offset:0 sc1
 buffer_load_dwordx4 v[20:23], v4, s[8:11], s28 offen offset:1024 sc1
 buffer_load_dwordx4 v[24:27], v4, s[8:11], s28 offen offset:2048 sc1
 buffer_load_dwordx4 v[28:31], v4, s[8:11], s28 offen offset:3072 sc1
 buffer_load_dwordx4 v[32:35], v4, s[8:11], s29 offen offset:0 sc1
 buffer_load_dwordx4 v[36:39], v4, s[8:11], s29 offen offset:1024 sc1
 buffer_load_dwordx4 v[40:43], v4, s[8:11], s29 offen offset:2048 sc1
 buffer_load_dwordx4 v[44:47], v4, s[8:11], s29 offen offset:3072 sc1
 s_waitcnt vmcnt(8)
 s_barrier
 ds_read_b128 a[0:3], v4 offset:0
 ds_read_b128 a[4:7], v4 offset:1024
 ds_read_b128 a[8:11], v4 offset:2048
 ds_read_b128 a[12:15], v4 offset:3072
 ds_read_b128 a[16:19], v5 offset:8192
L_p4_c0:
 s_waitcnt vmcnt(7)
 v_max_u32 v11, v16, v17
 v_max3_u32 v11, v18, v19, v11
 s_waitcnt vmcnt(6)
 v_max3_u32 v11, v20, v21, v11
 v_max3_u32 v11, v22, v23, v11
 v_cmp_eq_u32 vcc, -1, v11
 s_cbranch_vccnz L_p4_f0
L_p4_o0:
 s_waitcnt lgkmcnt(4)
 v_mfma_f32_16x16x32_bf16 v[88:91], a[0:3], v[16:19], 0
 ds_read_b128 a[20:23], v4 offset:4096
 s_waitcnt lgkmcnt(4)
 v_mfma_f32_16x16x32_bf16 v[92:95], a[4:7], v[16:19], 0
 ds_read_b128 a[24:27], v4 offset:5120
 s_waitcnt lgkmcnt(4)
 v_mfma_f32_16x16x32_bf16 v[96:99], a[8:11], v[16:19], 0
 ds_read_b128 a[28:31], v4 offset:6144
 s_waitcnt lgkmcnt(4)
 v_mfma_f32_16x16x32_bf16 v[100:103], a[12:15], v[16:19], 0
 ds_read_b128 a[32:35], v4 offset:7168
 s_waitcnt lgkmcnt(4)
 v_mfma_f32_16x16x32_bf16 v[104:107], a[16:19], v[16:19], 0
 ds_read_b128 a[36:39], v5 offset:9216
 buffer_load_dwordx4 v[48:51], v4, s[8:11], s33 offen offset:0 sc1
 s_waitcnt lgkmcnt(4)
 v_mfma_f32_16x16x32_bf16 v[88:91], a[20:23], v[20:23], v[88:91]
 ds_read_b128 a[0:3], v4 offset:8192
 s_waitcnt lgkmcnt(4)
 v_mfma_f32_16x16x32_bf16 v[92:95], a[24:27], v[20:23], v[92:95]
 ds_read_b128 a[4:7], v4 offset:9216
 s_waitcnt lgkmcnt(4)
 v_mfma_f32_16x16x32_bf16 v[96:99], a[28:31], v[20:23], v[96:99]
 ds_read_b128 a[8:11], v4 offset:10240
 s_waitcnt lgkmcnt(4)
 v_mfma_f32_16x16x32_bf16 v[100:103], a[32:35], v[20:23], v[100:103]
 ds_read_b128 a[12:15], v4 offset:11264
 s_waitcnt lgkmcnt(4)
 v_mfma_f32_16x16x32_bf16 v[104:107], a[36:39], v[20:23], v[104:107]
 ds_read_b128 a[16:19], v5 offset:10240
 buffer_load_dwordx4 v[52:55], v4, s[8:11], s33 offen offset:1024 sc1
L_p4_c2:
 s_waitcnt vmcnt(7)
 v_max_u32 v11, v24, v25
 v_max3_u32 v11, v26, v27, v11
 s_waitcnt vmcnt(6)
 v_max3_u32 v11, v28, v29, v11
 v_max3_u32 v11, v30, v31, v11
 v_cmp_eq_u32 vcc, -1, v11
 s_cbranch_vccnz L_p4_f2
L_p4_o2:
 s_waitcnt lgkmcnt(4)
 v_mfma_f32_16x16x32_bf16 v[88:91], a[0:3], v[24:27], v[88:91]
 ds_read_b128 a[20:23], v4 offset:12288
 s_waitcnt lgkmcnt(4)
 v_mfma_f32_16x16x32_bf16 v[92:95], a[4:7], v[24:27], v[92:95]
 ds_read_b128 a[24:27], v4 offset:13312
 s_waitcnt lgkmcnt(4)
 v_mfma_f32_16x16x32_bf16 v[96:99], a[8:11], v[24:27], v[96:99]
 ds_read_b128 a[28:31], v4 offset:14336
 s_waitcnt lgkmcnt(4)
 v_mfma_f32_16x16x32_bf16 v[100:103], a[12:15], v[24:27], v[100:103]
 ds_read_b128 a[32:35], v4 offset:15360
 s_waitcnt lgkmcnt(4)
 v_mfma_f32_16x16x32_bf16 v[104:107], a[16:19], v[24:27], v[104:107]
 ds_read_b128 a[36:39], v5 offset:11264
 buffer_load_dwordx4 v[56:59], v4, s[8:11], s33 offen offset:2048 sc1
 s_waitcnt lgkmcnt(4)
 v_mfma_f32_16x16x32_bf16 v[88:91], a[20:23], v[28:31], v[88:91]
 ds_read_b128 a[0:3], v4 offset:16384
 s_waitcnt lgkmcnt(4)
 v_mfma_f32_16x16x32_bf16 v[92:95], a[24:27], v[28:31], v[92:95]
 ds_read_b128 a[4:7], v4 offset:17408
 s_waitcnt lgkmcnt(4)
 v_mfma_f32_16x16x32_bf16 v[96:99], a[28:31], v[28:31], v[96:99]
 ds_read_b128 a[8:11], v4 offset:18432
 s_waitcnt lgkmcnt(4)
 v_mfma_f32_16x16x32_bf16 v[100:103], a[32:35], v[28:31], v[100:103]
 ds_read_b128 a[12:15], v4 offset:19456
 s_waitcnt lgkmcnt(4)
 v_mfma_f32_16x16x32_bf16 v[104:107], a[36:39], v[28:31], v[104:107]
 ds_read_b128 a[16:19], v5 offset:12288
 buffer_load_dwordx4 v[60:63], v4, s[8:11], s33 offen offset:3072 sc1
L_p4_c4:
 s_waitcnt vmcnt(7)
 v_max_u32 v11, v32, v33
 v_max3_u32 v11, v34, v35, v11
 s_waitcnt vmcnt(6)
 v_max3_u32 v11, v36, v37, v11
 v_max3_u32 v11, v38, v39, v11
 v_cmp_eq_u32 vcc, -1, v11
 s_cbranch_vccnz L_p4_f4
L_p4_o4:
 s_waitcnt lgkmcnt(4)
 v_mfma_f32_16x16x32_bf16 v[88:91], a[0:3], v[32:35], v[88:91]
 ds_read_b128 a[20:23], v4 offset:20480
 s_waitcnt lgkmcnt(4)
 v_mfma_f32_16x16x32_bf16 v[92:95], a[4:7], v[32:35], v[92:95]
 ds_read_b128 a[24:27], v4 offset:21504
 s_waitcnt lgkmcnt(4)
 v_mfma_f32_16x16x32_bf16 v[96:99], a[8:11], v[32:35], v[96:99]
 ds_read_b128 a[28:31], v4 offset:22528
 s_waitcnt lgkmcnt(4)
 v_mfma_f32_16x16x32_bf16 v[100:103], a[12:15], v[32:35], v[100:103]
 ds_read_b128 a[32:35], v4 offset:23552
 s_waitcnt lgkmcnt(4)
 v_mfma_f32_16x16x32_bf16 v[104:107], a[16:19], v[32:35], v[104:107]
 ds_read_b128 a[36:39], v5 offset:13312
 buffer_load_dwordx4 v[64:67], v4, s[8:11], s35 offen offset:0 sc1
 s_waitcnt lgkmcnt(4)
 v_mfma_f32_16x16x32_bf16 v[88:91], a[20:23], v[36:39], v[88:91]
 ds_read_b128 a[0:3], v4 offset:24576
 s_waitcnt lgkmcnt(4)
 v_mfma_f32_16x16x32_bf16 v[92:95], a[24:27], v[36:39], v[92:95]
 ds_read_b128 a[4:7], v4 offset:25600
 s_waitcnt lgkmcnt(4)
 v_mfma_f32_16x16x32_bf16 v[96:99], a[28:31], v[36:39], v[96:99]
 ds_read_b128 a[8:11], v4 offset:26624
 s_waitcnt lgkmcnt(4)
 v_mfma_f32_16x16x32_bf16 v[100:103], a[32:35], v[36:39], v[100:103]
 ds_read_b128 a[12:15], v4 offset:27648
 s_waitcnt lgkmcnt(4)
 v_mfma_f32_16x16x32_bf16 v[104:107], a[36:39], v[36:39], v[104:107]
 ds_read_b128 a[16:19], v5 offset:14336
 buffer_load_dwordx4 v[68:71], v4, s[8:11], s35 offen offset:1024 sc1
L_p4_c6:
 s_waitcnt vmcnt(7)
 v_max_u32 v11, v40, v41
 v_max3_u32 v11, v42, v43, v11
 s_waitcnt vmcnt(6)
 v_max3_u32 v11, v44, v45, v11
 v_max3_u32 v11, v46, v47, v11
 v_cmp_eq_u32 vcc, -1, v11
 s_cbranch_vccnz L_p4_f6
L_p4_o6:
 s_waitcnt lgkmcnt(4)
 v_mfma_f32_16x16x32_bf16 v[88:91], a[0:3], v[40:43], v[88:91]
 ds_read_b128 a[20:23], v4 offset:28672
 s_waitcnt lgkmcnt(4)
 v_mfma_f32_16x16x32_bf16 v[92:95], a[4:7], v[40:43], v[92:95]
 ds_read_b128 a[24:27], v4 offset:29696
 s_waitcnt lgkmcnt(4)
 v_mfma_f32_16x16x32_bf16 v[96:99], a[8:11], v[40:43], v[96:99]
 ds_read_b128 a[28:31], v4 offset:30720
 s_waitcnt lgkmcnt(4)
 v_mfma_f32_16x16x32_bf16 v[100:103], a[12:15], v[40:43], v[100:103]
 ds_read_b128 a[32:35], v4 offset:31744
 s_waitcnt lgkmcnt(4)
 v_mfma_f32_16x16x32_bf16 v[104:107], a[16:19], v[40:43], v[104:107]
 ds_read_b128 a[36:39], v5 offset:15360
 buffer_load_dwordx4 v[72:75], v4, s[8:11], s35 offen offset:2048 sc1
 s_waitcnt lgkmcnt(4)
 v_mfma_f32_16x16x32_bf16 v[88:91], a[20:23], v[44:47], v[88:91]
 ds_read_b128 a[0:3], v4 offset:32768
 s_waitcnt lgkmcnt(4)
 v_mfma_f32_16x16x32_bf16 v[92:95], a[24:27], v[44:47], v[92:95]
 ds_read_b128 a[4:7], v4 offset:33792
 s_waitcnt lgkmcnt(4)
 v_mfma_f32_16x16x32_bf16 v[96:99], a[28:31], v[44:47], v[96:99]
 ds_read_b128 a[8:11], v4 offset:34816
 s_waitcnt lgkmcnt(4)
 v_mfma_f32_16x16x32_bf16 v[100:103], a[32:35], v[44:47], v[100:103]
 ds_read_b128 a[12:15], v4 offset:35840
 s_waitcnt lgkmcnt(4)
 v_mfma_f32_16x16x32_bf16 v[104:107], a[36:39], v[44:47], v[104:107]
 ds_read_b128 a[16:19], v5 offset:16384
 buffer_load_dwordx4 v[76:79], v4, s[8:11], s35 offen offset:3072 sc1
L_p4_c8:
 s_waitcnt vmcnt(7)
 v_max_u32 v11, v48, v49
 v_max3_u32 v11, v50, v51, v11
 s_waitcnt vmcnt(6)
 v_max3_u32 v11, v52, v53, v11
 v_max3_u32 v11, v54, v55, v11
 v_cmp_eq_u32 vcc, -1, v11
 s_cbranch_vccnz L_p4_f8
L_p4_o8:
 s_waitcnt lgkmcnt(4)
 v_mfma_f32_16x16x32_bf16 v[88:91], a[0:3], v[48:51], v[88:91]
 ds_read_b128 a[20:23], v4 offset:36864
 s_waitcnt lgkmcnt(4)
 v_mfma_f32_16x16x32_bf16 v[92:95], a[4:7], v[48:51], v[92:95]
 ds_read_b128 a[24:27], v4 offset:37888
 s_waitcnt lgkmcnt(4)
 v_mfma_f32_16x16x32_bf16 v[96:99], a[8:11], v[48:51], v[96:99]
 ds_read_b128 a[28:31], v4 offset:38912
 buffer_load_dwordx2 v[80:81], v10, s[8:11], s36 offen offset:0 sc1
 s_waitcnt lgkmcnt(4)
 v_mfma_f32_16x16x32_bf16 v[100:103], a[12:15], v[48:51], v[100:103]
 ds_read_b128 a[32:35], v4 offset:39936
 s_waitcnt lgkmcnt(4)
 v_mfma_f32_16x16x32_bf16 v[104:107], a[16:19], v[48:51], v[104:107]
 ds_read_b128 a[36:39], v5 offset:17408
 buffer_load_dwordx2 v[82:83], v10, s[8:11], s36 offen offset:128 sc1
 s_waitcnt lgkmcnt(4)
 v_mfma_f32_16x16x32_bf16 v[88:91], a[20:23], v[52:55], v[88:91]
 ds_read_b128 a[0:3], v4 offset:40960
 s_waitcnt lgkmcnt(4)
 v_mfma_f32_16x16x32_bf16 v[92:95], a[24:27], v[52:55], v[92:95]
 ds_read_b128 a[4:7], v4 offset:41984
 s_waitcnt lgkmcnt(4)
 v_mfma_f32_16x16x32_bf16 v[96:99], a[28:31], v[52:55], v[96:99]
 ds_read_b128 a[8:11], v4 offset:43008
 buffer_load_dwordx2 v[84:85], v10, s[8:11], s36 offen offset:1024 sc1
 s_waitcnt lgkmcnt(4)
 v_mfma_f32_16x16x32_bf16 v[100:103], a[32:35], v[52:55], v[100:103]
 ds_read_b128 a[12:15], v4 offset:44032
 s_waitcnt lgkmcnt(4)
 v_mfma_f32_16x16x32_bf16 v[104:107], a[36:39], v[52:55], v[104:107]
 ds_read_b128 a[16:19], v5 offset:18432
 buffer_load_dwordx2 v[86:87], v10, s[8:11], s36 offen offset:1152 sc1
L_p4_c10:
 s_waitcnt vmcnt(9)
 v_max_u32 v11, v56, v57
 v_max3_u32 v11, v58, v59, v11
 s_waitcnt vmcnt(8)
 v_max3_u32 v11, v60, v61, v11
 v_max3_u32 v11, v62, v63, v11
 v_cmp_eq_u32 vcc, -1, v11
 s_cbranch_vccnz L_p4_f10
L_p4_o10:
 s_waitcnt lgkmcnt(4)
 v_mfma_f32_16x16x32_bf16 v[88:91], a[0:3], v[56:59], v[88:91]
 ds_read_b128 a[20:23], v4 offset:45056
 s_waitcnt lgkmcnt(4)
 v_mfma_f32_16x16x32_bf16 v[92:95], a[4:7], v[56:59], v[92:95]
 ds_read_b128 a[24:27], v4 offset:46080
 s_waitcnt lgkmcnt(4)
 v_mfma_f32_16x16x32_bf16 v[96:99], a[8:11], v[56:59], v[96:99]
 ds_read_b128 a[28:31], v4 offset:47104
 s_waitcnt lgkmcnt(4)
 v_mfma_f32_16x16x32_bf16 v[100:103], a[12:15], v[56:59], v[100:103]
 ds_read_b128 a[32:35], v4 offset:48128
 s_waitcnt lgkmcnt(4)
 v_mfma_f32_16x16x32_bf16 v[104:107], a[16:19], v[56:59], v[104:107]
 ds_read_b128 a[36:39], v5 offset:19456
 s_add_u32 s3, s31, 0
 buffer_load_dwordx2 v[108:109], v6, s[8:11], s3 offen sc1
 s_waitcnt lgkmcnt(4)
 v_mfma_f32_16x16x32_bf16 v[88:91], a[20:23], v[60:63], v[88:91]
 ds_read_b128 a[0:3], v4 offset:49152
 s_waitcnt lgkmcnt(4)
 v_mfma_f32_16x16x32_bf16 v[92:95], a[24:27], v[60:63], v[92:95]
 ds_read_b128 a[4:7], v4 offset:50176
 s_waitcnt lgkmcnt(4)
 v_mfma_f32_16x16x32_bf16 v[96:99], a[28:31], v[60:63], v[96:99]
 ds_read_b128 a[8:11], v4 offset:51200
 s_waitcnt lgkmcnt(4)
 v_mfma_f32_16x16x32_bf16 v[100:103], a[32:35], v[60:63], v[100:103]
 ds_read_b128 a[12:15], v4 offset:52224
 s_waitcnt lgkmcnt(4)
 v_mfma_f32_16x16x32_bf16 v[104:107], a[36:39], v[60:63], v[104:107]
 ds_read_b128 a[16:19], v5 offset:20480
 s_add_u32 s3, s31, 16640
 buffer_load_dwordx2 v[110:111], v6, s[8:11], s3 offen sc1
L_p4_c12:
 s_waitcnt vmcnt(9)
 v_max_u32 v11, v64, v65
 v_max3_u32 v11, v66, v67, v11
 s_waitcnt vmcnt(8)
 v_max3_u32 v11, v68, v69, v11
 v_max3_u32 v11, v70, v71, v11
 v_cmp_eq_u32 vcc, -1, v11
 s_cbranch_vccnz L_p4_f12
L_p4_o12:
 s_waitcnt lgkmcnt(4)
 v_mfma_f32_16x16x32_bf16 v[88:91], a[0:3], v[64:67], v[88:91]
 ds_read_b128 a[20:23], v4 offset:53248
 s_waitcnt lgkmcnt(4)
 v_mfma_f32_16x16x32_bf16 v[92:95], a[4:7], v[64:67], v[92:95]
 ds_read_b128 a[24:27], v4 offset:54272
 s_waitcnt lgkmcnt(4)
 v_mfma_f32_16x16x32_bf16 v[96:99], a[8:11], v[64:67], v[96:99]
 ds_read_b128 a[28:31], v4 offset:55296
 s_waitcnt lgkmcnt(4)
 v_mfma_f32_16x16x32_bf16 v[100:103], a[12:15], v[64:67], v[100:103]
 ds_read_b128 a[32:35], v4 offset:56320
 s_waitcnt lgkmcnt(4)
 v_mfma_f32_16x16x32_bf16 v[104:107], a[16:19], v[64:67], v[104:107]
 ds_read_b128 a[36:39], v5 offset:21504
 s_add_u32 s3, s31, 133120
 buffer_load_dwordx2 v[112:113], v6, s[8:11], s3 offen sc1
 s_waitcnt lgkmcnt(4)
 v_mfma_f32_16x16x32_bf16 v[88:91], a[20:23], v[68:71], v[88:91]
 ds_read_b128 a[0:3], v4 offset:57344
 s_waitcnt lgkmcnt(4)
 v_mfma_f32_16x16x32_bf16 v[92:95], a[24:27], v[68:71], v[92:95]
 ds_read_b128 a[4:7], v4 offset:58368
 s_waitcnt lgkmcnt(4)
 v_mfma_f32_16x16x32_bf16 v[96:99], a[28:31], v[68:71], v[96:99]
 ds_read_b128 a[8:11], v4 offset:59392
 s_waitcnt lgkmcnt(4)
 v_mfma_f32_16x16x32_bf16 v[100:103], a[32:35], v[68:71], v[100:103]
 ds_read_b128 a[12:15], v4 offset:60416
 s_waitcnt lgkmcnt(4)
 v_mfma_f32_16x16x32_bf16 v[104:107], a[36:39], v[68:71], v[104:107]
 ds_read_b128 a[16:19], v5 offset:22528
 s_add_u32 s3, s31, 149760
 buffer_load_dwordx2 v[114:115], v6, s[8:11], s3 offen sc1
L_p4_c14:
 s_waitcnt vmcnt(9)
 v_max_u32 v11, v72, v73
 v_max3_u32 v11, v74, v75, v11
 s_waitcnt vmcnt(8)
 v_max3_u32 v11, v76, v77, v11
 v_max3_u32 v11, v78, v79, v11
 v_cmp_eq_u32 vcc, -1, v11
 s_cbranch_vccnz L_p4_f14
L_p4_o14:
 s_waitcnt lgkmcnt(4)
 v_mfma_f32_16x16x32_bf16 v[88:91], a[0:3], v[72:75], v[88:91]
 ds_read_b128 a[20:23], v4 offset:61440
 s_waitcnt lgkmcnt(4)
 v_mfma_f32_16x16x32_bf16 v[92:95], a[4:7], v[72:75], v[92:95]
 ds_read_b128 a[24:27], v4 offset:62464
 s_waitcnt lgkmcnt(4)
 v_mfma_f32_16x16x32_bf16 v[96:99], a[8:11], v[72:75], v[96:99]
 ds_read_b128 a[28:31], v4 offset:63488
 s_waitcnt lgkmcnt(4)
 v_mfma_f32_16x16x32_bf16 v[100:103], a[12:15], v[72:75], v[100:103]
 ds_read_b128 a[32:35], v4 offset:64512
 s_waitcnt lgkmcnt(4)
 v_mfma_f32_16x16x32_bf16 v[104:107], a[16:19], v[72:75], v[104:107]
 ds_read_b128 a[36:39], v5 offset:23552
 buffer_load_dwordx2 v[116:117], v6, s[8:11], s30 offen sc1
 s_waitcnt lgkmcnt(4)
 v_mfma_f32_16x16x32_bf16 v[88:91], a[20:23], v[76:79], v[88:91]
 ds_read_b128 a[0:3], v5 offset:0
 s_waitcnt lgkmcnt(4)
 v_mfma_f32_16x16x32_bf16 v[92:95], a[24:27], v[76:79], v[92:95]
 ds_read_b128 a[4:7], v5 offset:1024
 s_waitcnt lgkmcnt(4)
 v_mfma_f32_16x16x32_bf16 v[96:99], a[28:31], v[76:79], v[96:99]
 ds_read_b128 a[8:11], v5 offset:2048
 s_waitcnt lgkmcnt(4)
 v_mfma_f32_16x16x32_bf16 v[100:103], a[32:35], v[76:79], v[100:103]
 ds_read_b128 a[12:15], v5 offset:3072
 s_waitcnt lgkmcnt(4)
 v_mfma_f32_16x16x32_bf16 v[104:107], a[36:39], v[76:79], v[104:107]
 ds_read_b128 a[16:19], v5 offset:24576
L_p4_c16:
 s_waitcnt vmcnt(8)
 v_max_u32 v11, v80, v81
 s_waitcnt vmcnt(7)
 v_max3_u32 v11, v82, v83, v11
 s_waitcnt vmcnt(6)
 v_max3_u32 v11, v84, v85, v11
 s_waitcnt vmcnt(5)
 v_max3_u32 v11, v86, v87, v11
 v_cmp_eq_u32 vcc, -1, v11
 s_cbranch_vccnz L_p4_f16
L_p4_o16:
 s_waitcnt lgkmcnt(4)
 v_mfma_f32_16x16x32_bf16 v[88:91], a[0:3], v[80:83], v[88:91]
 ds_read_b128 a[20:23], v5 offset:4096
 s_waitcnt lgkmcnt(4)
 v_mfma_f32_16x16x32_bf16 v[92:95], a[4:7], v[80:83], v[92:95]
 ds_read_b128 a[24:27], v5 offset:5120
 s_waitcnt lgkmcnt(4)
 v_mfma_f32_16x16x32_bf16 v[96:99], a[8:11], v[80:83], v[96:99]
 ds_read_b128 a[28:31], v5 offset:6144
 s_waitcnt lgkmcnt(4)
 v_mfma_f32_16x16x32_bf16 v[100:103], a[12:15], v[80:83], v[100:103]
 ds_read_b128 a[32:35], v5 offset:7168
 s_waitcnt lgkmcnt(4)
 v_mfma_f32_16x16x32_bf16 v[104:107], a[16:19], v[80:83], v[104:107]
 ds_read_b128 a[36:39], v5 offset:25600
 s_waitcnt lgkmcnt(4)
 v_mfma_f32_16x16x32_bf16 v[88:91], a[20:23], v[84:87], v[88:91]
 s_waitcnt lgkmcnt(3)
 v_mfma_f32_16x16x32_bf16 v[92:95], a[24:27], v[84:87], v[92:95]
 s_waitcnt lgkmcnt(2)
 v_mfma_f32_16x16x32_bf16 v[96:99], a[28:31], v[84:87], v[96:99]
 s_waitcnt lgkmcnt(1)
 v_mfma_f32_16x16x32_bf16 v[100:103], a[32:35], v[84:87], v[100:103]
 s_waitcnt lgkmcnt(0)
 v_mfma_f32_16x16x32_bf16 v[104:107], a[36:39], v[84:87], v[104:107]
 s_mov_b32 s34, 0
L_p4_rchk:
 s_waitcnt vmcnt(4)
 v_max_u32 v11, v108, v109
 s_waitcnt vmcnt(3)
 v_max3_u32 v11, v110, v111, v11
 s_waitcnt vmcnt(2)
 v_max3_u32 v11, v112, v113, v11
 s_waitcnt vmcnt(1)
 v_max3_u32 v11, v114, v115, v11
 s_waitcnt vmcnt(0)
 v_max3_u32 v11, v116, v117, v11
 v_cmp_eq_u32 vcc, -1, v11
 s_cbranch_vccnz L_p4_rre
L_p4_rok:
 s_cmp_eq_u32 s24, 0
 s_cselect_b32 s3, 0, 1.0
 v_mov_b32 v9, s3
 v_cmp_eq_u32 vcc, 0, v3
 s_nop 1
 v_cndmask_b32 v9, 1.0, v9, vcc
 v_lshlrev_b32 v120, 16, v108
 v_and_b32 v121, 0xffff0000, v108
 v_lshlrev_b32 v122, 16, v109
 v_and_b32 v123, 0xffff0000, v109
 v_pk_add_f32 v[88:89], v[88:89], v[120:121]
 v_pk_add_f32 v[90:91], v[90:91], v[122:123]
 v_cvt_pk_bf16_f32 v108, v88, v89
 v_cvt_pk_bf16_f32 v109, v90, v91
 v_lshlrev_b32 v120, 16, v110
 v_and_b32 v121, 0xffff0000, v110
 v_lshlrev_b32 v122, 16, v111
 v_and_b32 v123, 0xffff0000, v111
 v_pk_add_f32 v[92:93], v[92:93], v[120:121]
 v_pk_add_f32 v[94:95], v[94:95], v[122:123]
 v_cvt_pk_bf16_f32 v110, v92, v93
 v_cvt_pk_bf16_f32 v111, v94, v95
 v_lshlrev_b32 v120, 16, v112
 v_and_b32 v121, 0xffff0000, v112
 v_lshlrev_b32 v122, 16, v113
 v_and_b32 v123, 0xffff0000, v113
 v_pk_add_f32 v[96:97], v[96:97], v[120:121]
 v_pk_add_f32 v[98:99], v[98:99], v[122:123]
 v_cvt_pk_bf16_f32 v112, v96, v97
 v_cvt_pk_bf16_f32 v113, v98, v99
 v_lshlrev_b32 v120, 16, v114
 v_and_b32 v121, 0xffff0000, v114
 v_lshlrev_b32 v122, 16, v115
 v_and_b32 v123, 0xffff0000, v115
 v_pk_add_f32 v[100:101], v[100:101], v[120:121]
 v_pk_add_f32 v[102:103], v[102:103], v[122:123]
 v_cvt_pk_bf16_f32 v114, v100, v101
 v_cvt_pk_bf16_f32 v115, v102, v103
 v_lshlrev_b32 v120, 16, v116
 v_and_b32 v121, 0xffff0000, v116
 v_lshlrev_b32 v122, 16, v117
 v_and_b32 v123, 0xffff0000, v117
 v_pk_add_f32 v[104:105], v[104:105], v[120:121]
 v_pk_add_f32 v[106:107], v[106:107], v[122:123]
 v_cvt_pk_bf16_f32 v116, v104, v105
 v_cvt_pk_bf16_f32 v117, v106, v107
 s_cmp_lg_u32 s45, 0
 s_cbranch_scc1 L_p4_final
 v_min_u32 v108, -2, v108
 v_min_u32 v109, -2, v109
 v_min_u32 v110, -2, v110
 v_min_u32 v111, -2, v111
 v_min_u32 v112, -2, v112
 v_min_u32 v113, -2, v113
 v_min_u32 v114, -2, v114
 v_min_u32 v115, -2, v115
 v_min_u32 v116, -2, v116
 v_min_u32 v117, -2, v117
 v_mul_f32 v8, v88, v88
 v_mul_f32 v12, v89, v9
 v_fmac_f32 v8, v12, v12
 v_fmac_f32 v8, v90, v90
 v_fmac_f32 v8, v91, v91
 v_fmac_f32 v8, v92, v92
 v_fmac_f32 v8, v93, v93
 v_fmac_f32 v8, v94, v94
 v_fmac_f32 v8, v95, v95
 v_fmac_f32 v8, v96, v96
 v_fmac_f32 v8, v97, v97
 v_fmac_f32 v8, v98, v98
 v_fmac_f32 v8, v99, v99
 v_fmac_f32 v8, v100, v100
 v_fmac_f32 v8, v101, v101
 v_fmac_f32 v8, v102, v102
 v_fmac_f32 v8, v103, v103
 s_cmp_eq_u32 s21, 0
 s_cbranch_scc1 L_p4_ss4
 v_fmac_f32 v8, v104, v104
 v_fmac_f32 v8, v105, v105
 v_fmac_f32 v8, v106, v106
 v_fmac_f32 v8, v107, v107
L_p4_ss4:
 s_mov_b32 s44, 0xc00000
 v_mov_b32 v11, 1.0
 s_and_b32 s38, s20, 1
 s_lshl_b32 s3, s20, 10
 s_add_u32 s3, s3, 155648
 v_mfma_f32_16x16x4_f32 v[128:131], v11, v8, 0
 v_lshl_add_u32 v5, v1, 3, s3
 v_xor_b32 v6, 0x400, v5
 s_cmp_eq_u32 s38, 0
 s_cselect_b64 vcc, -1, 0
 v_cndmask_b32 v132, v108, v112, vcc
 v_cndmask_b32 v108, v112, v108, vcc
 v_cndmask_b32 v133, v109, v113, vcc
 v_cndmask_b32 v109, v113, v109, vcc
 ds_write_b64 v5, v[132:133] offset:0
 v_cndmask_b32 v134, v110, v114, vcc
 v_cndmask_b32 v110, v114, v110, vcc
 v_cndmask_b32 v135, v111, v115, vcc
 v_cndmask_b32 v111, v115, v111, vcc
 ds_write_b64 v5, v[134:135] offset:512
 ds_write_b32 v5, v128 offset:4096
 ds_write_b64 v5, v[116:117] offset:4608
 s_lshr_b32 s3, s25, 1
 s_lshl_b32 s3, s3, 8
 s_add_u32 s39, s3, s44
 v_mul_u32_u24 v7, 33280, v3
 v_lshl_add_u32 v7, v2, 4, v7
 s_lshr_b32 s3, s27, 1
 s_lshl_b32 s3, s3, 3
 s_and_b32 s35, s27, 1
 s_add_u32 s3, s3, s35
 s_mul_i32 s3, s3, 16640
 s_add_u32 s34, s3, s39
 s_lshl_b32 s3, s24, 1
 s_add_u32 s3, s3, s38
 s_mul_i32 s3, s3, 133120
 s_add_u32 s39, s39, s3
 s_add_u32 s35, s39, 16640
 s_lshr_b32 s36, s25, 3
 s_lshl_b32 s36, s36, 1
 s_lshr_b32 s3, s24, 2
 s_add_u32 s36, s36, s3
 s_lshl_b32 s36, s36, 10
 s_bfe_u32 s3, s25, 0x20001
 s_lshl_b32 s3, s3, 8
 s_add_u32 s36, s36, s3
 s_and_b32 s3, s24, 3
 s_lshl2_add_u32 s36, s3, s36
 s_add_u32 s36, s36, 0x15a0000
 s_waitcnt lgkmcnt(0)
 s_barrier
 ds_read_b64 v[132:133], v6
 ds_read_b64 v[134:135], v6 offset:512
 ds_read_b32 v129, v6 offset:4096
 ds_read_b64 v[144:145], v6 offset:4608
 v_mov_b32 v146, v116
 v_mov_b32 v147, v117
 s_waitcnt lgkmcnt(3)
 v_cndmask_b32 v136, v132, v108, vcc
 v_cndmask_b32 v138, v108, v132, vcc
 v_cndmask_b32 v137, v133, v109, vcc
 v_cndmask_b32 v139, v109, v133, vcc
 buffer_store_dwordx4 v[136:139], v7, s[8:11], s39 offen sc1
 s_waitcnt lgkmcnt(2)
 v_cndmask_b32 v140, v134, v110, vcc
 v_cndmask_b32 v142, v110, v134, vcc
 v_cndmask_b32 v141, v135, v111, vcc
 v_cndmask_b32 v143, v111, v135, vcc
 buffer_store_dwordx4 v[140:143], v7, s[8:11], s35 offen sc1
 s_waitcnt lgkmcnt(1)
 v_cvt_pk_bf16_f32 v128, v128, v129
 v_min_u32 v128, -2, v128
 s_and_b64 exec, vcc, 0xffff
 s_cbranch_execz L_p4_noss
 buffer_store_dword v128, v4, s[8:11], s36 offen sc1
L_p4_noss:
 s_mov_b64 exec, -1
 s_and_b32 s3, s38, s21
 s_cbranch_scc0 L_p4_nx5
 s_waitcnt lgkmcnt(0)
 buffer_store_dwordx4 v[144:147], v7, s[8:11], s34 offen sc1
L_p4_nx5:
 s_mov_b32 s45, 1
 s_branch L_kp_layer
L_p4_final:
 s_mov_b32 s12, s6
 s_mov_b32 s13, s7
 s_mov_b32 s14, 0x240000
 s_mov_b32 s15, 0x20000
 s_and_b32 s26, s25, 64
 s_bfe_u32 s3, s25, 0x10004
 s_lshl_b32 s3, s3, 5
 s_or_b32 s26, s26, s3
 s_bfe_u32 s3, s25, 0x20001
 s_lshl_b32 s3, s3, 3
 s_or_b32 s26, s26, s3
 s_bfe_u32 s3, s25, 0x10003
 s_lshl_b32 s3, s3, 2
 s_or_b32 s26, s26, s3
 s_and_b32 s3, s25, 1
 s_lshl_b32 s3, s3, 1
 s_or_b32 s26, s26, s3
 s_bfe_u32 s3, s25, 0x10005
 s_or_b32 s26, s26, s3
 s_mul_i32 s26, s26, 18432
 v_mul_u32_u24 v7, 1152, v2
 v_lshl_add_u32 v7, v3, 4, v7
 s_lshl_b32 s3, s24, 7
 s_add_u32 s39, s26, s3
 buffer_store_dwordx4 v[108:111], v7, s[12:15], s39 offen
 buffer_store_dwordx4 v[112:115], v7, s[12:15], s39 offen offset:64
 s_cmp_eq_u32 s21, 0
 s_cbranch_scc1 L_p4_end
 s_lshr_b32 s3, s27, 1
 s_lshl_b32 s3, s3, 6
 s_add_u32 s26, s26, s3
 s_and_b32 s3, s27, 1
 s_lshl3_add_u32 s26, s3, s26
 buffer_store_dwordx2 v[116:117], v7, s[12:15], s26 offen
L_p4_end:
 s_endpgm
L_p4_f0:
 s_add_u32 s59, s59, 1
 s_cmp_gt_u32 s59, 131072
 s_cbranch_scc1 L_p4_o0
 s_waitcnt vmcnt(0)
 buffer_load_dwordx4 v[16:19], v4, s[8:11], s28 offen offset:0 sc1
 buffer_load_dwordx4 v[20:23], v4, s[8:11], s28 offen offset:1024 sc1
 buffer_load_dwordx4 v[24:27], v4, s[8:11], s28 offen offset:2048 sc1
 buffer_load_dwordx4 v[28:31], v4, s[8:11], s28 offen offset:3072 sc1
 buffer_load_dwordx4 v[32:35], v4, s[8:11], s29 offen offset:0 sc1
 buffer_load_dwordx4 v[36:39], v4, s[8:11], s29 offen offset:1024 sc1
 buffer_load_dwordx4 v[40:43], v4, s[8:11], s29 offen offset:2048 sc1
 buffer_load_dwordx4 v[44:47], v4, s[8:11], s29 offen offset:3072 sc1
 s_waitcnt vmcnt(0)
 s_branch L_p4_c0
L_p4_f2:
 s_add_u32 s59, s59, 1
 s_cmp_gt_u32 s59, 131072
 s_cbranch_scc1 L_p4_o2
 s_waitcnt vmcnt(0)
 buffer_load_dwordx4 v[24:27], v4, s[8:11], s28 offen offset:2048 sc1
 buffer_load_dwordx4 v[28:31], v4, s[8:11], s28 offen offset:3072 sc1
 buffer_load_dwordx4 v[32:35], v4, s[8:11], s29 offen offset:0 sc1
 buffer_load_dwordx4 v[36:39], v4, s[8:11], s29 offen offset:1024 sc1
 buffer_load_dwordx4 v[40:43], v4, s[8:11], s29 offen offset:2048 sc1
 buffer_load_dwordx4 v[44:47], v4, s[8:11], s29 offen offset:3072 sc1
 buffer_load_dwordx4 v[48:51], v4, s[8:11], s33 offen offset:0 sc1
 buffer_load_dwordx4 v[52:55], v4, s[8:11], s33 offen offset:1024 sc1
 s_waitcnt vmcnt(0)
 s_branch L_p4_c2
L_p4_f4:
 s_add_u32 s59, s59, 1
 s_cmp_gt_u32 s59, 131072
 s_cbranch_scc1 L_p4_o4
 s_waitcnt vmcnt(0)
 buffer_load_dwordx4 v[32:35], v4, s[8:11], s29 offen offset:0 sc1
 buffer_load_dwordx4 v[36:39], v4, s[8:11], s29 offen offset:1024 sc1
 buffer_load_dwordx4 v[40:43], v4, s[8:11], s29 offen offset:2048 sc1
 buffer_load_dwordx4 v[44:47], v4, s[8:11], s29 offen offset:3072 sc1
 buffer_load_dwordx4 v[48:51], v4, s[8:11], s33 offen offset:0 sc1
 buffer_load_dwordx4 v[52:55], v4, s[8:11], s33 offen offset:1024 sc1
 buffer_load_dwordx4 v[56:59], v4, s[8:11], s33 offen offset:2048 sc1
 buffer_load_dwordx4 v[60:63], v4, s[8:11], s33 offen offset:3072 sc1
 s_waitcnt vmcnt(0)
 s_branch L_p4_c4
L_p4_f6:
 s_add_u32 s59, s59, 1
 s_cmp_gt_u32 s59, 131072
 s_cbranch_scc1 L_p4_o6
 s_waitcnt vmcnt(0)
 buffer_load_dwordx4 v[40:43], v4, s[8:11], s29 offen offset:2048 sc1
 buffer_load_dwordx4 v[44:47], v4, s[8:11], s29 offen offset:3072 sc1
 buffer_load_dwordx4 v[48:51], v4, s[8:11], s33 offen offset:0 sc1
 buffer_load_dwordx4 v[52:55], v4, s[8:11], s33 offen offset:1024 sc1
 buffer_load_dwordx4 v[56:59], v4, s[8:11], s33 offen offset:2048 sc1
 buffer_load_dwordx4 v[60:63], v4, s[8:11], s33 offen offset:3072 sc1
 buffer_load_dwordx4 v[64:67], v4, s[8:11], s35 offen offset:0 sc1
 buffer_load_dwordx4 v[68:71], v4, s[8:11], s35 offen offset:1024 sc1
 s_waitcnt vmcnt(0)
 s_branch L_p4_c6
L_p4_f8:
 s_add_u32 s59, s59, 1
 s_cmp_gt_u32 s59, 131072
 s_cbranch_scc1 L_p4_o8
 s_waitcnt vmcnt(0)
 buffer_load_dwordx4 v[48:51], v4, s[8:11], s33 offen offset:0 sc1
 buffer_load_dwordx4 v[52:55], v4, s[8:11], s33 offen offset:1024 sc1
 buffer_load_dwordx4 v[56:59], v4, s[8:11], s33 offen offset:2048 sc1
 buffer_load_dwordx4 v[60:63], v4, s[8:11], s33 offen offset:3072 sc1
 buffer_load_dwordx4 v[64:67], v4, s[8:11], s35 offen offset:0 sc1
 buffer_load_dwordx4 v[68:71], v4, s[8:11], s35 offen offset:1024 sc1
 buffer_load_dwordx4 v[72:75], v4, s[8:11], s35 offen offset:2048 sc1
 buffer_load_dwordx4 v[76:79], v4, s[8:11], s35 offen offset:3072 sc1
 s_waitcnt vmcnt(0)
 s_branch L_p4_c8
L_p4_f10:
 s_add_u32 s59, s59, 1
 s_cmp_gt_u32 s59, 131072
 s_cbranch_scc1 L_p4_o10
 s_waitcnt vmcnt(0)
 buffer_load_dwordx4 v[56:59], v4, s[8:11], s33 offen offset:2048 sc1
 buffer_load_dwordx4 v[60:63], v4, s[8:11], s33 offen offset:3072 sc1
 buffer_load_dwordx4 v[64:67], v4, s[8:11], s35 offen offset:0 sc1
 buffer_load_dwordx4 v[68:71], v4, s[8:11], s35 offen offset:1024 sc1
 buffer_load_dwordx4 v[72:75], v4, s[8:11], s35 offen offset:2048 sc1
 buffer_load_dwordx4 v[76:79], v4, s[8:11], s35 offen offset:3072 sc1
 buffer_load_dwordx2 v[80:81], v10, s[8:11], s36 offen offset:0 sc1
 buffer_load_dwordx2 v[82:83], v10, s[8:11], s36 offen offset:128 sc1
 buffer_load_dwordx2 v[84:85], v10, s[8:11], s36 offen offset:1024 sc1
 buffer_load_dwordx2 v[86:87], v10, s[8:11], s36 offen offset:1152 sc1
 s_waitcnt vmcnt(0)
 s_branch L_p4_c10
L_p4_f12:
 s_add_u32 s59, s59, 1
 s_cmp_gt_u32 s59, 131072
 s_cbranch_scc1 L_p4_o12
 s_waitcnt vmcnt(0)
 buffer_load_dwordx4 v[64:67], v4, s[8:11], s35 offen offset:0 sc1
 buffer_load_dwordx4 v[68:71], v4, s[8:11], s35 offen offset:1024 sc1
 buffer_load_dwordx4 v[72:75], v4, s[8:11], s35 offen offset:2048 sc1
 buffer_load_dwordx4 v[76:79], v4, s[8:11], s35 offen offset:3072 sc1
 buffer_load_dwordx2 v[80:81], v10, s[8:11], s36 offen offset:0 sc1
 buffer_load_dwordx2 v[82:83], v10, s[8:11], s36 offen offset:128 sc1
 buffer_load_dwordx2 v[84:85], v10, s[8:11], s36 offen offset:1024 sc1
 buffer_load_dwordx2 v[86:87], v10, s[8:11], s36 offen offset:1152 sc1
 s_waitcnt vmcnt(0)
 s_branch L_p4_c12
L_p4_f14:
 s_add_u32 s59, s59, 1
 s_cmp_gt_u32 s59, 131072
 s_cbranch_scc1 L_p4_o14
 s_waitcnt vmcnt(0)
 buffer_load_dwordx4 v[72:75], v4, s[8:11], s35 offen offset:2048 sc1
 buffer_load_dwordx4 v[76:79], v4, s[8:11], s35 offen offset:3072 sc1
 buffer_load_dwordx2 v[80:81], v10, s[8:11], s36 offen offset:0 sc1
 buffer_load_dwordx2 v[82:83], v10, s[8:11], s36 offen offset:128 sc1
 buffer_load_dwordx2 v[84:85], v10, s[8:11], s36 offen offset:1024 sc1
 buffer_load_dwordx2 v[86:87], v10, s[8:11], s36 offen offset:1152 sc1
 s_waitcnt vmcnt(0)
 s_branch L_p4_c14
L_p4_f16:
 s_add_u32 s59, s59, 1
 s_cmp_gt_u32 s59, 131072
 s_cbranch_scc1 L_p4_o16
 s_waitcnt vmcnt(0)
 buffer_load_dwordx2 v[80:81], v10, s[8:11], s36 offen offset:0 sc1
 buffer_load_dwordx2 v[82:83], v10, s[8:11], s36 offen offset:128 sc1
 buffer_load_dwordx2 v[84:85], v10, s[8:11], s36 offen offset:1024 sc1
 buffer_load_dwordx2 v[86:87], v10, s[8:11], s36 offen offset:1152 sc1
 s_waitcnt vmcnt(0)
 s_branch L_p4_c16
L_p4_rre:
 s_add_u32 s34, s34, 1
 s_cmp_gt_u32 s34, 131072
 s_cbranch_scc1 L_p4_rok
 s_add_u32 s3, s31, 0
 buffer_load_dwordx2 v[108:109], v6, s[8:11], s3 offen sc1
 s_add_u32 s3, s31, 16640
 buffer_load_dwordx2 v[110:111], v6, s[8:11], s3 offen sc1
 s_add_u32 s3, s31, 133120
 buffer_load_dwordx2 v[112:113], v6, s[8:11], s3 offen sc1
 s_add_u32 s3, s31, 149760
 buffer_load_dwordx2 v[114:115], v6, s[8:11], s3 offen sc1
 buffer_load_dwordx2 v[116:117], v6, s[8:11], s30 offen sc1
 s_waitcnt vmcnt(0)
 s_branch L_p4_rchk
L_p3_f0:
 s_add_u32 s59, s59, 1
 s_cmp_gt_u32 s59, 131072
 s_cbranch_scc1 L_p3_o0
 s_sub_u32 s26, s26, 798720
 s_sub_u32 s27, s27, 798720
 s_waitcnt vmcnt(0)
 buffer_load_dwordx4 v[16:19], v6, s[8:11], s26 offen sc1
 s_add_u32 s26, s26, 133120
 buffer_load_dwordx4 v[20:23], v6, s[8:11], s27 offen sc1
 s_add_u32 s27, s27, 133120
 buffer_load_dwordx4 v[24:27], v6, s[8:11], s26 offen sc1
 s_add_u32 s26, s26, 133120
 buffer_load_dwordx4 v[28:31], v6, s[8:11], s27 offen sc1
 s_add_u32 s27, s27, 133120
 buffer_load_dwordx4 v[32:35], v6, s[8:11], s26 offen sc1
 s_add_u32 s26, s26, 133120
 buffer_load_dwordx4 v[36:39], v6, s[8:11], s27 offen sc1
 s_add_u32 s27, s27, 133120
 buffer_load_dwordx4 v[40:43], v6, s[8:11], s26 offen sc1
 s_add_u32 s26, s26, 133120
 buffer_load_dwordx4 v[44:47], v6, s[8:11], s27 offen sc1
 s_add_u32 s27, s27, 133120
 buffer_load_dwordx4 v[48:51], v6, s[8:11], s26 offen sc1
 s_add_u32 s26, s26, 133120
 buffer_load_dwordx4 v[52:55], v6, s[8:11], s27 offen sc1
 s_add_u32 s27, s27, 133120
 buffer_load_dwordx4 v[56:59], v6, s[8:11], s26 offen sc1
 s_add_u32 s26, s26, 133120
 buffer_load_dwordx4 v[60:63], v6, s[8:11], s27 offen sc1
 s_add_u32 s27, s27, 133120
 s_waitcnt vmcnt(0)
 v_max_u32 v8, v16, v17
 v_max3_u32 v8, v18, v19, v8
 v_max3_u32 v8, v20, v21, v8
 v_max3_u32 v8, v22, v23, v8
 v_cmp_eq_u32 vcc, -1, v8
 s_cbranch_vccnz L_p3_f0
 s_branch L_p3_o0
L_p3_f1:
 s_add_u32 s59, s59, 1
 s_cmp_gt_u32 s59, 131072
 s_cbranch_scc1 L_p3_o1
 s_sub_u32 s26, s26, 798720
 s_sub_u32 s27, s27, 798720
 s_waitcnt vmcnt(0)
 buffer_load_dwordx4 v[24:27], v6, s[8:11], s26 offen sc1
 s_add_u32 s26, s26, 133120
 buffer_load_dwordx4 v[28:31], v6, s[8:11], s27 offen sc1
 s_add_u32 s27, s27, 133120
 buffer_load_dwordx4 v[32:35], v6, s[8:11], s26 offen sc1
 s_add_u32 s26, s26, 133120
 buffer_load_dwordx4 v[36:39], v6, s[8:11], s27 offen sc1
 s_add_u32 s27, s27, 133120
 buffer_load_dwordx4 v[40:43], v6, s[8:11], s26 offen sc1
 s_add_u32 s26, s26, 133120
 buffer_load_dwordx4 v[44:47], v6, s[8:11], s27 offen sc1
 s_add_u32 s27, s27, 133120
 buffer_load_dwordx4 v[48:51], v6, s[8:11], s26 offen sc1
 s_add_u32 s26, s26, 133120
 buffer_load_dwordx4 v[52:55], v6, s[8:11], s27 offen sc1
 s_add_u32 s27, s27, 133120
 buffer_load_dwordx4 v[56:59], v6, s[8:11], s26 offen sc1
 s_add_u32 s26, s26, 133120
 buffer_load_dwordx4 v[60:63], v6, s[8:11], s27 offen sc1
 s_add_u32 s27, s27, 133120
 buffer_load_dwordx4 v[64:67], v6, s[8:11], s26 offen sc1
 s_add_u32 s26, s26, 133120
 buffer_load_dwordx4 v[68:71], v6, s[8:11], s27 offen sc1
 s_add_u32 s27, s27, 133120
 s_waitcnt vmcnt(0)
 v_max_u32 v8, v24, v25
 v_max3_u32 v8, v26, v27, v8
 v_max3_u32 v8, v28, v29, v8
 v_max3_u32 v8, v30, v31, v8
 v_cmp_eq_u32 vcc, -1, v8
 s_cbranch_vccnz L_p3_f1
 s_branch L_p3_o1
L_p3_f2:
 s_add_u32 s59, s59, 1
 s_cmp_gt_u32 s59, 131072
 s_cbranch_scc1 L_p3_o2
 s_sub_u32 s26, s26, 798720
 s_sub_u32 s27, s27, 798720
 s_waitcnt vmcnt(0)
 buffer_load_dwordx4 v[32:35], v6, s[8:11], s26 offen sc1
 s_add_u32 s26, s26, 133120
 buffer_load_dwordx4 v[36:39], v6, s[8:11], s27 offen sc1
 s_add_u32 s27, s27, 133120
 buffer_load_dwordx4 v[40:43], v6, s[8:11], s26 offen sc1
 s_add_u32 s26, s26, 133120
 buffer_load_dwordx4 v[44:47], v6, s[8:11], s27 offen sc1
 s_add_u32 s27, s27, 133120
 buffer_load_dwordx4 v[48:51], v6, s[8:11], s26 offen sc1
 s_add_u32 s26, s26, 133120
 buffer_load_dwordx4 v[52:55], v6, s[8:11], s27 offen sc1
 s_add_u32 s27, s27, 133120
 buffer_load_dwordx4 v[56:59], v6, s[8:11], s26 offen sc1
 s_add_u32 s26, s26, 133120
 buffer_load_dwordx4 v[60:63], v6, s[8:11], s27 offen sc1
 s_add_u32 s27, s27, 133120
 buffer_load_dwordx4 v[64:67], v6, s[8:11], s26 offen sc1
 s_add_u32 s26, s26, 133120
 buffer_load_dwordx4 v[68:71], v6, s[8:11], s27 offen sc1
 s_add_u32 s27, s27, 133120
 buffer_load_dwordx4 v[72:75], v6, s[8:11], s26 offen sc1
 s_add_u32 s26, s26, 133120
 buffer_load_dwordx4 v[76:79], v6, s[8:11], s27 offen sc1
 s_add_u32 s27, s27, 133120
 s_waitcnt vmcnt(0)
 v_max_u32 v8, v32, v33
 v_max3_u32 v8, v34, v35, v8
 v_max3_u32 v8, v36, v37, v8
 v_max3_u32 v8, v38, v39, v8
 v_cmp_eq_u32 vcc, -1, v8
 s_cbranch_vccnz L_p3_f2
 s_branch L_p3_o2
L_p3_f3:
 s_add_u32 s59, s59, 1
 s_cmp_gt_u32 s59, 131072
 s_cbranch_scc1 L_p3_o3
 s_sub_u32 s26, s26, 798720
 s_sub_u32 s27, s27, 798720
 s_waitcnt vmcnt(0)
 buffer_load_dwordx4 v[40:43], v6, s[8:11], s26 offen sc1
 s_add_u32 s26, s26, 133120
 buffer_load_dwordx4 v[44:47], v6, s[8:11], s27 offen sc1
 s_add_u32 s27, s27, 133120
 buffer_load_dwordx4 v[48:51], v6, s[8:11], s26 offen sc1
 s_add_u32 s26, s26, 133120
 buffer_load_dwordx4 v[52:55], v6, s[8:11], s27 offen sc1
 s_add_u32 s27, s27, 133120
 buffer_load_dwordx4 v[56:59], v6, s[8:11], s26 offen sc1
 s_add_u32 s26, s26, 133120
 buffer_load_dwordx4 v[60:63], v6, s[8:11], s27 offen sc1
 s_add_u32 s27, s27, 133120
 buffer_load_dwordx4 v[64:67], v6, s[8:11], s26 offen sc1
 s_add_u32 s26, s26, 133120
 buffer_load_dwordx4 v[68:71], v6, s[8:11], s27 offen sc1
 s_add_u32 s27, s27, 133120
 buffer_load_dwordx4 v[72:75], v6, s[8:11], s26 offen sc1
 s_add_u32 s26, s26, 133120
 buffer_load_dwordx4 v[76:79], v6, s[8:11], s27 offen sc1
 s_add_u32 s27, s27, 133120
 buffer_load_dwordx4 v[80:83], v6, s[8:11], s26 offen sc1
 s_add_u32 s26, s26, 133120
 buffer_load_dwordx4 v[84:87], v6, s[8:11], s27 offen sc1
 s_add_u32 s27, s27, 133120
 s_waitcnt vmcnt(0)
 v_max_u32 v8, v40, v41
 v_max3_u32 v8, v42, v43, v8
 v_max3_u32 v8, v44, v45, v8
 v_max3_u32 v8, v46, v47, v8
 v_cmp_eq_u32 vcc, -1, v8
 s_cbranch_vccnz L_p3_f3
 s_branch L_p3_o3
L_p3_f4:
 s_add_u32 s59, s59, 1
 s_cmp_gt_u32 s59, 131072
 s_cbranch_scc1 L_p3_o4
 s_sub_u32 s26, s26, 798720
 s_sub_u32 s27, s27, 798720
 s_waitcnt vmcnt(0)
 buffer_load_dwordx4 v[48:51], v6, s[8:11], s26 offen sc1
 s_add_u32 s26, s26, 133120
 buffer_load_dwordx4 v[52:55], v6, s[8:11], s27 offen sc1
 s_add_u32 s27, s27, 133120
 buffer_load_dwordx4 v[56:59], v6, s[8:11], s26 offen sc1
 s_add_u32 s26, s26, 133120
 buffer_load_dwordx4 v[60:63], v6, s[8:11], s27 offen sc1
 s_add_u32 s27, s27, 133120
 buffer_load_dwordx4 v[64:67], v6, s[8:11], s26 offen sc1
 s_add_u32 s26, s26, 133120
 buffer_load_dwordx4 v[68:71], v6, s[8:11], s27 offen sc1
 s_add_u32 s27, s27, 133120
 buffer_load_dwordx4 v[72:75], v6, s[8:11], s26 offen sc1
 s_add_u32 s26, s26, 133120
 buffer_load_dwordx4 v[76:79], v6, s[8:11], s27 offen sc1
 s_add_u32 s27, s27, 133120
 buffer_load_dwordx4 v[80:83], v6, s[8:11], s26 offen sc1
 s_add_u32 s26, s26, 133120
 buffer_load_dwordx4 v[84:87], v6, s[8:11], s27 offen sc1
 s_add_u32 s27, s27, 133120
 buffer_load_dwordx4 v[88:91], v6, s[8:11], s26 offen sc1
 s_add_u32 s26, s26, 133120
 buffer_load_dwordx4 v[92:95], v6, s[8:11], s27 offen sc1
 s_add_u32 s27, s27, 133120
 s_waitcnt vmcnt(0)
 v_max_u32 v8, v48, v49
 v_max3_u32 v8, v50, v51, v8
 v_max3_u32 v8, v52, v53, v8
 v_max3_u32 v8, v54, v55, v8
 v_cmp_eq_u32 vcc, -1, v8
 s_cbranch_vccnz L_p3_f4
 s_branch L_p3_o4
L_p3_f5:
 s_add_u32 s59, s59, 1
 s_cmp_gt_u32 s59, 131072
 s_cbranch_scc1 L_p3_o5
 s_sub_u32 s26, s26, 798720
 s_sub_u32 s27, s27, 798720
 s_waitcnt vmcnt(0)
 buffer_load_dwordx4 v[56:59], v6, s[8:11], s26 offen sc1
 s_add_u32 s26, s26, 133120
 buffer_load_dwordx4 v[60:63], v6, s[8:11], s27 offen sc1
 s_add_u32 s27, s27, 133120
 buffer_load_dwordx4 v[64:67], v6, s[8:11], s26 offen sc1
 s_add_u32 s26, s26, 133120
 buffer_load_dwordx4 v[68:71], v6, s[8:11], s27 offen sc1
 s_add_u32 s27, s27, 133120
 buffer_load_dwordx4 v[72:75], v6, s[8:11], s26 offen sc1
 s_add_u32 s26, s26, 133120
 buffer_load_dwordx4 v[76:79], v6, s[8:11], s27 offen sc1
 s_add_u32 s27, s27, 133120
 buffer_load_dwordx4 v[80:83], v6, s[8:11], s26 offen sc1
 s_add_u32 s26, s26, 133120
 buffer_load_dwordx4 v[84:87], v6, s[8:11], s27 offen sc1
 s_add_u32 s27, s27, 133120
 buffer_load_dwordx4 v[88:91], v6, s[8:11], s26 offen sc1
 s_add_u32 s26, s26, 133120
 buffer_load_dwordx4 v[92:95], v6, s[8:11], s27 offen sc1
 s_add_u32 s27, s27, 133120
 buffer_load_dwordx4 v[96:99], v6, s[8:11], s26 offen sc1
 s_add_u32 s26, s26, 133120
 buffer_load_dwordx4 v[100:103], v6, s[8:11], s27 offen sc1
 s_add_u32 s27, s27, 133120
 s_waitcnt vmcnt(0)
 v_max_u32 v8, v56, v57
 v_max3_u32 v8, v58, v59, v8
 v_max3_u32 v8, v60, v61, v8
 v_max3_u32 v8, v62, v63, v8
 v_cmp_eq_u32 vcc, -1, v8
 s_cbranch_vccnz L_p3_f5
 s_branch L_p3_o5
L_p3_f6:
 s_add_u32 s59, s59, 1
 s_cmp_gt_u32 s59, 131072
 s_cbranch_scc1 L_p3_o6
 s_sub_u32 s26, s26, 798720
 s_sub_u32 s27, s27, 798720
 s_waitcnt vmcnt(0)
 buffer_load_dwordx4 v[64:67], v6, s[8:11], s26 offen sc1
 s_add_u32 s26, s26, 133120
 buffer_load_dwordx4 v[68:71], v6, s[8:11], s27 offen sc1
 s_add_u32 s27, s27, 133120
 buffer_load_dwordx4 v[72:75], v6, s[8:11], s26 offen sc1
 s_add_u32 s26, s26, 133120
 buffer_load_dwordx4 v[76:79], v6, s[8:11], s27 offen sc1
 s_add_u32 s27, s27, 133120
 buffer_load_dwordx4 v[80:83], v6, s[8:11], s26 offen sc1
 s_add_u32 s26, s26, 133120
 buffer_load_dwordx4 v[84:87], v6, s[8:11], s27 offen sc1
 s_add_u32 s27, s27, 133120
 buffer_load_dwordx4 v[88:91], v6, s[8:11], s26 offen sc1
 s_add_u32 s26, s26, 133120
 buffer_load_dwordx4 v[92:95], v6, s[8:11], s27 offen sc1
 s_add_u32 s27, s27, 133120
 buffer_load_dwordx4 v[96:99], v6, s[8:11], s26 offen sc1
 s_add_u32 s26, s26, 133120
 buffer_load_dwordx4 v[100:103], v6, s[8:11], s27 offen sc1
 s_add_u32 s27, s27, 133120
 buffer_load_dwordx4 v[104:107], v6, s[8:11], s26 offen sc1
 s_add_u32 s26, s26, 133120
 buffer_load_dwordx4 v[108:111], v6, s[8:11], s27 offen sc1
 s_add_u32 s27, s27, 133120
 s_waitcnt vmcnt(0)
 v_max_u32 v8, v64, v65
 v_max3_u32 v8, v66, v67, v8
 v_max3_u32 v8, v68, v69, v8
 v_max3_u32 v8, v70, v71, v8
 v_cmp_eq_u32 vcc, -1, v8
 s_cbranch_vccnz L_p3_f6
 s_branch L_p3_o6
L_p3_f7:
 s_add_u32 s59, s59, 1
 s_cmp_gt_u32 s59, 131072
 s_cbranch_scc1 L_p3_o7
 s_sub_u32 s26, s26, 798720
 s_sub_u32 s27, s27, 798720
 s_waitcnt vmcnt(0)
 buffer_load_dwordx4 v[72:75], v6, s[8:11], s26 offen sc1
 s_add_u32 s26, s26, 133120
 buffer_load_dwordx4 v[76:79], v6, s[8:11], s27 offen sc1
 s_add_u32 s27, s27, 133120
 buffer_load_dwordx4 v[80:83], v6, s[8:11], s26 offen sc1
 s_add_u32 s26, s26, 133120
 buffer_load_dwordx4 v[84:87], v6, s[8:11], s27 offen sc1
 s_add_u32 s27, s27, 133120
 buffer_load_dwordx4 v[88:91], v6, s[8:11], s26 offen sc1
 s_add_u32 s26, s26, 133120
 buffer_load_dwordx4 v[92:95], v6, s[8:11], s27 offen sc1
 s_add_u32 s27, s27, 133120
 buffer_load_dwordx4 v[96:99], v6, s[8:11], s26 offen sc1
 s_add_u32 s26, s26, 133120
 buffer_load_dwordx4 v[100:103], v6, s[8:11], s27 offen sc1
 s_add_u32 s27, s27, 133120
 buffer_load_dwordx4 v[104:107], v6, s[8:11], s26 offen sc1
 s_add_u32 s26, s26, 133120
 buffer_load_dwordx4 v[108:111], v6, s[8:11], s27 offen sc1
 s_add_u32 s27, s27, 133120
 buffer_load_dwordx4 v[112:115], v6, s[8:11], s26 offen sc1
 s_add_u32 s26, s26, 133120
 buffer_load_dwordx4 v[116:119], v6, s[8:11], s27 offen sc1
 s_add_u32 s27, s27, 133120
 s_waitcnt vmcnt(0)
 v_max_u32 v8, v72, v73
 v_max3_u32 v8, v74, v75, v8
 v_max3_u32 v8, v76, v77, v8
 v_max3_u32 v8, v78, v79, v8
 v_cmp_eq_u32 vcc, -1, v8
 s_cbranch_vccnz L_p3_f7
 s_branch L_p3_o7
L_p3_f8:
 s_add_u32 s59, s59, 1
 s_cmp_gt_u32 s59, 131072
 s_cbranch_scc1 L_p3_o8
 s_sub_u32 s26, s26, 798720
 s_sub_u32 s27, s27, 798720
 s_waitcnt vmcnt(0)
 buffer_load_dwordx4 v[80:83], v6, s[8:11], s26 offen sc1
 s_add_u32 s26, s26, 133120
 buffer_load_dwordx4 v[84:87], v6, s[8:11], s27 offen sc1
 s_add_u32 s27, s27, 133120
 buffer_load_dwordx4 v[88:91], v6, s[8:11], s26 offen sc1
 s_add_u32 s26, s26, 133120
 buffer_load_dwordx4 v[92:95], v6, s[8:11], s27 offen sc1
 s_add_u32 s27, s27, 133120
 buffer_load_dwordx4 v[96:99], v6, s[8:11], s26 offen sc1
 s_add_u32 s26, s26, 133120
 buffer_load_dwordx4 v[100:103], v6, s[8:11], s27 offen sc1
 s_add_u32 s27, s27, 133120
 buffer_load_dwordx4 v[104:107], v6, s[8:11], s26 offen sc1
 s_add_u32 s26, s26, 133120
 buffer_load_dwordx4 v[108:111], v6, s[8:11], s27 offen sc1
 s_add_u32 s27, s27, 133120
 buffer_load_dwordx4 v[112:115], v6, s[8:11], s26 offen sc1
 s_add_u32 s26, s26, 133120
 buffer_load_dwordx4 v[116:119], v6, s[8:11], s27 offen sc1
 s_add_u32 s27, s27, 133120
 buffer_load_dwordx4 v[120:123], v6, s[8:11], s26 offen sc1
 s_add_u32 s26, s26, 133120
 buffer_load_dwordx4 v[124:127], v6, s[8:11], s27 offen sc1
 s_add_u32 s27, s27, 133120
 s_waitcnt vmcnt(0)
 v_max_u32 v8, v80, v81
 v_max3_u32 v8, v82, v83, v8
 v_max3_u32 v8, v84, v85, v8
 v_max3_u32 v8, v86, v87, v8
 v_cmp_eq_u32 vcc, -1, v8
 s_cbranch_vccnz L_p3_f8
 s_branch L_p3_o8
L_p3_f9:
 s_add_u32 s59, s59, 1
 s_cmp_gt_u32 s59, 131072
 s_cbranch_scc1 L_p3_o9
 s_sub_u32 s26, s26, 798720
 s_sub_u32 s27, s27, 798720
 s_waitcnt vmcnt(0)
 buffer_load_dwordx4 v[88:91], v6, s[8:11], s26 offen sc1
 s_add_u32 s26, s26, 133120
 buffer_load_dwordx4 v[92:95], v6, s[8:11], s27 offen sc1
 s_add_u32 s27, s27, 133120
 buffer_load_dwordx4 v[96:99], v6, s[8:11], s26 offen sc1
 s_add_u32 s26, s26, 133120
 buffer_load_dwordx4 v[100:103], v6, s[8:11], s27 offen sc1
 s_add_u32 s27, s27, 133120
 buffer_load_dwordx4 v[104:107], v6, s[8:11], s26 offen sc1
 s_add_u32 s26, s26, 133120
 buffer_load_dwordx4 v[108:111], v6, s[8:11], s27 offen sc1
 s_add_u32 s27, s27, 133120
 buffer_load_dwordx4 v[112:115], v6, s[8:11], s26 offen sc1
 s_add_u32 s26, s26, 133120
 buffer_load_dwordx4 v[116:119], v6, s[8:11], s27 offen sc1
 s_add_u32 s27, s27, 133120
 buffer_load_dwordx4 v[120:123], v6, s[8:11], s26 offen sc1
 s_add_u32 s26, s26, 133120
 buffer_load_dwordx4 v[124:127], v6, s[8:11], s27 offen sc1
 s_add_u32 s27, s27, 133120
 buffer_load_dwordx4 v[128:131], v6, s[8:11], s26 offen sc1
 s_add_u32 s26, s26, 133120
 buffer_load_dwordx4 v[132:135], v6, s[8:11], s27 offen sc1
 s_add_u32 s27, s27, 133120
 s_waitcnt vmcnt(0)
 v_max_u32 v8, v88, v89
 v_max3_u32 v8, v90, v91, v8
 v_max3_u32 v8, v92, v93, v8
 v_max3_u32 v8, v94, v95, v8
 v_cmp_eq_u32 vcc, -1, v8
 s_cbranch_vccnz L_p3_f9
 s_branch L_p3_o9
L_p3_f10:
 s_add_u32 s59, s59, 1
 s_cmp_gt_u32 s59, 131072
 s_cbranch_scc1 L_p3_o10
 s_sub_u32 s26, s26, 798720
 s_sub_u32 s27, s27, 798720
 s_waitcnt vmcnt(0)
 buffer_load_dwordx4 v[96:99], v6, s[8:11], s26 offen sc1
 s_add_u32 s26, s26, 133120
 buffer_load_dwordx4 v[100:103], v6, s[8:11], s27 offen sc1
 s_add_u32 s27, s27, 133120
 buffer_load_dwordx4 v[104:107], v6, s[8:11], s26 offen sc1
 s_add_u32 s26, s26, 133120
 buffer_load_dwordx4 v[108:111], v6, s[8:11], s27 offen sc1
 s_add_u32 s27, s27, 133120
 buffer_load_dwordx4 v[112:115], v6, s[8:11], s26 offen sc1
 s_add_u32 s26, s26, 133120
 buffer_load_dwordx4 v[116:119], v6, s[8:11], s27 offen sc1
 s_add_u32 s27, s27, 133120
 buffer_load_dwordx4 v[120:123], v6, s[8:11], s26 offen sc1
 s_add_u32 s26, s26, 133120
 buffer_load_dwordx4 v[124:127], v6, s[8:11], s27 offen sc1
 s_add_u32 s27, s27, 133120
 buffer_load_dwordx4 v[128:131], v6, s[8:11], s26 offen sc1
 s_add_u32 s26, s26, 133120
 buffer_load_dwordx4 v[132:135], v6, s[8:11], s27 offen sc1
 s_add_u32 s27, s27, 133120
 buffer_load_dwordx4 v[136:139], v6, s[8:11], s26 offen sc1
 s_add_u32 s26, s26, 133120
 buffer_load_dwordx4 v[140:143], v6, s[8:11], s27 offen sc1
 s_add_u32 s27, s27, 133120
 s_waitcnt vmcnt(0)
 v_max_u32 v8, v96, v97
 v_max3_u32 v8, v98, v99, v8
 v_max3_u32 v8, v100, v101, v8
 v_max3_u32 v8, v102, v103, v8
 v_cmp_eq_u32 vcc, -1, v8
 s_cbranch_vccnz L_p3_f10
 s_branch L_p3_o10
L_p3_f11:
 s_add_u32 s59, s59, 1
 s_cmp_gt_u32 s59, 131072
 s_cbranch_scc1 L_p3_o11
 s_sub_u32 s26, s26, 798720
 s_sub_u32 s27, s27, 798720
 s_waitcnt vmcnt(0)
 buffer_load_dwordx4 v[104:107], v6, s[8:11], s26 offen sc1
 s_add_u32 s26, s26, 133120
 buffer_load_dwordx4 v[108:111], v6, s[8:11], s27 offen sc1
 s_add_u32 s27, s27, 133120
 buffer_load_dwordx4 v[112:115], v6, s[8:11], s26 offen sc1
 s_add_u32 s26, s26, 133120
 buffer_load_dwordx4 v[116:119], v6, s[8:11], s27 offen sc1
 s_add_u32 s27, s27, 133120
 buffer_load_dwordx4 v[120:123], v6, s[8:11], s26 offen sc1
 s_add_u32 s26, s26, 133120
 buffer_load_dwordx4 v[124:127], v6, s[8:11], s27 offen sc1
 s_add_u32 s27, s27, 133120
 buffer_load_dwordx4 v[128:131], v6, s[8:11], s26 offen sc1
 s_add_u32 s26, s26, 133120
 buffer_load_dwordx4 v[132:135], v6, s[8:11], s27 offen sc1
 s_add_u32 s27, s27, 133120
 buffer_load_dwordx4 v[136:139], v6, s[8:11], s26 offen sc1
 s_add_u32 s26, s26, 133120
 buffer_load_dwordx4 v[140:143], v6, s[8:11], s27 offen sc1
 s_add_u32 s27, s27, 133120
 buffer_load_dwordx4 v[144:147], v6, s[8:11], s26 offen sc1
 s_add_u32 s26, s26, 133120
 buffer_load_dwordx4 v[148:151], v6, s[8:11], s27 offen sc1
 s_add_u32 s27, s27, 133120
 s_waitcnt vmcnt(0)
 v_max_u32 v8, v104, v105
 v_max3_u32 v8, v106, v107, v8
 v_max3_u32 v8, v108, v109, v8
 v_max3_u32 v8, v110, v111, v8
 v_cmp_eq_u32 vcc, -1, v8
 s_cbranch_vccnz L_p3_f11
 s_branch L_p3_o11
L_p3_f12:
 s_add_u32 s59, s59, 1
 s_cmp_gt_u32 s59, 131072
 s_cbranch_scc1 L_p3_o12
 s_sub_u32 s26, s26, 798720
 s_sub_u32 s27, s27, 798720
 s_waitcnt vmcnt(0)
 buffer_load_dwordx4 v[112:115], v6, s[8:11], s26 offen sc1
 s_add_u32 s26, s26, 133120
 buffer_load_dwordx4 v[116:119], v6, s[8:11], s27 offen sc1
 s_add_u32 s27, s27, 133120
 buffer_load_dwordx4 v[120:123], v6, s[8:11], s26 offen sc1
 s_add_u32 s26, s26, 133120
 buffer_load_dwordx4 v[124:127], v6, s[8:11], s27 offen sc1
 s_add_u32 s27, s27, 133120
 buffer_load_dwordx4 v[128:131], v6, s[8:11], s26 offen sc1
 s_add_u32 s26, s26, 133120
 buffer_load_dwordx4 v[132:135], v6, s[8:11], s27 offen sc1
 s_add_u32 s27, s27, 133120
 buffer_load_dwordx4 v[136:139], v6, s[8:11], s26 offen sc1
 s_add_u32 s26, s26, 133120
 buffer_load_dwordx4 v[140:143], v6, s[8:11], s27 offen sc1
 s_add_u32 s27, s27, 133120
 buffer_load_dwordx4 v[144:147], v6, s[8:11], s26 offen sc1
 s_add_u32 s26, s26, 133120
 buffer_load_dwordx4 v[148:151], v6, s[8:11], s27 offen sc1
 s_add_u32 s27, s27, 133120
 buffer_load_dwordx4 v[152:155], v6, s[8:11], s26 offen sc1
 s_add_u32 s26, s26, 133120
 buffer_load_dwordx4 v[156:159], v6, s[8:11], s27 offen sc1
 s_add_u32 s27, s27, 133120
 s_waitcnt vmcnt(0)
 v_max_u32 v8, v112, v113
 v_max3_u32 v8, v114, v115, v8
 v_max3_u32 v8, v116, v117, v8
 v_max3_u32 v8, v118, v119, v8
 v_cmp_eq_u32 vcc, -1, v8
 s_cbranch_vccnz L_p3_f12
 s_branch L_p3_o12
L_p3_f13:
 s_add_u32 s59, s59, 1
 s_cmp_gt_u32 s59, 131072
 s_cbranch_scc1 L_p3_o13
 s_sub_u32 s26, s26, 665600
 s_sub_u32 s27, s27, 665600
 s_waitcnt vmcnt(0)
 buffer_load_dwordx4 v[120:123], v6, s[8:11], s26 offen sc1
 s_add_u32 s26, s26, 133120
 buffer_load_dwordx4 v[124:127], v6, s[8:11], s27 offen sc1
 s_add_u32 s27, s27, 133120
 buffer_load_dwordx4 v[128:131], v6, s[8:11], s26 offen sc1
 s_add_u32 s26, s26, 133120
 buffer_load_dwordx4 v[132:135], v6, s[8:11], s27 offen sc1
 s_add_u32 s27, s27, 133120
 buffer_load_dwordx4 v[136:139], v6, s[8:11], s26 offen sc1
 s_add_u32 s26, s26, 133120
 buffer_load_dwordx4 v[140:143], v6, s[8:11], s27 offen sc1
 s_add_u32 s27, s27, 133120
 buffer_load_dwordx4 v[144:147], v6, s[8:11], s26 offen sc1
 s_add_u32 s26, s26, 133120
 buffer_load_dwordx4 v[148:151], v6, s[8:11], s27 offen sc1
 s_add_u32 s27, s27, 133120
 buffer_load_dwordx4 v[152:155], v6, s[8:11], s26 offen sc1
 s_add_u32 s26, s26, 133120
 buffer_load_dwordx4 v[156:159], v6, s[8:11], s27 offen sc1
 s_add_u32 s27, s27, 133120
 s_waitcnt vmcnt(0)
 v_max_u32 v8, v120, v121
 v_max3_u32 v8, v122, v123, v8
 v_max3_u32 v8, v124, v125, v8
 v_max3_u32 v8, v126, v127, v8
 v_cmp_eq_u32 vcc, -1, v8
 s_cbranch_vccnz L_p3_f13
 s_branch L_p3_o13
L_p3_f14:
 s_add_u32 s59, s59, 1
 s_cmp_gt_u32 s59, 131072
 s_cbranch_scc1 L_p3_o14
 s_sub_u32 s26, s26, 532480
 s_sub_u32 s27, s27, 532480
 s_waitcnt vmcnt(0)
 buffer_load_dwordx4 v[128:131], v6, s[8:11], s26 offen sc1
 s_add_u32 s26, s26, 133120
 buffer_load_dwordx4 v[132:135], v6, s[8:11], s27 offen sc1
 s_add_u32 s27, s27, 133120
 buffer_load_dwordx4 v[136:139], v6, s[8:11], s26 offen sc1
 s_add_u32 s26, s26, 133120
 buffer_load_dwordx4 v[140:143], v6, s[8:11], s27 offen sc1
 s_add_u32 s27, s27, 133120
 buffer_load_dwordx4 v[144:147], v6, s[8:11], s26 offen sc1
 s_add_u32 s26, s26, 133120
 buffer_load_dwordx4 v[148:151], v6, s[8:11], s27 offen sc1
 s_add_u32 s27, s27, 133120
 buffer_load_dwordx4 v[152:155], v6, s[8:11], s26 offen sc1
 s_add_u32 s26, s26, 133120
 buffer_load_dwordx4 v[156:159], v6, s[8:11], s27 offen sc1
 s_add_u32 s27, s27, 133120
 s_waitcnt vmcnt(0)
 v_max_u32 v8, v128, v129
 v_max3_u32 v8, v130, v131, v8
 v_max3_u32 v8, v132, v133, v8
 v_max3_u32 v8, v134, v135, v8
 v_cmp_eq_u32 vcc, -1, v8
 s_cbranch_vccnz L_p3_f14
 s_branch L_p3_o14
L_p3_f15:
 s_add_u32 s59, s59, 1
 s_cmp_gt_u32 s59, 131072
 s_cbranch_scc1 L_p3_o15
 s_sub_u32 s26, s26, 399360
 s_sub_u32 s27, s27, 399360
 s_waitcnt vmcnt(0)
 buffer_load_dwordx4 v[136:139], v6, s[8:11], s26 offen sc1
 s_add_u32 s26, s26, 133120
 buffer_load_dwordx4 v[140:143], v6, s[8:11], s27 offen sc1
 s_add_u32 s27, s27, 133120
 buffer_load_dwordx4 v[144:147], v6, s[8:11], s26 offen sc1
 s_add_u32 s26, s26, 133120
 buffer_load_dwordx4 v[148:151], v6, s[8:11], s27 offen sc1
 s_add_u32 s27, s27, 133120
 buffer_load_dwordx4 v[152:155], v6, s[8:11], s26 offen sc1
 s_add_u32 s26, s26, 133120
 buffer_load_dwordx4 v[156:159], v6, s[8:11], s27 offen sc1
 s_add_u32 s27, s27, 133120
 s_waitcnt vmcnt(0)
 v_max_u32 v8, v136, v137
 v_max3_u32 v8, v138, v139, v8
 v_max3_u32 v8, v140, v141, v8
 v_max3_u32 v8, v142, v143, v8
 v_cmp_eq_u32 vcc, -1, v8
 s_cbranch_vccnz L_p3_f15
 s_branch L_p3_o15
L_p3_f16:
 s_add_u32 s59, s59, 1
 s_cmp_gt_u32 s59, 131072
 s_cbranch_scc1 L_p3_o16
 s_sub_u32 s26, s26, 266240
 s_sub_u32 s27, s27, 266240
 s_waitcnt vmcnt(0)
 buffer_load_dwordx4 v[144:147], v6, s[8:11], s26 offen sc1
 s_add_u32 s26, s26, 133120
 buffer_load_dwordx4 v[148:151], v6, s[8:11], s27 offen sc1
 s_add_u32 s27, s27, 133120
 buffer_load_dwordx4 v[152:155], v6, s[8:11], s26 offen sc1
 s_add_u32 s26, s26, 133120
 buffer_load_dwordx4 v[156:159], v6, s[8:11], s27 offen sc1
 s_add_u32 s27, s27, 133120
 s_waitcnt vmcnt(0)
 v_max_u32 v8, v144, v145
 v_max3_u32 v8, v146, v147, v8
 v_max3_u32 v8, v148, v149, v8
 v_max3_u32 v8, v150, v151, v8
 v_cmp_eq_u32 vcc, -1, v8
 s_cbranch_vccnz L_p3_f16
 s_branch L_p3_o16
L_p3_f17:
 s_add_u32 s59, s59, 1
 s_cmp_gt_u32 s59, 131072
 s_cbranch_scc1 L_p3_o17
 s_sub_u32 s26, s26, 133120
 s_sub_u32 s27, s27, 133120
 s_waitcnt vmcnt(0)
 buffer_load_dwordx4 v[152:155], v6, s[8:11], s26 offen sc1
 s_add_u32 s26, s26, 133120
 buffer_load_dwordx4 v[156:159], v6, s[8:11], s27 offen sc1
 s_add_u32 s27, s27, 133120
 s_waitcnt vmcnt(0)
 v_max_u32 v8, v152, v153
 v_max3_u32 v8, v154, v155, v8
 v_max3_u32 v8, v156, v157, v8
 v_max3_u32 v8, v158, v159, v8
 v_cmp_eq_u32 vcc, -1, v8
 s_cbranch_vccnz L_p3_f17
 s_branch L_p3_o17
L_kp_side:
 s_waitcnt lgkmcnt(0)
 s_mov_b32 s8, s4
 s_mov_b32 s9, s5
 s_mov_b32 s10, 0x2000000
 s_mov_b32 s11, 0x20000
 s_cmp_ge_u32 s98, 243
 s_cbranch_scc1 L_kp_pz
 s_cmp_ge_u32 s98, 216
 s_cbranch_scc1 L_kp_j4
 s_sub_u32 s3, s98, 144
 s_and_b32 s23, s3, 7
 s_lshr_b32 s24, s3, 3
 s_cmp_eq_u32 s24, 8
 s_cselect_b32 s24, s23, s24
 s_cselect_b32 s23, 8, s23
 s_lshl2_add_u32 s25, s23, s20
 s_and_b32 s21, s24, 1
 s_xor_b32 s21, s21, 1
 s_lshl_b32 s22, s24, 2
 s_lshr_b32 s27, s24, 1
 s_add_u32 s27, s27, 32
 s_sub_u32 s3, s25, 32
 s_lshr_b32 s28, s3, 1
 s_lshl_b32 s28, s28, 3
 s_and_b32 s3, s25, 1
 s_add_u32 s28, s28, s3
 s_mul_i32 s29, s25, 18
 s_cmp_ge_u32 s25, 32
 s_cselect_b64 vcc, -1, 0
 v_lshrrev_b32 v10, 3, v1
 v_add_u32 v10, 0, v10
 v_add_u32 v11, s29, v10
 v_lshrrev_b32 v12, 2, v10
 v_lshl_add_u32 v12, v12, 1, s28
 v_bfe_u32 v13, v10, 1, 1
 v_lshl_add_u32 v12, v12, 1, v13
 v_mul_u32_u24 v12, 18, v12
 v_and_b32 v13, 1, v10
 v_add3_u32 v12, v12, v13, 16
 v_cndmask_b32 v11, v11, v12, vcc
 v_mul_u32_u24 v5, 1152, v11
 v_lshrrev_b32 v10, 3, v1
 v_add_u32 v10, 8, v10
 v_add_u32 v11, s29, v10
 v_lshrrev_b32 v12, 2, v10
 v_lshl_add_u32 v12, v12, 1, s28
 v_bfe_u32 v13, v10, 1, 1
 v_lshl_add_u32 v12, v12, 1, v13
 v_mul_u32_u24 v12, 18, v12
 v_and_b32 v13, 1, v10
 v_add3_u32 v12, v12, v13, 16
 v_cndmask_b32 v11, v11, v12, vcc
 v_mul_u32_u24 v6, 1152, v11
 v_and_b32 v8, 7, v1
 v_xor_b32 v9, v8, v3
 v_lshl_add_u32 v5, v9, 4, v5
 v_xor_b32 v9, 4, v9
 v_lshl_add_u32 v6, v9, 4, v6
 s_mov_b32 s12, s52
 s_mov_b32 s13, s53
 s_mov_b32 s14, 0xa2000
 s_mov_b32 s15, 0x20000
 s_mul_i32 s36, s20, 18432
 s_mov_b32 s37, s24
 s_mov_b32 s40, 3
L_j2xa:
 s_lshl_b32 s3, s37, 11
 s_add_u32 m0, s3, s36
 s_lshl_b32 s3, s37, 7
 buffer_load_dwordx4 v5, s[12:15], s3 offen lds
 s_add_u32 m0, m0, 1024
 s_add_u32 s37, s37, 1
 buffer_load_dwordx4 v6, s[12:15], s3 offen lds
 s_cmp_eq_u32 s37, 9
 s_cselect_b32 s37, 0, s37
 s_sub_u32 s40, s40, 1
 s_cmp_lg_u32 s40, 0
 s_cbranch_scc1 L_j2xa
 v_add_u32 v7, 92160, v4
 s_mov_b32 s41, 1
 s_add_u32 s38, s22, s20
 v_lshrrev_b32 v8, 2, v2
 v_lshlrev_b32 v8, 3, v8
 v_and_b32 v9, 3, v2
 v_add_u32 v8, v8, v9
 v_lshlrev_b32 v9, 3, v3
 v_cvt_f32_u32 v9, v9
 s_lshr_b32 s3, s38, 1
 s_lshl_b32 s3, s3, 5
 s_and_b32 s39, s38, 1
 s_lshl2_add_u32 s3, s39, s3
 v_add_u32 v10, s3, v8
 v_lshrrev_b32 v11, 1, v10
 v_and_b32 v12, 1, v10
 v_cvt_f32_u32 v12, v12
 v_mul_f32 v12, 0x3e800000, v12
 v_cvt_f32_u32 v11, v11
 v_mul_f32 v11, 0x3ae38e39, v11
 v_cmp_eq_u32 vcc, 0, v10
 s_nop 1
 v_cndmask_b32 v11, v11, 0.5, vcc
 v_cmp_eq_u32 vcc, 1, v10
 s_nop 1
 v_cndmask_b32 v12, v12, 0, vcc
 v_cos_f32 v15, v11
 s_nop 0
 v_add_f32 v15, v15, v15
 v_mul_f32 v13, 0x42000000, v11
 v_fma_f32 v88, v9, v11, v12
 v_add_f32 v96, v88, v13
 v_add_f32 v89, v88, v11
 v_add_f32 v97, v96, v11
 v_cos_f32 v13, v13
 v_cos_f32 v88, v88
 v_cos_f32 v96, v96
 v_cos_f32 v89, v89
 v_cos_f32 v97, v97
 s_lshl_b32 s3, s20, 10
 v_add_u32 v14, s3, v7
 v_add_f32 v13, v13, v13
 v_fma_f32 v90, v15, v89, -v88
 v_fma_f32 v98, v15, v97, -v96
 v_fma_f32 v91, v15, v90, -v89
 v_fma_f32 v99, v15, v98, -v97
 v_fma_f32 v92, v15, v91, -v90
 v_fma_f32 v100, v15, v99, -v98
 v_fma_f32 v93, v15, v92, -v91
 v_fma_f32 v101, v15, v100, -v99
 v_fma_f32 v94, v15, v93, -v92
 v_fma_f32 v102, v15, v101, -v100
 v_fma_f32 v95, v15, v94, -v93
 v_fma_f32 v103, v15, v102, -v101
 v_cvt_pk_bf16_f32 v104, v88, v89
 v_cvt_pk_bf16_f32 v105, v90, v91
 v_cvt_pk_bf16_f32 v106, v92, v93
 v_cvt_pk_bf16_f32 v107, v94, v95
 ds_write_b128 v14, v[104:107] offset:0
 v_cvt_pk_bf16_f32 v108, v96, v97
 v_cvt_pk_bf16_f32 v109, v98, v99
 v_cvt_pk_bf16_f32 v110, v100, v101
 v_cvt_pk_bf16_f32 v111, v102, v103
 ds_write_b128 v14, v[108:111] offset:5120
 v_fma_f32 v88, v13, v96, -v88
 v_fma_f32 v89, v13, v97, -v89
 v_fma_f32 v90, v13, v98, -v90
 v_fma_f32 v91, v13, v99, -v91
 v_fma_f32 v92, v13, v100, -v92
 v_fma_f32 v93, v13, v101, -v93
 v_fma_f32 v94, v13, v102, -v94
 v_fma_f32 v95, v13, v103, -v95
 v_cvt_pk_bf16_f32 v104, v88, v89
 v_cvt_pk_bf16_f32 v105, v90, v91
 v_cvt_pk_bf16_f32 v106, v92, v93
 v_cvt_pk_bf16_f32 v107, v94, v95
 ds_write_b128 v14, v[104:107] offset:10240
 v_fma_f32 v96, v13, v88, -v96
 v_fma_f32 v97, v13, v89, -v97
 v_fma_f32 v98, v13, v90, -v98
 v_fma_f32 v99, v13, v91, -v99
 v_fma_f32 v100, v13, v92, -v100
 v_fma_f32 v101, v13, v93, -v101
 v_fma_f32 v102, v13, v94, -v102
 v_fma_f32 v103, v13, v95, -v103
 v_cvt_pk_bf16_f32 v108, v96, v97
 v_cvt_pk_bf16_f32 v109, v98, v99
 v_cvt_pk_bf16_f32 v110, v100, v101
 v_cvt_pk_bf16_f32 v111, v102, v103
 ds_write_b128 v14, v[108:111] offset:15360
 v_fma_f32 v88, v13, v96, -v88
 v_fma_f32 v89, v13, v97, -v89
 v_fma_f32 v90, v13, v98, -v90
 v_fma_f32 v91, v13, v99, -v91
 v_fma_f32 v92, v13, v100, -v92
 v_fma_f32 v93, v13, v101, -v93
 v_fma_f32 v94, v13, v102, -v94
 v_fma_f32 v95, v13, v103, -v95
 v_cvt_pk_bf16_f32 v104, v88, v89
 v_cvt_pk_bf16_f32 v105, v90, v91
 v_cvt_pk_bf16_f32 v106, v92, v93
 v_cvt_pk_bf16_f32 v107, v94, v95
 ds_write_b128 v14, v[104:107] offset:20480
 v_fma_f32 v96, v13, v88, -v96
 v_fma_f32 v97, v13, v89, -v97
 v_fma_f32 v98, v13, v90, -v98
 v_fma_f32 v99, v13, v91, -v99
 v_fma_f32 v100, v13, v92, -v100
 v_fma_f32 v101, v13, v93, -v101
 v_fma_f32 v102, v13, v94, -v102
 v_fma_f32 v103, v13, v95, -v103
 v_cvt_pk_bf16_f32 v108, v96, v97
 v_cvt_pk_bf16_f32 v109, v98, v99
 v_cvt_pk_bf16_f32 v110, v100, v101
 v_cvt_pk_bf16_f32 v111, v102, v103
 ds_write_b128 v14, v[108:111] offset:25600
 v_fma_f32 v88, v13, v96, -v88
 v_fma_f32 v89, v13, v97, -v89
 v_fma_f32 v90, v13, v98, -v90
 v_fma_f32 v91, v13, v99, -v91
 v_fma_f32 v92, v13, v100, -v92
 v_fma_f32 v93, v13, v101, -v93
 v_fma_f32 v94, v13, v102, -v94
 v_fma_f32 v95, v13, v103, -v95
 v_cvt_pk_bf16_f32 v104, v88, v89
 v_cvt_pk_bf16_f32 v105, v90, v91
 v_cvt_pk_bf16_f32 v106, v92, v93
 v_cvt_pk_bf16_f32 v107, v94, v95
 ds_write_b128 v14, v[104:107] offset:30720
 v_fma_f32 v96, v13, v88, -v96
 v_fma_f32 v97, v13, v89, -v97
 v_fma_f32 v98, v13, v90, -v98
 v_fma_f32 v99, v13, v91, -v99
 v_fma_f32 v100, v13, v92, -v100
 v_fma_f32 v101, v13, v93, -v101
 v_fma_f32 v102, v13, v94, -v102
 v_fma_f32 v103, v13, v95, -v103
 v_cvt_pk_bf16_f32 v108, v96, v97
 v_cvt_pk_bf16_f32 v109, v98, v99
 v_cvt_pk_bf16_f32 v110, v100, v101
 v_cvt_pk_bf16_f32 v111, v102, v103
 ds_write_b128 v14, v[108:111] offset:35840
 v_fma_f32 v88, v13, v96, -v88
 v_fma_f32 v89, v13, v97, -v89
 v_fma_f32 v90, v13, v98, -v90
 v_fma_f32 v91, v13, v99, -v91
 v_fma_f32 v92, v13, v100, -v92
 v_fma_f32 v93, v13, v101, -v93
 v_fma_f32 v94, v13, v102, -v94
 v_fma_f32 v95, v13, v103, -v95
 v_cvt_pk_bf16_f32 v104, v88, v89
 v_cvt_pk_bf16_f32 v105, v90, v91
 v_cvt_pk_bf16_f32 v106, v92, v93
 v_cvt_pk_bf16_f32 v107, v94, v95
 ds_write_b128 v14, v[104:107] offset:40960
 s_cmp_eq_u32 s41, 0
 s_cbranch_scc1 L_j2_trig_done
 s_mov_b32 s38, s27
 s_mov_b32 s33, s20
 s_lshr_b32 s3, s38, 1
 s_lshl_b32 s3, s3, 5
 s_and_b32 s39, s38, 1
 s_lshl2_add_u32 s3, s39, s3
 v_add_u32 v10, s3, v8
 v_lshrrev_b32 v11, 1, v10
 v_and_b32 v12, 1, v10
 v_cvt_f32_u32 v12, v12
 v_mul_f32 v12, 0x3e800000, v12
 v_cvt_f32_u32 v11, v11
 v_mul_f32 v11, 0x3ae38e39, v11
 v_cmp_eq_u32 vcc, 0, v10
 s_nop 1
 v_cndmask_b32 v11, v11, 0.5, vcc
 v_cmp_eq_u32 vcc, 1, v10
 s_nop 1
 v_cndmask_b32 v12, v12, 0, vcc
 v_cos_f32 v15, v11
 s_nop 0
 v_add_f32 v15, v15, v15
L_j2_tr:
 s_lshl_b32 s3, s33, 5
 v_cvt_f32_u32 v13, s3
 v_add_f32 v13, v13, v9
 v_fma_f32 v13, v13, v11, v12
 v_fract_f32 v13, v13
 v_add_f32 v89, v13, v11
 v_cos_f32 v88, v13
 v_cos_f32 v89, v89
 s_mul_i32 s3, s33, 5120
 v_add_u32 v14, s3, v7
 v_fma_f32 v90, v15, v89, -v88
 v_fma_f32 v91, v15, v90, -v89
 v_fma_f32 v92, v15, v91, -v90
 v_fma_f32 v93, v15, v92, -v91
 v_fma_f32 v94, v15, v93, -v92
 v_fma_f32 v95, v15, v94, -v93
 v_cvt_pk_bf16_f32 v96, v88, v89
 v_cvt_pk_bf16_f32 v97, v90, v91
 v_cvt_pk_bf16_f32 v98, v92, v93
 v_cvt_pk_bf16_f32 v99, v94, v95
 s_add_u32 s33, s33, 4
 s_cmp_lt_u32 s33, 9
 ds_write_b128 v14, v[96:99] offset:4096
 s_cbranch_scc1 L_j2_tr
L_j2_trig_done:
 s_mov_b32 s40, 6
L_j2xb:
 s_lshl_b32 s3, s37, 11
 s_add_u32 m0, s3, s36
 s_lshl_b32 s3, s37, 7
 buffer_load_dwordx4 v5, s[12:15], s3 offen lds
 s_add_u32 m0, m0, 1024
 s_add_u32 s37, s37, 1
 buffer_load_dwordx4 v6, s[12:15], s3 offen lds
 s_cmp_eq_u32 s37, 9
 s_cselect_b32 s37, 0, s37
 s_sub_u32 s40, s40, 1
 s_cmp_lg_u32 s40, 0
 s_cbranch_scc1 L_j2xb
 v_add_u32 v5, 92160, v4
 v_lshrrev_b32 v8, 1, v2
 v_xor_b32 v8, v8, v3
 v_lshlrev_b32 v9, 7, v2
 s_mul_i32 s3, s20, 18432
 s_add_u32 s3, s3, 0
 v_add_u32 v9, s3, v9
 v_lshl_add_u32 v10, v8, 4, v9
 v_xor_b32 v8, 4, v8
 v_lshl_add_u32 v11, v8, 4, v9
 v_and_b32 v8, 1, v2
 v_lshlrev_b32 v8, 4, v8
 v_mov_b32 v9, 0x3f80
 v_lshlrev_b32 v8, v8, v9
 v_lshrrev_b32 v9, 1, v2
 v_lshlrev_b32 v12, 1, v3
 v_cmp_eq_u32 vcc, v9, v12
 s_nop 1
 v_cndmask_b32 v130, 0, v8, vcc
 v_add_u32 v12, 1, v12
 v_cmp_eq_u32 vcc, v9, v12
 s_nop 1
 v_cndmask_b32 v131, 0, v8, vcc
 v_mov_b32 v128, 0
 v_mov_b32 v129, 0
 v_mov_b32 v132, 0
 v_mov_b32 v133, 0
 v_and_b32 v8, 2, v2
 v_cmp_eq_u32 vcc, 0, v8
 v_mov_b32 v9, -1.0
 s_nop 0
 v_cndmask_b32 v14, v9, 1.0, vcc
 s_cmp_eq_u32 s24, 0
 s_mov_b32 s36, 0x3d715bef
 s_cselect_b32 s3, 0x3d2aaaab, s36
 v_mov_b32 v12, s36
 v_mov_b32 v13, s3
 v_cmp_gt_u32 vcc, 2, v2
 s_nop 1
 v_cndmask_b32 v13, v12, v13, vcc
 s_lshl_b32 s3, s24, 11
 v_add_u32 v6, s3, v10
 v_add_u32 v7, s3, v11
 s_bitcmp1_b32 s27, 1
 s_cselect_b64 vcc, -1, 0
 v_cndmask_b32 v15, v10, v11, vcc
 s_waitcnt vmcnt(0)
 ds_read_b128 v[16:19], v10 offset:0
 ds_read_b128 v[52:55], v11 offset:8192
 ds_read_b128 v[20:23], v11 offset:0
 ds_read_b128 v[56:59], v10 offset:10240
 ds_read_b128 v[24:27], v10 offset:2048
 ds_read_b128 v[60:63], v11 offset:10240
 ds_read_b128 v[28:31], v11 offset:2048
 ds_read_b128 v[64:67], v10 offset:12288
 ds_read_b128 v[32:35], v10 offset:4096
 ds_read_b128 v[68:71], v11 offset:12288
 ds_read_b128 v[36:39], v11 offset:4096
 ds_read_b128 v[72:75], v10 offset:14336
 ds_read_b128 v[40:43], v10 offset:6144
 ds_read_b128 v[76:79], v11 offset:14336
 ds_read_b128 v[44:47], v11 offset:6144
 ds_read_b128 v[80:83], v10 offset:16384
 ds_read_b128 v[48:51], v10 offset:8192
 ds_read_b128 v[84:87], v11 offset:16384
 ds_read_b128 v[136:139], v6
 ds_read_b128 v[140:143], v7
 ds_read_b128 v[144:147], v15 offset:16384
 s_waitcnt vmcnt(0) lgkmcnt(0)
 s_barrier
 s_add_u32 s61, s60, 0
 s_lshl_b32 s3, s20, 10
 s_add_u32 m0, s3, 0
 ds_read_b128 a[0:3], v5 offset:0
 ds_read_b128 a[4:7], v5 offset:1024
 ds_read_b128 a[8:11], v5 offset:2048
 ds_read_b128 a[12:15], v5 offset:3072
 ds_read_b128 a[16:19], v5 offset:4096
 s_waitcnt lgkmcnt(4)
 v_mfma_f32_16x16x32_bf16 v[88:91], v[16:19], a[0:3], 0
 v_mfma_f32_16x16x32_bf16 v[92:95], v[52:55], a[0:3], 0
 ds_read_b128 a[20:23], v5 offset:5120
 s_waitcnt lgkmcnt(4)
 v_mfma_f32_16x16x32_bf16 v[96:99], v[16:19], a[4:7], 0
 ds_read_b128 a[24:27], v5 offset:6144
 v_mfma_f32_16x16x32_bf16 v[100:103], v[52:55], a[4:7], 0
 s_waitcnt lgkmcnt(4)
 v_mfma_f32_16x16x32_bf16 v[104:107], v[16:19], a[8:11], 0
 ds_read_b128 a[28:31], v5 offset:7168
 v_mfma_f32_16x16x32_bf16 v[108:111], v[52:55], a[8:11], 0
 ds_read_b128 a[32:35], v5 offset:8192
 s_waitcnt lgkmcnt(5)
 v_mfma_f32_16x16x32_bf16 v[112:115], v[16:19], a[12:15], 0
 v_mfma_f32_16x16x32_bf16 v[116:119], v[52:55], a[12:15], 0
 ds_read_b128 a[36:39], v5 offset:9216
 s_waitcnt lgkmcnt(5)
 v_mfma_f32_16x16x32_bf16 v[120:123], v[16:19], a[16:19], 0
 buffer_load_dwordx4 v4, s[8:11], s61 offen lds
 s_add_u32 s61, s61, 4096
 s_add_u32 m0, m0, 4096
 v_mfma_f32_16x16x32_bf16 v[124:127], v[52:55], a[16:19], 0
 buffer_load_dwordx4 v4, s[8:11], s61 offen lds
 s_add_u32 s61, s61, 4096
 s_add_u32 m0, m0, 4096
 s_waitcnt lgkmcnt(4)
 v_mfma_f32_16x16x32_bf16 v[88:91], v[20:23], a[20:23], v[88:91]
 v_mfma_f32_16x16x32_bf16 v[92:95], v[56:59], a[20:23], v[92:95]
 ds_read_b128 a[0:3], v5 offset:10240
 s_waitcnt lgkmcnt(4)
 v_mfma_f32_16x16x32_bf16 v[96:99], v[20:23], a[24:27], v[96:99]
 ds_read_b128 a[4:7], v5 offset:11264
 v_mfma_f32_16x16x32_bf16 v[100:103], v[56:59], a[24:27], v[100:103]
 s_waitcnt lgkmcnt(4)
 v_mfma_f32_16x16x32_bf16 v[104:107], v[20:23], a[28:31], v[104:107]
 ds_read_b128 a[8:11], v5 offset:12288
 v_mfma_f32_16x16x32_bf16 v[108:111], v[56:59], a[28:31], v[108:111]
 ds_read_b128 a[12:15], v5 offset:13312
 s_waitcnt lgkmcnt(5)
 v_mfma_f32_16x16x32_bf16 v[112:115], v[20:23], a[32:35], v[112:115]
 v_mfma_f32_16x16x32_bf16 v[116:119], v[56:59], a[32:35], v[116:119]
 ds_read_b128 a[16:19], v5 offset:14336
 s_waitcnt lgkmcnt(5)
 v_mfma_f32_16x16x32_bf16 v[120:123], v[20:23], a[36:39], v[120:123]
 buffer_load_dwordx4 v4, s[8:11], s61 offen lds
 s_add_u32 s61, s61, 4096
 s_add_u32 m0, m0, 4096
 v_mfma_f32_16x16x32_bf16 v[124:127], v[56:59], a[36:39], v[124:127]
 buffer_load_dwordx4 v4, s[8:11], s61 offen lds
 s_add_u32 s61, s61, 4096
 s_add_u32 m0, m0, 4096
 s_waitcnt lgkmcnt(4)
 v_mfma_f32_16x16x32_bf16 v[88:91], v[24:27], a[0:3], v[88:91]
 v_mfma_f32_16x16x32_bf16 v[92:95], v[60:63], a[0:3], v[92:95]
 ds_read_b128 a[20:23], v5 offset:15360
 s_waitcnt lgkmcnt(4)
 v_mfma_f32_16x16x32_bf16 v[96:99], v[24:27], a[4:7], v[96:99]
 ds_read_b128 a[24:27], v5 offset:16384
 v_mfma_f32_16x16x32_bf16 v[100:103], v[60:63], a[4:7], v[100:103]
 ds_read_b128 a[28:31], v5 offset:17408
 s_waitcnt lgkmcnt(5)
 v_mfma_f32_16x16x32_bf16 v[104:107], v[24:27], a[8:11], v[104:107]
 ds_read_b128 a[32:35], v5 offset:18432
 v_mfma_f32_16x16x32_bf16 v[108:111], v[60:63], a[8:11], v[108:111]
 s_waitcnt lgkmcnt(5)
 v_mfma_f32_16x16x32_bf16 v[112:115], v[24:27], a[12:15], v[112:115]
 ds_read_b128 a[36:39], v5 offset:19456
 v_mfma_f32_16x16x32_bf16 v[116:119], v[60:63], a[12:15], v[116:119]
 buffer_load_dwordx4 v4, s[8:11], s61 offen lds
 s_add_u32 s61, s61, 4096
 s_add_u32 m0, m0, 4096
 s_waitcnt lgkmcnt(5)
 v_mfma_f32_16x16x32_bf16 v[120:123], v[24:27], a[16:19], v[120:123]
 buffer_load_dwordx4 v4, s[8:11], s61 offen lds
 s_add_u32 s61, s61, 4096
 s_add_u32 m0, m0, 4096
 v_mfma_f32_16x16x32_bf16 v[124:127], v[60:63], a[16:19], v[124:127]
 buffer_load_dwordx4 v4, s[8:11], s61 offen lds
 s_add_u32 s61, s61, 4096
 s_add_u32 m0, m0, 4096
 s_waitcnt lgkmcnt(4)
 v_mfma_f32_16x16x32_bf16 v[88:91], v[28:31], a[20:23], v[88:91]
 v_mfma_f32_16x16x32_bf16 v[92:95], v[64:67], a[20:23], v[92:95]
 ds_read_b128 a[0:3], v5 offset:20480
 s_waitcnt lgkmcnt(4)
 v_mfma_f32_16x16x32_bf16 v[96:99], v[28:31], a[24:27], v[96:99]
 ds_read_b128 a[4:7], v5 offset:21504
 v_mfma_f32_16x16x32_bf16 v[100:103], v[64:67], a[24:27], v[100:103]
 s_waitcnt lgkmcnt(4)
 v_mfma_f32_16x16x32_bf16 v[104:107], v[28:31], a[28:31], v[104:107]
 ds_read_b128 a[8:11], v5 offset:22528
 v_mfma_f32_16x16x32_bf16 v[108:111], v[64:67], a[28:31], v[108:111]
 ds_read_b128 a[12:15], v5 offset:23552
 s_waitcnt lgkmcnt(5)
 v_mfma_f32_16x16x32_bf16 v[112:115], v[28:31], a[32:35], v[112:115]
 v_mfma_f32_16x16x32_bf16 v[116:119], v[64:67], a[32:35], v[116:119]
 ds_read_b128 a[16:19], v5 offset:24576
 s_waitcnt lgkmcnt(5)
 v_mfma_f32_16x16x32_bf16 v[120:123], v[28:31], a[36:39], v[120:123]
 buffer_load_dwordx4 v4, s[8:11], s61 offen lds
 s_add_u32 s61, s61, 4096
 s_add_u32 m0, m0, 4096
 v_mfma_f32_16x16x32_bf16 v[124:127], v[64:67], a[36:39], v[124:127]
 buffer_load_dwordx4 v4, s[8:11], s61 offen lds
 s_add_u32 s61, s61, 4096
 s_add_u32 m0, m0, 4096
 s_waitcnt lgkmcnt(4)
 v_mfma_f32_16x16x32_bf16 v[88:91], v[32:35], a[0:3], v[88:91]
 v_mfma_f32_16x16x32_bf16 v[92:95], v[68:71], a[0:3], v[92:95]
 ds_read_b128 a[20:23], v5 offset:25600
 s_waitcnt lgkmcnt(4)
 v_mfma_f32_16x16x32_bf16 v[96:99], v[32:35], a[4:7], v[96:99]
 ds_read_b128 a[24:27], v5 offset:26624
 v_mfma_f32_16x16x32_bf16 v[100:103], v[68:71], a[4:7], v[100:103]
 ds_read_b128 a[28:31], v5 offset:27648
 s_waitcnt lgkmcnt(5)
 v_mfma_f32_16x16x32_bf16 v[104:107], v[32:35], a[8:11], v[104:107]
 ds_read_b128 a[32:35], v5 offset:28672
 v_mfma_f32_16x16x32_bf16 v[108:111], v[68:71], a[8:11], v[108:111]
 s_waitcnt lgkmcnt(5)
 v_mfma_f32_16x16x32_bf16 v[112:115], v[32:35], a[12:15], v[112:115]
 ds_read_b128 a[36:39], v5 offset:29696
 v_mfma_f32_16x16x32_bf16 v[116:119], v[68:71], a[12:15], v[116:119]
 buffer_load_dwordx4 v4, s[8:11], s61 offen lds
 s_add_u32 s61, s61, 4096
 s_add_u32 m0, m0, 4096
 s_waitcnt lgkmcnt(5)
 v_mfma_f32_16x16x32_bf16 v[120:123], v[32:35], a[16:19], v[120:123]
 buffer_load_dwordx4 v4, s[8:11], s61 offen lds
 s_add_u32 s61, s61, 4096
 s_add_u32 m0, m0, 4096
 v_mfma_f32_16x16x32_bf16 v[124:127], v[68:71], a[16:19], v[124:127]
 buffer_load_dwordx4 v4, s[8:11], s61 offen lds
 s_add_u32 s61, s61, 4096
 s_add_u32 m0, m0, 4096
 s_waitcnt lgkmcnt(4)
 v_mfma_f32_16x16x32_bf16 v[88:91], v[36:39], a[20:23], v[88:91]
 v_mfma_f32_16x16x32_bf16 v[92:95], v[72:75], a[20:23], v[92:95]
 ds_read_b128 a[0:3], v5 offset:30720
 s_waitcnt lgkmcnt(4)
 v_mfma_f32_16x16x32_bf16 v[96:99], v[36:39], a[24:27], v[96:99]
 ds_read_b128 a[4:7], v5 offset:31744
 v_mfma_f32_16x16x32_bf16 v[100:103], v[72:75], a[24:27], v[100:103]
 s_waitcnt lgkmcnt(4)
 v_mfma_f32_16x16x32_bf16 v[104:107], v[36:39], a[28:31], v[104:107]
 ds_read_b128 a[8:11], v5 offset:32768
 v_mfma_f32_16x16x32_bf16 v[108:111], v[72:75], a[28:31], v[108:111]
 ds_read_b128 a[12:15], v5 offset:33792
 s_waitcnt lgkmcnt(5)
 v_mfma_f32_16x16x32_bf16 v[112:115], v[36:39], a[32:35], v[112:115]
 v_mfma_f32_16x16x32_bf16 v[116:119], v[72:75], a[32:35], v[116:119]
 ds_read_b128 a[16:19], v5 offset:34816
 s_waitcnt lgkmcnt(5)
 v_mfma_f32_16x16x32_bf16 v[120:123], v[36:39], a[36:39], v[120:123]
 buffer_load_dwordx4 v4, s[8:11], s61 offen lds
 s_add_u32 s61, s61, 4096
 s_add_u32 m0, m0, 4096
 v_mfma_f32_16x16x32_bf16 v[124:127], v[72:75], a[36:39], v[124:127]
 buffer_load_dwordx4 v4, s[8:11], s61 offen lds
 s_add_u32 s61, s61, 4096
 s_add_u32 m0, m0, 4096
 s_waitcnt lgkmcnt(4)
 v_mfma_f32_16x16x32_bf16 v[88:91], v[40:43], a[0:3], v[88:91]
 v_mfma_f32_16x16x32_bf16 v[92:95], v[76:79], a[0:3], v[92:95]
 ds_read_b128 a[20:23], v5 offset:35840
 s_waitcnt lgkmcnt(4)
 v_mfma_f32_16x16x32_bf16 v[96:99], v[40:43], a[4:7], v[96:99]
 ds_read_b128 a[24:27], v5 offset:36864
 v_mfma_f32_16x16x32_bf16 v[100:103], v[76:79], a[4:7], v[100:103]
 ds_read_b128 a[28:31], v5 offset:37888
 s_waitcnt lgkmcnt(5)
 v_mfma_f32_16x16x32_bf16 v[104:107], v[40:43], a[8:11], v[104:107]
 ds_read_b128 a[32:35], v5 offset:38912
 v_mfma_f32_16x16x32_bf16 v[108:111], v[76:79], a[8:11], v[108:111]
 s_waitcnt lgkmcnt(5)
 v_mfma_f32_16x16x32_bf16 v[112:115], v[40:43], a[12:15], v[112:115]
 ds_read_b128 a[36:39], v5 offset:39936
 v_mfma_f32_16x16x32_bf16 v[116:119], v[76:79], a[12:15], v[116:119]
 buffer_load_dwordx4 v4, s[8:11], s61 offen lds
 s_add_u32 s61, s61, 4096
 s_add_u32 m0, m0, 4096
 s_waitcnt lgkmcnt(5)
 v_mfma_f32_16x16x32_bf16 v[120:123], v[40:43], a[16:19], v[120:123]
 buffer_load_dwordx4 v4, s[8:11], s61 offen lds
 s_add_u32 s61, s61, 4096
 s_add_u32 m0, m0, 4096
 v_mfma_f32_16x16x32_bf16 v[124:127], v[76:79], a[16:19], v[124:127]
 buffer_load_dwordx4 v4, s[8:11], s61 offen lds
 s_add_u32 s61, s61, 4096
 s_add_u32 m0, m0, 4096
 s_waitcnt lgkmcnt(4)
 v_mfma_f32_16x16x32_bf16 v[88:91], v[44:47], a[20:23], v[88:91]
 v_mfma_f32_16x16x32_bf16 v[92:95], v[80:83], a[20:23], v[92:95]
 ds_read_b128 a[0:3], v5 offset:40960
 s_waitcnt lgkmcnt(4)
 v_mfma_f32_16x16x32_bf16 v[96:99], v[44:47], a[24:27], v[96:99]
 ds_read_b128 a[4:7], v5 offset:41984
 v_mfma_f32_16x16x32_bf16 v[100:103], v[80:83], a[24:27], v[100:103]
 s_waitcnt lgkmcnt(4)
 v_mfma_f32_16x16x32_bf16 v[104:107], v[44:47], a[28:31], v[104:107]
 ds_read_b128 a[8:11], v5 offset:43008
 v_mfma_f32_16x16x32_bf16 v[108:111], v[80:83], a[28:31], v[108:111]
 ds_read_b128 a[12:15], v5 offset:44032
 s_waitcnt lgkmcnt(5)
 v_mfma_f32_16x16x32_bf16 v[112:115], v[44:47], a[32:35], v[112:115]
 v_mfma_f32_16x16x32_bf16 v[116:119], v[80:83], a[32:35], v[116:119]
 ds_read_b128 a[16:19], v5 offset:45056
 s_waitcnt lgkmcnt(5)
 v_mfma_f32_16x16x32_bf16 v[120:123], v[44:47], a[36:39], v[120:123]
 buffer_load_dwordx4 v4, s[8:11], s61 offen lds
 s_add_u32 s61, s61, 4096
 s_add_u32 m0, m0, 4096
 v_mfma_f32_16x16x32_bf16 v[124:127], v[80:83], a[36:39], v[124:127]
 buffer_load_dwordx4 v4, s[8:11], s61 offen lds
 s_add_u32 s61, s61, 4096
 s_add_u32 m0, m0, 4096
 s_waitcnt lgkmcnt(4)
 v_mfma_f32_16x16x32_bf16 v[88:91], v[48:51], a[0:3], v[88:91]
 v_mfma_f32_16x16x32_bf16 v[92:95], v[84:87], a[0:3], v[92:95]
 s_waitcnt lgkmcnt(3)
 v_mfma_f32_16x16x32_bf16 v[96:99], v[48:51], a[4:7], v[96:99]
 v_mfma_f32_16x16x32_bf16 v[100:103], v[84:87], a[4:7], v[100:103]
 buffer_load_dwordx4 v4, s[8:11], s61 offen lds
 s_add_u32 s61, s61, 4096
 s_add_u32 m0, m0, 4096
 s_waitcnt lgkmcnt(2)
 v_mfma_f32_16x16x32_bf16 v[104:107], v[48:51], a[8:11], v[104:107]
 v_mfma_f32_16x16x32_bf16 v[108:111], v[84:87], a[8:11], v[108:111]
 s_waitcnt lgkmcnt(1)
 v_mfma_f32_16x16x32_bf16 v[112:115], v[48:51], a[12:15], v[112:115]
 buffer_load_dwordx4 v4, s[8:11], s61 offen lds
 s_add_u32 s61, s61, 4096
 s_add_u32 m0, m0, 4096
 v_mfma_f32_16x16x32_bf16 v[116:119], v[84:87], a[12:15], v[116:119]
 s_waitcnt lgkmcnt(0)
 v_mfma_f32_16x16x32_bf16 v[120:123], v[48:51], a[16:19], v[120:123]
 v_mfma_f32_16x16x32_bf16 v[124:127], v[84:87], a[16:19], v[124:127]
 buffer_load_dwordx4 v4, s[8:11], s61 offen lds
 s_add_u32 s61, s61, 4096
 s_add_u32 m0, m0, 4096
 s_cmp_ge_u32 s20, 2
 s_cbranch_scc1 L_j2_n22
 buffer_load_dwordx4 v4, s[8:11], s61 offen lds
 s_add_u32 s61, s61, 4096
 s_add_u32 m0, m0, 4096
L_j2_n22:
 v_mfma_f32_16x16x32_bf16 v[148:151], v[136:139], v[130:133], 0
 v_mfma_f32_16x16x32_bf16 v[152:155], v[136:139], v[128:131], 0
 v_mfma_f32_16x16x32_bf16 v[156:159], v[140:143], v[130:133], 0
 v_mfma_f32_16x16x32_bf16 v[160:163], v[140:143], v[128:131], 0
 v_mfma_f32_16x16x32_bf16 v[164:167], v[144:147], v[130:133], 0
 v_mfma_f32_16x16x32_bf16 v[168:171], v[144:147], v[128:131], 0
 v_fma_f32 v88, v92, v14, v88
 v_fma_f32 v89, v93, v14, v89
 v_fma_f32 v90, v94, v14, v90
 v_fma_f32 v91, v95, v14, v91
 v_mul_f32 v88, v13, v88
 v_mul_f32 v89, v13, v89
 v_mul_f32 v90, v13, v90
 v_mul_f32 v91, v13, v91
 v_cvt_pk_bf16_f32 v16, v88, v89
 v_cvt_pk_bf16_f32 v17, v90, v91
 v_fma_f32 v96, v100, v14, v96
 v_fma_f32 v97, v101, v14, v97
 v_fma_f32 v98, v102, v14, v98
 v_fma_f32 v99, v103, v14, v99
 v_mul_f32 v96, v12, v96
 v_mul_f32 v97, v12, v97
 v_mul_f32 v98, v12, v98
 v_mul_f32 v99, v12, v99
 v_cvt_pk_bf16_f32 v18, v96, v97
 v_cvt_pk_bf16_f32 v19, v98, v99
 v_fma_f32 v104, v108, v14, v104
 v_fma_f32 v105, v109, v14, v105
 v_fma_f32 v106, v110, v14, v106
 v_fma_f32 v107, v111, v14, v107
 v_mul_f32 v104, v12, v104
 v_mul_f32 v105, v12, v105
 v_mul_f32 v106, v12, v106
 v_mul_f32 v107, v12, v107
 v_cvt_pk_bf16_f32 v20, v104, v105
 v_cvt_pk_bf16_f32 v21, v106, v107
 v_fma_f32 v112, v116, v14, v112
 v_fma_f32 v113, v117, v14, v113
 v_fma_f32 v114, v118, v14, v114
 v_fma_f32 v115, v119, v14, v115
 v_mul_f32 v112, v12, v112
 v_mul_f32 v113, v12, v113
 v_mul_f32 v114, v12, v114
 v_mul_f32 v115, v12, v115
 v_cvt_pk_bf16_f32 v22, v112, v113
 v_cvt_pk_bf16_f32 v23, v114, v115
 v_fma_f32 v120, v124, v14, v120
 v_fma_f32 v121, v125, v14, v121
 v_fma_f32 v122, v126, v14, v122
 v_fma_f32 v123, v127, v14, v123
 v_mul_f32 v120, v12, v120
 v_mul_f32 v121, v12, v121
 v_mul_f32 v122, v12, v122
 v_mul_f32 v123, v12, v123
 v_cvt_pk_bf16_f32 v24, v120, v121
 v_cvt_pk_bf16_f32 v25, v122, v123
 s_bitcmp1_b32 s27, 0
 s_cselect_b64 vcc, -1, 0
 v_cndmask_b32 v164, v164, v168, vcc
 v_cndmask_b32 v165, v165, v169, vcc
 v_cndmask_b32 v166, v166, v170, vcc
 v_cndmask_b32 v167, v167, v171, vcc
 v_cvt_pk_bf16_f32 v26, v148, v149
 v_cvt_pk_bf16_f32 v27, v150, v151
 v_cvt_pk_bf16_f32 v28, v152, v153
 v_cvt_pk_bf16_f32 v29, v154, v155
 v_cvt_pk_bf16_f32 v30, v156, v157
 v_cvt_pk_bf16_f32 v31, v158, v159
 v_cvt_pk_bf16_f32 v32, v160, v161
 v_cvt_pk_bf16_f32 v33, v162, v163
 v_cvt_pk_bf16_f32 v34, v164, v165
 v_cvt_pk_bf16_f32 v35, v166, v167
 s_and_b32 s38, s20, 1
 s_lshl_b32 s3, s20, 12
 s_add_u32 s3, s3, 139264
 v_lshl_add_u32 v5, v1, 3, s3
 v_xor_b32 v6, 0x1000, v5
 s_cmp_eq_u32 s38, 0
 s_cselect_b64 vcc, -1, 0
 s_mov_b32 s3, 0x16c0000
 s_cselect_b32 s39, 0x1600000, s3
 s_mul_i32 s3, s24, 92160
 s_add_u32 s39, s39, s3
 s_lshr_b32 s3, s25, 1
 s_lshl_b32 s37, s3, 10
 s_add_u32 s37, s37, s39
 s_add_u32 s37, s37, 73728
 s_lshl_b32 s3, s3, 12
 s_add_u32 s39, s39, s3
 v_cndmask_b32 v36, v16, v26, vcc
 v_cndmask_b32 v16, v26, v16, vcc
 v_cndmask_b32 v37, v17, v27, vcc
 v_cndmask_b32 v17, v27, v17, vcc
 ds_write_b64 v5, v[36:37] offset:0
 v_cndmask_b32 v38, v18, v28, vcc
 v_cndmask_b32 v18, v28, v18, vcc
 v_cndmask_b32 v39, v19, v29, vcc
 v_cndmask_b32 v19, v29, v19, vcc
 ds_write_b64 v5, v[38:39] offset:512
 v_cndmask_b32 v40, v20, v30, vcc
 v_cndmask_b32 v20, v30, v20, vcc
 v_cndmask_b32 v41, v21, v31, vcc
 v_cndmask_b32 v21, v31, v21, vcc
 ds_write_b64 v5, v[40:41] offset:1024
 v_cndmask_b32 v42, v22, v32, vcc
 v_cndmask_b32 v22, v32, v22, vcc
 v_cndmask_b32 v43, v23, v33, vcc
 v_cndmask_b32 v23, v33, v23, vcc
 ds_write_b64 v5, v[42:43] offset:1536
 v_cndmask_b32 v44, v24, v34, vcc
 v_cndmask_b32 v24, v34, v24, vcc
 v_cndmask_b32 v45, v25, v35, vcc
 v_cndmask_b32 v25, v35, v25, vcc
 ds_write_b64 v5, v[44:45] offset:2048
 s_waitcnt lgkmcnt(0)
 s_barrier
 ds_read_b64 v[36:37], v6 offset:0
 ds_read_b64 v[38:39], v6 offset:512
 ds_read_b64 v[40:41], v6 offset:1024
 ds_read_b64 v[42:43], v6 offset:1536
 ds_read_b64 v[44:45], v6 offset:2048
 s_waitcnt lgkmcnt(4)
 v_cndmask_b32 v48, v36, v16, vcc
 v_cndmask_b32 v50, v16, v36, vcc
 v_cndmask_b32 v49, v37, v17, vcc
 v_cndmask_b32 v51, v17, v37, vcc
 buffer_store_dwordx4 v[48:51], v4, s[8:11], s39 offen offset:0 sc1
 s_waitcnt lgkmcnt(3)
 v_cndmask_b32 v52, v38, v18, vcc
 v_cndmask_b32 v54, v18, v38, vcc
 v_cndmask_b32 v53, v39, v19, vcc
 v_cndmask_b32 v55, v19, v39, vcc
 buffer_store_dwordx4 v[52:55], v4, s[8:11], s39 offen offset:1024 sc1
 s_waitcnt lgkmcnt(2)
 v_cndmask_b32 v56, v40, v20, vcc
 v_cndmask_b32 v58, v20, v40, vcc
 v_cndmask_b32 v57, v41, v21, vcc
 v_cndmask_b32 v59, v21, v41, vcc
 buffer_store_dwordx4 v[56:59], v4, s[8:11], s39 offen offset:2048 sc1
 s_waitcnt lgkmcnt(1)
 v_cndmask_b32 v60, v42, v22, vcc
 v_cndmask_b32 v62, v22, v42, vcc
 v_cndmask_b32 v61, v43, v23, vcc
 v_cndmask_b32 v63, v23, v43, vcc
 buffer_store_dwordx4 v[60:63], v4, s[8:11], s39 offen offset:3072 sc1
 s_waitcnt lgkmcnt(0)
 v_cndmask_b32 v64, v44, v24, vcc
 v_cndmask_b32 v66, v24, v44, vcc
 v_cndmask_b32 v65, v45, v25, vcc
 v_cndmask_b32 v67, v25, v45, vcc
 buffer_store_dwordx4 v[64:67], v4, s[8:11], s37 offen sc1
 s_and_b32 s3, s98, 15
 s_lshl_b32 s36, s3, 8
 s_add_u32 s36, s36, 0x18d0000
 v_mov_b32 v8, 1
 v_lshlrev_b32 v9, 11, v1
 s_waitcnt vmcnt(0)
 s_barrier
 s_cmp_lg_u32 s20, 0
 s_cbranch_scc1 L_j2_arr
 s_mov_b32 exec_hi, 0
 s_mov_b32 exec_lo, 1
 buffer_atomic_add v8, v9, s[8:11], s36 offen sc1
 s_mov_b64 exec, -1
L_j2_arr:
 s_branch L_kp_p3
L_kp_j4:
 s_sub_u32 s21, s98, 216
 s_lshl2_add_u32 s21, s21, s20
 s_mul_hi_u32 s22, s21, 0x55555556
 s_mul_i32 s3, s22, 3
 s_sub_u32 s23, s21, s3
 s_mul_i32 s23, s23, 6
 s_add_u32 s24, s23, 6
 s_lshr_b32 s3, s22, 1
 s_lshl_b32 s3, s3, 5
 s_and_b32 s25, s22, 1
 s_lshl2_add_u32 s3, s25, s3
 s_cmp_ge_u32 s22, 18
 s_cselect_b32 s25, 576, 0
 s_sub_u32 s3, s3, s25
 v_lshrrev_b32 v8, 2, v2
 v_and_b32 v9, 3, v2
 v_lshl_add_u32 v8, v8, 3, v9
 v_add_u32 v8, s3, v8
 v_cvt_f32_i32 v10, v8
 v_mul_f32 v10, 0x3ae38e39, v10
 v_lshlrev_b32 v9, 2, v3
 v_cvt_f32_u32 v9, v9
 v_and_b32 v11, 1, v2
 v_lshlrev_b32 v11, 31, v11
 v_xor_b32 v11, 0x3d2aaaab, v11
 v_mov_b32 v12, 0x3d2aaaab
 v_cvt_pk_bf16_f32 v11, v11, v12
 s_mov_b32 s26, 0x3d715bef
 s_and_b32 s27, s22, 15
 s_mul_i32 s27, s27, 3
 s_lshr_b32 s3, s22, 4
 s_add_u32 s27, s27, s3
 s_mul_i32 s27, s27, 18432
 s_add_u32 s27, s27, 0x1780000
L_j4_loop:
 s_lshl_b32 s3, s23, 4
 v_cvt_f32_u32 v13, s3
 v_add_f32 v13, v13, v9
 v_cmp_eq_f32 vcc, 0, v13
 v_mul_f32 v13, v13, v10
 v_fract_f32 v13, v13
 v_fmamk_f32 v14, v10, 0x00000000, v13
 v_cos_f32 v15, v14
 v_sin_f32 v16, v14
 v_mul_f32 v15, s26, v15
 v_mul_f32 v16, s26, v16
 v_cvt_pk_bf16_f32 v20, v15, -v16
 v_fmamk_f32 v14, v10, 0x3f800000, v13
 v_cos_f32 v15, v14
 v_sin_f32 v16, v14
 v_mul_f32 v15, s26, v15
 v_mul_f32 v16, s26, v16
 v_cvt_pk_bf16_f32 v21, v15, -v16
 v_fmamk_f32 v14, v10, 0x40000000, v13
 v_cos_f32 v15, v14
 v_sin_f32 v16, v14
 v_mul_f32 v15, s26, v15
 v_mul_f32 v16, s26, v16
 v_cvt_pk_bf16_f32 v22, v15, -v16
 v_fmamk_f32 v14, v10, 0x40400000, v13
 v_cos_f32 v15, v14
 v_sin_f32 v16, v14
 v_mul_f32 v15, s26, v15
 v_mul_f32 v16, s26, v16
 v_cvt_pk_bf16_f32 v23, v15, -v16
 v_cndmask_b32 v20, v20, v11, vcc
 s_lshl_b32 s3, s23, 10
 s_add_u32 s3, s3, s27
 buffer_store_dwordx4 v[20:23], v4, s[8:11], s3 offen sc1
 s_add_u32 s23, s23, 1
 s_cmp_lt_u32 s23, s24
 s_cbranch_scc1 L_j4_loop
L_kp_pz:
 s_sub_u32 s21, s98, 216
 s_mul_i32 s22, s21, 61440
 s_add_u32 s22, s22, 0x6f0000
 s_mov_b32 s23, 15
 v_mov_b32 v8, -1
 v_mov_b32 v9, -1
 v_mov_b32 v10, -1
 v_mov_b32 v11, -1
 v_lshlrev_b32 v7, 4, v0
L_pz_loop:
 s_min_u32 s3, s22, 0x93f000
 buffer_store_dwordx4 v[8:11], v7, s[8:11], s3 offen sc1
 s_add_u32 s22, s22, 4096
 s_sub_u32 s23, s23, 1
 s_cmp_lg_u32 s23, 0
 s_cbranch_scc1 L_pz_loop
 s_and_b32 s3, s98, 15
 s_lshl_b32 s36, s3, 8
 s_add_u32 s36, s36, 0x18d0000
 v_mov_b32 v8, 1
 v_lshlrev_b32 v9, 11, v1
 s_waitcnt vmcnt(0)
 s_barrier
 s_cmp_lg_u32 s20, 0
 s_cbranch_scc1 L_js_arr
 s_mov_b32 exec_hi, 0
 s_mov_b32 exec_lo, 1
 buffer_atomic_add v8, v9, s[8:11], s36 offen sc1
 s_mov_b64 exec, -1
L_js_arr:
L_kp_pref:
 s_add_u32 s61, s60, 0
 s_lshl_b32 s3, s20, 10
 s_add_u32 m0, s3, 0
 s_nop 0
 buffer_load_dwordx4 v4, s[8:11], s61 offen lds
 s_add_u32 s61, s61, 4096
 s_add_u32 m0, m0, 4096
 s_nop 0
 buffer_load_dwordx4 v4, s[8:11], s61 offen lds
 s_add_u32 s61, s61, 4096
 s_add_u32 m0, m0, 4096
 s_nop 0
 buffer_load_dwordx4 v4, s[8:11], s61 offen lds
 s_add_u32 s61, s61, 4096
 s_add_u32 m0, m0, 4096
 s_nop 0
 buffer_load_dwordx4 v4, s[8:11], s61 offen lds
 s_add_u32 s61, s61, 4096
 s_add_u32 m0, m0, 4096
 s_nop 0
 buffer_load_dwordx4 v4, s[8:11], s61 offen lds
 s_add_u32 s61, s61, 4096
 s_add_u32 m0, m0, 4096
 s_nop 0
 buffer_load_dwordx4 v4, s[8:11], s61 offen lds
 s_add_u32 s61, s61, 4096
 s_add_u32 m0, m0, 4096
 s_nop 0
 buffer_load_dwordx4 v4, s[8:11], s61 offen lds
 s_add_u32 s61, s61, 4096
 s_add_u32 m0, m0, 4096
 s_nop 0
 buffer_load_dwordx4 v4, s[8:11], s61 offen lds
 s_add_u32 s61, s61, 4096
 s_add_u32 m0, m0, 4096
 s_nop 0
 buffer_load_dwordx4 v4, s[8:11], s61 offen lds
 s_add_u32 s61, s61, 4096
 s_add_u32 m0, m0, 4096
 s_nop 0
 buffer_load_dwordx4 v4, s[8:11], s61 offen lds
 s_add_u32 s61, s61, 4096
 s_add_u32 m0, m0, 4096
 s_nop 0
 buffer_load_dwordx4 v4, s[8:11], s61 offen lds
 s_add_u32 s61, s61, 4096
 s_add_u32 m0, m0, 4096
 s_nop 0
 buffer_load_dwordx4 v4, s[8:11], s61 offen lds
 s_add_u32 s61, s61, 4096
 s_add_u32 m0, m0, 4096
 s_nop 0
 buffer_load_dwordx4 v4, s[8:11], s61 offen lds
 s_add_u32 s61, s61, 4096
 s_add_u32 m0, m0, 4096
 s_nop 0
 buffer_load_dwordx4 v4, s[8:11], s61 offen lds
 s_add_u32 s61, s61, 4096
 s_add_u32 m0, m0, 4096
 s_nop 0
 buffer_load_dwordx4 v4, s[8:11], s61 offen lds
 s_add_u32 s61, s61, 4096
 s_add_u32 m0, m0, 4096
 s_nop 0
 buffer_load_dwordx4 v4, s[8:11], s61 offen lds
 s_add_u32 s61, s61, 4096
 s_add_u32 m0, m0, 4096
 s_nop 0
 buffer_load_dwordx4 v4, s[8:11], s61 offen lds
 s_add_u32 s61, s61, 4096
 s_add_u32 m0, m0, 4096
 s_nop 0
 buffer_load_dwordx4 v4, s[8:11], s61 offen lds
 s_add_u32 s61, s61, 4096
 s_add_u32 m0, m0, 4096
 s_nop 0
 buffer_load_dwordx4 v4, s[8:11], s61 offen lds
 s_add_u32 s61, s61, 4096
 s_add_u32 m0, m0, 4096
 s_nop 0
 buffer_load_dwordx4 v4, s[8:11], s61 offen lds
 s_add_u32 s61, s61, 4096
 s_add_u32 m0, m0, 4096
 s_nop 0
 buffer_load_dwordx4 v4, s[8:11], s61 offen lds
 s_add_u32 s61, s61, 4096
 s_add_u32 m0, m0, 4096
 s_nop 0
 buffer_load_dwordx4 v4, s[8:11], s61 offen lds
 s_add_u32 s61, s61, 4096
 s_add_u32 m0, m0, 4096
 s_cmp_ge_u32 s20, 2
 s_cbranch_scc1 L_pf_n22
 buffer_load_dwordx4 v4, s[8:11], s61 offen lds
 s_add_u32 s61, s61, 4096
 s_add_u32 m0, m0, 4096
L_pf_n22:
 s_branch L_kp_p3
L_kp_exit:
 s_endpgm
L_code_end:
.section .rodata,"a"
.p2align 6
.amdhsa_kernel k1_kernel
  .amdhsa_next_free_vgpr 188
  .amdhsa_next_free_sgpr 63
  .amdhsa_accum_offset 148
  .amdhsa_group_segment_fixed_size 0
  .amdhsa_kernarg_size 72
  .amdhsa_user_sgpr_count 2
  .amdhsa_user_sgpr_kernarg_segment_ptr 1
  .amdhsa_system_sgpr_workgroup_id_x 1
  .amdhsa_float_denorm_mode_32 3
.end_amdhsa_kernel
.p2align 6
.amdhsa_kernel kp_kernel
  .amdhsa_next_free_vgpr 456
  .amdhsa_next_free_sgpr 99
  .amdhsa_accum_offset 256
  .amdhsa_group_segment_fixed_size 0
  .amdhsa_kernarg_size 72
  .amdhsa_user_sgpr_count 2
  .amdhsa_user_sgpr_kernarg_segment_ptr 1
  .amdhsa_system_sgpr_workgroup_id_x 1
  .amdhsa_float_denorm_mode_32 3
.end_amdhsa_kernel
```
